```python
import torch

def _softmax(x, axis=-1):
    return torch.softmax(x, dim=axis)
def _gelu(x):
    return torch.nn.functional.gelu(x, approximate="tanh")
def _silu(x):
    return torch.nn.functional.silu(x)
def _sigmoid(x):
    return torch.sigmoid(x)
def _layernorm(x, axis=-1, eps=1e-5):
    m = x.mean(dim=axis, keepdim=True)
    v = x.var(dim=axis, keepdim=True, unbiased=False)
    return (x - m) / torch.sqrt(v + eps)
def _scatter_add(tgt, idx, src, axis=0):
    return tgt.clone().index_add_(axis, idx, src)
def _segment_sum(src, seg, n):
    out = torch.zeros((n,) + src.shape[1:], dtype=src.dtype)
    return out.index_add_(0, seg, src)
def _pad(x, pw):
    flat = tuple(v for pair in reversed(pw) for v in pair)
    return torch.nn.functional.pad(x, flat)

kernel_name = 'gated_mix__spectral_gfnet__swiglu_ffn__prompt'

def setup_inputs():

    _w = (lambda a: (lambda t: t.to(torch.bfloat16) if t.is_floating_point() else t)(torch.as_tensor(a)))
    def _A_setup():
        B, S, D = 1, 2048, 448
        Df = D // 2 + 1
        return {
            "x": _w((lambda *s: torch.randn(*s, dtype=torch.bfloat16) * 0.05)(B, S, D)),
            "w_r": _w((lambda *s: torch.randn(*s, dtype=torch.bfloat16) * 0.8)(S, Df) * 0.02),
            "w_i": _w((lambda *s: torch.randn(*s, dtype=torch.bfloat16) * 0.8)(S, Df) * 0.02),
        }
    _A_in = _A_setup()

    def _B_setup():
        B, S, D, F = 1, 2048, 448, 1792
        return {
            "x": _w((lambda *s: torch.randn(*s, dtype=torch.bfloat16) * 0.05)(B, S, D)),
            "w_gate": _w((lambda *s: torch.randn(*s, dtype=torch.bfloat16) * 0.05)(D, F)),
            "w_up": _w((lambda *s: torch.randn(*s, dtype=torch.bfloat16) * 0.05)(D, F)),
            "w_down": _w((lambda *s: torch.randn(*s, dtype=torch.bfloat16) * 0.05)(F, D)),
        }
    _B_in = _B_setup()

    return {
        "A_x": _A_in["x"],
        "A_w_r": _A_in["w_r"],
        "A_w_i": _A_in["w_i"],
        "B_x": _B_in["x"],
        "B_w_gate": _B_in["w_gate"],
        "B_w_up": _B_in["w_up"],
        "B_w_down": _B_in["w_down"],
        "gate_w": _w((lambda *s: torch.randn(*s, dtype=torch.bfloat16) * 0.05)(448) * 16.0),
    }

def reference(A_x, A_w_r, A_w_i, B_x, B_w_gate, B_w_up, B_w_down, gate_w):
    def _A_ref(x, w_r, w_i):
        B, S, D = x.shape
        X = (lambda x, axes=(-2,-1): torch.fft.rfft2(x.float(), dim=axes))(x, axes=(-2, -1))
        W = w_r + 1j * w_i
        X = X * W
        y = (lambda x, s, axes=(-2,-1): torch.fft.irfft2(x, s=s, dim=axes).to(torch.bfloat16))(X, (S, D), axes=(-2, -1))
        return y

    def _B_ref(x, w_gate, w_up, w_down):
        g = _silu(x @ w_gate)
        u = x @ w_up
        return (g * u) @ w_down

    x = A_x
    g = _sigmoid((x * gate_w).sum(-1, keepdims=True))
    a = _A_ref(x, A_w_r, A_w_i)
    b = _B_ref(x, B_w_gate, B_w_up, B_w_down)
    return g * a + (1 - g) * b
```

```asm
; @launch grid=(256,1,1) block=(256,1,1) lds=163840
.amdgcn_target "amdgcn-amd-amdhsa--gfx950"
.text
.globl gated_mix__spectral_gfnet__swiglu_ffn__prompt_kernel
.p2align 8
.type gated_mix__spectral_gfnet__swiglu_ffn__prompt_kernel,@function
gated_mix__spectral_gfnet__swiglu_ffn__prompt_kernel:
L_begin:
    s_cmp_ge_u32 s2, 256
    s_cbranch_scc1 L_exit
    s_load_dwordx16 s[64:79], s[0:1], 0
    s_load_dwordx2 s[80:81], s[0:1], 64
    s_load_dwordx2 s[82:83], s[0:1], 80
    s_lshr_b32 s34, s2, 3
    s_getpc_b64 s[4:5]
L_pc:
    s_mul_i32 s3, s34, 12
    v_add_u32 v2, s3, v0
    v_lshlrev_b32 v2, 7, v2
    v_min_u32 v2, L_end-L_pc-4, v2
    v_mov_b32 v3, 0
    v_lshl_add_u64 v[2:3], v[2:3], 0, s[4:5]
    v_cmp_gt_u32 vcc, 12, v0
    s_nop 0
    s_and_saveexec_b64 s[6:7], vcc
    s_cbranch_execz L_nopf
    global_load_dword v255, v[2:3], off
L_nopf:
    s_mov_b64 exec, s[6:7]
    v_lshrrev_b32 v1, 6, v0
    v_and_b32 v0, 63, v0
    s_and_b32 s33, s2, 7
    v_readfirstlane_b32 s28, v1
    v_lshlrev_b32 v32, 4, v0
    s_cmp_ge_u32 s34, 28
    s_cbranch_scc1 L_spare
    s_and_b32 s29, s34, 3
    s_and_b32 s3, s33, 6
    s_lshl_b32 s3, s3, 1
    s_add_u32 s29, s29, s3
    s_and_b32 s31, s33, 1
    s_lshr_b32 s32, s34, 2
    v_lshrrev_b32 v1, 3, v0
    v_and_b32 v2, 7, v0
    v_lshrrev_b32 v39, 4, v0
    v_xor_b32 v3, v2, v39
    v_mul_u32_u24 v1, 57344, v1
    s_lshl_b32 s3, s29, 2
    s_add_u32 s61, s3, s28
    s_mul_i32 s3, s61, 896
    v_add_u32 v1, s3, v1
    v_lshl_add_u32 v4, v3, 4, v1
    v_xor_b32 v3, 4, v3
    v_lshl_add_u32 v5, v3, 4, v1
    v_add_u32 v6, 915456, v4
    v_add_u32 v7, 1373184, v5
    v_add_u32 v5, 457728, v5
    s_lshl_b32 s62, s28, 12
    s_lshl_b32 s54, s32, 7
    v_mov_b32 v33, 11173888
    v_and_b32 v38, 15, v0
    s_and_b32 s33, s28, 1
    s_lshr_b32 s63, s28, 1
    s_and_b32 s3, s2, -2
    s_mul_i32 s38, s31, 224
    s_add_u32 s38, s38, s3
    s_lshl_b32 s38, s38, 1
    s_add_u32 s38, s38, s28
    s_mul_i32 s38, s38, 1792
    s_add_u32 s3, s3, s63
    s_lshl_b32 s3, s3, 2
    s_add_u32 s3, s3, s31
    s_mul_i32 s35, s3, 1792
    v_mul_u32_u24 v31, 3584, v39
    v_lshl_add_u32 v31, v38, 7, v31
    s_mul_i32 s39, s31, 112
    s_add_u32 s39, s39, s32
    s_mul_i32 s30, s31, 7
    s_add_u32 s30, s30, s32
    v_mad_u32_u24 v1, v38, 7, s39
    s_xor_b32 s3, s33, s29
    s_and_b32 s3, s3, 1
    v_lshl_add_u32 v3, v1, 1, s3
    v_cmp_eq_u32 vcc, 1, v3
    v_mov_b32 v3, 224
    v_cvt_f32_u32 v2, s3
    v_cndmask_b32 v1, v1, v3, vcc
    v_cndmask_b32 v2, v2, 0, vcc
    v_cvt_f32_u32 v1, v1
    v_mul_f32 v80, 0x3b124925, v1
    s_mul_i32 s3, s63, 224
    s_lshr_b32 s34, s54, 1
    s_add_u32 s3, s3, s34
    v_lshl_add_u32 v1, v39, 3, s3
    v_cvt_f32_u32 v1, v1
    s_waitcnt lgkmcnt(0)
    s_mov_b32 s8, s64
    s_and_b32 s9, s65, 0xffff
    s_mov_b32 s10, 1835008
    s_mov_b32 s11, 0x20000
    s_add_u32 m0, s62, 0
    s_nop 0
    buffer_load_dwordx4 v4, s[8:11], s54 offen offset:0 lds
    buffer_load_dwordx4 v5, s[8:11], s54 offen offset:1024 lds
    s_cmp_eq_u32 s33, 1
    s_cselect_b32 s72, s74, s72
    s_cselect_b32 s73, s75, s73
    s_mov_b32 s12, s72
    s_and_b32 s13, s73, 0xffff
    s_mov_b32 s14, 1605632
    s_mov_b32 s15, 0x20000
    buffer_load_dwordx4 v6, s[8:11], s54 offen offset:2048 lds
    s_mov_b32 s16, s76
    s_and_b32 s17, s77, 0xffff
    s_mov_b32 s18, 1605632
    s_mov_b32 s19, 0x20000
    s_mov_b32 s20, s82
    s_and_b32 s21, s83, 0xffff
    s_mov_b32 s22, 13631488
    s_mov_b32 s23, 0x20000
    buffer_load_dwordx4 v7, s[8:11], s54 offen offset:3072 lds
    s_mov_b64 exec, 0x15551555
    buffer_load_dword v254, v31, s[12:15], s35 offen
    s_mov_b64 exec, -1
    buffer_load_dword v30, v33, s[20:23], 0 offen sc1
    v_mul_f32 v1, v1, v80
    v_fract_f32 v1, v1
    v_fmamk_f32 v64, v2, 0x3e800000, v1
    v_add_f32 v65, v64, v80
    v_mul_f32 v82, 0x42000000, v80
    v_add_f32 v80, v80, v80
    v_fract_f32 v82, v82
    v_pk_add_f32 v[66:67], v[64:65], v[80:81] op_sel_hi:[1,0]
    v_pk_add_f32 v[68:69], v[66:67], v[80:81] op_sel_hi:[1,0]
    v_pk_add_f32 v[70:71], v[68:69], v[80:81] op_sel_hi:[1,0]
    v_pk_add_f32 v[72:73], v[64:65], v[82:83] op_sel_hi:[1,0]
    v_pk_add_f32 v[74:75], v[66:67], v[82:83] op_sel_hi:[1,0]
    v_pk_add_f32 v[76:77], v[68:69], v[82:83] op_sel_hi:[1,0]
    v_pk_add_f32 v[78:79], v[70:71], v[82:83] op_sel_hi:[1,0]
    v_cos_f32 v82, v82
    v_cos_f32 v64, v64
    v_cos_f32 v65, v65
    v_cos_f32 v66, v66
    v_cos_f32 v67, v67
    v_cos_f32 v68, v68
    v_cos_f32 v69, v69
    v_cos_f32 v70, v70
    v_cos_f32 v71, v71
    v_cos_f32 v72, v72
    v_cos_f32 v73, v73
    v_cos_f32 v74, v74
    v_cos_f32 v75, v75
    v_cos_f32 v76, v76
    v_cos_f32 v77, v77
    v_cos_f32 v78, v78
    v_cos_f32 v79, v79
    v_add_f32 v82, v82, v82
    s_mul_i32 s3, s63, 14336
    s_lshl_b32 s34, s33, 10
    s_add_u32 s3, s3, s34
    s_add_u32 s3, s3, 131072
    v_add_u32 v3, s3, v32
    v_cvt_pk_bf16_f32 v84, v64, v65
    v_cvt_pk_bf16_f32 v85, v66, v67
    v_cvt_pk_bf16_f32 v86, v68, v69
    v_cvt_pk_bf16_f32 v87, v70, v71
    ds_write_b128 v3, v[84:87] offset:0
    v_cvt_pk_bf16_f32 v88, v72, v73
    v_cvt_pk_bf16_f32 v89, v74, v75
    v_cvt_pk_bf16_f32 v90, v76, v77
    v_cvt_pk_bf16_f32 v91, v78, v79
    ds_write_b128 v3, v[88:91] offset:2048
    v_pk_fma_f32 v[64:65], v[82:83], v[72:73], v[64:65] op_sel_hi:[0,1,1] neg_lo:[0,0,1] neg_hi:[0,0,1]
    v_pk_fma_f32 v[66:67], v[82:83], v[74:75], v[66:67] op_sel_hi:[0,1,1] neg_lo:[0,0,1] neg_hi:[0,0,1]
    v_pk_fma_f32 v[68:69], v[82:83], v[76:77], v[68:69] op_sel_hi:[0,1,1] neg_lo:[0,0,1] neg_hi:[0,0,1]
    v_pk_fma_f32 v[70:71], v[82:83], v[78:79], v[70:71] op_sel_hi:[0,1,1] neg_lo:[0,0,1] neg_hi:[0,0,1]
    v_cvt_pk_bf16_f32 v84, v64, v65
    v_cvt_pk_bf16_f32 v85, v66, v67
    v_cvt_pk_bf16_f32 v86, v68, v69
    v_cvt_pk_bf16_f32 v87, v70, v71
    ds_write_b128 v3, v[84:87] offset:4096
    v_pk_fma_f32 v[72:73], v[82:83], v[64:65], v[72:73] op_sel_hi:[0,1,1] neg_lo:[0,0,1] neg_hi:[0,0,1]
    v_pk_fma_f32 v[74:75], v[82:83], v[66:67], v[74:75] op_sel_hi:[0,1,1] neg_lo:[0,0,1] neg_hi:[0,0,1]
    v_pk_fma_f32 v[76:77], v[82:83], v[68:69], v[76:77] op_sel_hi:[0,1,1] neg_lo:[0,0,1] neg_hi:[0,0,1]
    v_pk_fma_f32 v[78:79], v[82:83], v[70:71], v[78:79] op_sel_hi:[0,1,1] neg_lo:[0,0,1] neg_hi:[0,0,1]
    v_cvt_pk_bf16_f32 v88, v72, v73
    v_cvt_pk_bf16_f32 v89, v74, v75
    v_cvt_pk_bf16_f32 v90, v76, v77
    v_cvt_pk_bf16_f32 v91, v78, v79
    ds_write_b128 v3, v[88:91] offset:6144
    v_pk_fma_f32 v[64:65], v[82:83], v[72:73], v[64:65] op_sel_hi:[0,1,1] neg_lo:[0,0,1] neg_hi:[0,0,1]
    v_pk_fma_f32 v[66:67], v[82:83], v[74:75], v[66:67] op_sel_hi:[0,1,1] neg_lo:[0,0,1] neg_hi:[0,0,1]
    v_pk_fma_f32 v[68:69], v[82:83], v[76:77], v[68:69] op_sel_hi:[0,1,1] neg_lo:[0,0,1] neg_hi:[0,0,1]
    v_pk_fma_f32 v[70:71], v[82:83], v[78:79], v[70:71] op_sel_hi:[0,1,1] neg_lo:[0,0,1] neg_hi:[0,0,1]
    v_cvt_pk_bf16_f32 v84, v64, v65
    v_cvt_pk_bf16_f32 v85, v66, v67
    v_cvt_pk_bf16_f32 v86, v68, v69
    v_cvt_pk_bf16_f32 v87, v70, v71
    ds_write_b128 v3, v[84:87] offset:8192
    v_pk_fma_f32 v[72:73], v[82:83], v[64:65], v[72:73] op_sel_hi:[0,1,1] neg_lo:[0,0,1] neg_hi:[0,0,1]
    v_pk_fma_f32 v[74:75], v[82:83], v[66:67], v[74:75] op_sel_hi:[0,1,1] neg_lo:[0,0,1] neg_hi:[0,0,1]
    v_pk_fma_f32 v[76:77], v[82:83], v[68:69], v[76:77] op_sel_hi:[0,1,1] neg_lo:[0,0,1] neg_hi:[0,0,1]
    v_pk_fma_f32 v[78:79], v[82:83], v[70:71], v[78:79] op_sel_hi:[0,1,1] neg_lo:[0,0,1] neg_hi:[0,0,1]
    v_cvt_pk_bf16_f32 v88, v72, v73
    v_cvt_pk_bf16_f32 v89, v74, v75
    v_cvt_pk_bf16_f32 v90, v76, v77
    v_cvt_pk_bf16_f32 v91, v78, v79
    ds_write_b128 v3, v[88:91] offset:10240
    v_pk_fma_f32 v[64:65], v[82:83], v[72:73], v[64:65] op_sel_hi:[0,1,1] neg_lo:[0,0,1] neg_hi:[0,0,1]
    v_pk_fma_f32 v[66:67], v[82:83], v[74:75], v[66:67] op_sel_hi:[0,1,1] neg_lo:[0,0,1] neg_hi:[0,0,1]
    v_pk_fma_f32 v[68:69], v[82:83], v[76:77], v[68:69] op_sel_hi:[0,1,1] neg_lo:[0,0,1] neg_hi:[0,0,1]
    v_pk_fma_f32 v[70:71], v[82:83], v[78:79], v[70:71] op_sel_hi:[0,1,1] neg_lo:[0,0,1] neg_hi:[0,0,1]
    v_cvt_pk_bf16_f32 v84, v64, v65
    v_cvt_pk_bf16_f32 v85, v66, v67
    v_cvt_pk_bf16_f32 v86, v68, v69
    v_cvt_pk_bf16_f32 v87, v70, v71
    ds_write_b128 v3, v[84:87] offset:12288
    s_add_u32 s55, s54, 128
    s_cmp_eq_u32 s55, 896
    s_cselect_b32 s55, 0, s55
    s_add_u32 s56, s55, 128
    s_cmp_eq_u32 s56, 896
    s_cselect_b32 s56, 0, s56
    s_add_u32 s57, s56, 128
    s_cmp_eq_u32 s57, 896
    s_cselect_b32 s57, 0, s57
    s_add_u32 s58, s57, 128
    s_cmp_eq_u32 s58, 896
    s_cselect_b32 s58, 0, s58
    s_add_u32 s59, s58, 128
    s_cmp_eq_u32 s59, 896
    s_cselect_b32 s59, 0, s59
    s_add_u32 s60, s59, 128
    s_cmp_eq_u32 s60, 896
    s_cselect_b32 s60, 0, s60
    v_add_u32 v8, 131072, v32
    s_waitcnt lgkmcnt(0)
    s_barrier
    ds_read_b128 v[128:131], v8 offset:0
    v_lshrrev_b32 v1, 3, v0
    v_and_b32 v2, 7, v0
    v_and_b32 v3, 2, v1
    ds_read_b128 v[132:135], v8 offset:1024
    v_xor_b32 v3, v2, v3
    v_mul_u32_u24 v12, 3584, v1
    s_mul_i32 s3, s63, 114688
    ds_read_b128 v[136:139], v8 offset:2048
    s_lshl_b32 s34, s30, 8
    s_add_u32 s3, s3, s34
    v_add_u32 v14, s3, v12
    ds_read_b128 v[140:143], v8 offset:3072
    v_lshl_add_u32 v12, v3, 4, v14
    v_xor_b32 v3, 4, v3
    v_lshl_add_u32 v13, v3, 4, v14
    ds_read_b128 v[144:147], v8 offset:4096
    v_add_u32 v14, 55296, v12
    v_add_u32 v15, 82944, v13
    v_add_u32 v13, 27648, v13
    ds_read_b128 v[148:151], v8 offset:5120
    s_lshl_b32 s6, s33, 1
    s_add_u32 s6, s6, s63
    s_lshl_b32 s6, s6, 12
    ds_read_b128 v[152:155], v8 offset:6144
    s_add_u32 s6, s6, 98304
    s_mul_i32 s40, s54, 1792
    s_add_u32 s47, s40, 128
    ds_read_b128 v[156:159], v8 offset:7168
    s_mul_i32 s41, s55, 1792
    s_add_u32 s48, s41, 128
    s_mul_i32 s42, s56, 1792
    ds_read_b128 v[160:163], v8 offset:8192
    s_add_u32 s49, s42, 128
    s_mul_i32 s43, s57, 1792
    s_add_u32 s50, s43, 128
    ds_read_b128 v[164:167], v8 offset:9216
    s_mul_i32 s44, s58, 1792
    s_add_u32 s51, s44, 128
    s_mul_i32 s45, s59, 1792
    ds_read_b128 v[168:171], v8 offset:10240
    s_add_u32 s52, s45, 128
    s_mul_i32 s46, s60, 1792
    s_add_u32 s53, s46, 128
    ds_read_b128 v[172:175], v8 offset:11264
    v_and_b32 v3, 6, v1
    v_xor_b32 v2, v2, v3
    v_mul_u32_u24 v1, 896, v1
    ds_read_b128 v[176:179], v8 offset:12288
    v_lshl_add_u32 v1, v2, 4, v1
    s_mul_i32 s4, s31, 28
    s_add_u32 s4, s4, s33
    ds_read_b128 v[180:183], v8 offset:13312
    s_mul_i32 s3, s4, 28672
    s_lshl_b32 s34, s32, 7
    s_add_u32 s3, s3, s34
    ds_read_b128 v[184:187], v8 offset:14336
    v_add_u32 v18, s3, v1
    v_add_u32 v19, 6144, v18
    v_add_u32 v20, 12288, v18
    ds_read_b128 v[188:191], v8 offset:15360
    v_add_u32 v21, 18432, v18
    v_bfe_u32 v1, v0, 2, 2
    v_and_b32 v2, 3, v0
    ds_read_b128 v[192:195], v8 offset:16384
    v_lshlrev_b32 v2, 3, v2
    v_lshl_add_u32 v2, v1, 7, v2
    v_bfe_u32 v1, v0, 3, 2
    ds_read_b128 v[196:199], v8 offset:17408
    v_lshl_add_u32 v3, v39, 10, v2
    s_add_u32 m0, s62, 16384
    s_nop 0
    buffer_load_dwordx4 v4, s[8:11], s55 offen offset:0 lds
    v_add_u32 v3, 98304, v3
    s_lshl_b32 s3, s33, 1
    ds_read_b128 v[200:203], v8 offset:18432
    v_xor_b32 v16, s3, v1
    v_lshl_add_u32 v16, v16, 5, v3
    v_xor_b32 v17, 32, v16
    ds_read_b128 v[204:207], v8 offset:19456
    v_lshl_add_u32 v2, v39, 9, v2
    v_lshl_add_u32 v2, v1, 5, v2
    s_lshl_b32 s3, s33, 12
    ds_read_b128 v[208:211], v8 offset:20480
    v_add_u32 v22, s3, v2
    v_xor_b32 v23, 32, v22
    v_xor_b32 v24, 64, v22
    buffer_load_dwordx4 v5, s[8:11], s55 offen offset:1024 lds
    ds_read_b128 v[212:215], v8 offset:21504
    v_xor_b32 v25, 96, v22
    s_mov_b32 s24, s80
    s_and_b32 s25, s81, 0xffff
    ds_read_b128 v[216:219], v8 offset:22528
    s_mov_b32 s26, 1835008
    s_mov_b32 s27, 0x20000
    s_sub_u32 s3, s32, 1
    ds_read_b128 v[220:223], v8 offset:23552
    s_lshr_b32 s3, s3, 17
    s_and_b32 s3, s3, 16384
    s_add_u32 s64, s3, 0
    ds_read_b128 v[224:227], v8 offset:24576
    s_sub_u32 s3, s32, 2
    buffer_load_dwordx4 v6, s[8:11], s55 offen offset:2048 lds
    s_lshr_b32 s3, s3, 17
    s_and_b32 s3, s3, 16384
    ds_read_b128 v[228:231], v8 offset:25600
    s_add_u32 s65, s3, 16384
    s_sub_u32 s3, s32, 3
    s_lshr_b32 s3, s3, 17
    ds_read_b128 v[232:235], v8 offset:26624
    s_and_b32 s3, s3, 16384
    s_add_u32 s66, s3, 32768
    s_sub_u32 s3, s32, 4
    ds_read_b128 v[236:239], v8 offset:27648
    s_lshr_b32 s3, s3, 17
    s_and_b32 s3, s3, 16384
    s_add_u32 s67, s3, 49152
    buffer_load_dwordx4 v7, s[8:11], s55 offen offset:3072 lds
    s_sub_u32 s3, s32, 5
    s_lshr_b32 s3, s3, 17
    s_and_b32 s3, s3, 16384
    s_add_u32 s68, s3, 65536
    s_sub_u32 s3, s32, 6
    s_lshr_b32 s3, s3, 17
    s_and_b32 s3, s3, 16384
    s_add_u32 s69, s3, 81920
    v_lshrrev_b32 v1, 1, v38
    v_and_b32 v2, 1, v38
    v_cmp_eq_u32 vcc, 1, v38
    v_cvt_f32_u32 v49, v1
    v_cvt_f32_u32 v51, v2
    v_cndmask_b32 v1, v1, 16, vcc
    s_add_u32 m0, s62, 32768
    s_nop 0
    buffer_load_dwordx4 v4, s[8:11], s56 offen offset:0 lds
    v_cndmask_b32 v2, v2, 0, vcc
    v_cvt_f32_u32 v48, v1
    v_cvt_f32_u32 v50, v2
    v_add_f32 v49, 0x41000000, v49
    v_lshlrev_b32 v1, 2, v39
    v_cvt_f32_u32 v1, v1
    v_mul_f32 v48, 0x3d000000, v48
    v_mul_f32 v50, 0x3e800000, v50
    v_fmac_f32 v50, v1, v48
    v_fmamk_f32 v40, v48, 0x00000000, v50
    v_fmamk_f32 v41, v48, 0x3f800000, v50
    v_fmamk_f32 v42, v48, 0x40000000, v50
    v_fmamk_f32 v43, v48, 0x40400000, v50
    v_fmamk_f32 v44, v48, 0x41800000, v50
    buffer_load_dwordx4 v5, s[8:11], s56 offen offset:1024 lds
    v_fmamk_f32 v45, v48, 0x41880000, v50
    v_fmamk_f32 v46, v48, 0x41900000, v50
    v_fmamk_f32 v47, v48, 0x41980000, v50
    v_cos_f32 v40, v40
    v_cos_f32 v41, v41
    v_cos_f32 v42, v42
    v_cos_f32 v43, v43
    v_cos_f32 v44, v44
    v_cos_f32 v45, v45
    buffer_load_dwordx4 v6, s[8:11], s56 offen offset:2048 lds
    v_cos_f32 v46, v46
    v_cos_f32 v47, v47
    v_cvt_pk_bf16_f32 v26, v40, v41
    v_cvt_pk_bf16_f32 v27, v42, v43
    v_cvt_pk_bf16_f32 v28, v44, v45
    v_cvt_pk_bf16_f32 v29, v46, v47
    v_mul_f32 v49, 0x3d000000, v49
    v_mul_f32 v51, 0x3e800000, v51
    v_fmac_f32 v51, v1, v49
    v_fmamk_f32 v40, v49, 0x00000000, v51
    v_fmamk_f32 v41, v49, 0x3f800000, v51
    v_fmamk_f32 v42, v49, 0x40000000, v51
    buffer_load_dwordx4 v7, s[8:11], s56 offen offset:3072 lds
    v_fmamk_f32 v43, v49, 0x40400000, v51
    v_fmamk_f32 v44, v49, 0x41800000, v51
    v_fmamk_f32 v45, v49, 0x41880000, v51
    v_fmamk_f32 v46, v49, 0x41900000, v51
    v_fmamk_f32 v47, v49, 0x41980000, v51
    v_cos_f32 v40, v40
    v_cos_f32 v41, v41
    v_cos_f32 v42, v42
    v_cos_f32 v43, v43
    v_cos_f32 v44, v44
    s_add_u32 m0, s62, 49152
    s_nop 0
    buffer_load_dwordx4 v4, s[8:11], s57 offen offset:0 lds
    v_cos_f32 v45, v45
    v_cos_f32 v46, v46
    v_cos_f32 v47, v47
    v_cvt_pk_bf16_f32 v34, v40, v41
    v_cvt_pk_bf16_f32 v35, v42, v43
    v_cvt_pk_bf16_f32 v36, v44, v45
    v_cvt_pk_bf16_f32 v37, v46, v47
    v_lshrrev_b32 v1, 1, v38
    v_xor_b32 v1, v1, v39
    v_lshlrev_b32 v2, 7, v38
    v_lshl_add_u32 v1, v1, 4, v2
    buffer_load_dwordx4 v5, s[8:11], s57 offen offset:1024 lds
    v_add_u32 v8, s62, v1
    v_xor_b32 v9, 64, v8
    v_xor_b32 v10, 4096, v8
    v_xor_b32 v11, 4096, v9
    s_waitcnt lgkmcnt(0)
    s_waitcnt vmcnt(10)
    s_barrier
    ds_read_b128 a[0:3], v8 offset:0
    ds_read_b128 a[4:7], v8 offset:2048
    ds_read_b128 a[16:19], v9 offset:0
    ds_read_b128 a[20:23], v9 offset:2048
    ds_read_b128 a[8:11], v10 offset:0
    ds_read_b128 a[12:15], v10 offset:2048
    ds_read_b128 a[24:27], v11 offset:0
    ds_read_b128 a[28:31], v11 offset:2048
    buffer_load_dwordx4 v6, s[8:11], s57 offen offset:2048 lds
    buffer_load_dwordx4 v7, s[8:11], s57 offen offset:3072 lds
    s_waitcnt vmcnt(8)
    s_barrier
    s_waitcnt lgkmcnt(6)
    v_mfma_f32_16x16x32_bf16 v[240:243], a[0:3], v[128:131], 0
    ds_read_b128 a[32:35], v8 offset:16384
    s_add_u32 m0, s62, 65536
    s_nop 0
    buffer_load_dwordx4 v4, s[8:11], s58 offen offset:0 lds
    v_mfma_f32_16x16x32_bf16 v[244:247], a[4:7], v[128:131], 0
    ds_read_b128 a[36:39], v8 offset:18432
    v_mfma_f32_16x16x32_bf16 v[248:251], a[0:3], v[132:135], 0
    ds_read_b128 a[48:51], v9 offset:16384
    buffer_load_dwordx4 v5, s[8:11], s58 offen offset:1024 lds
    v_mfma_f32_16x16x32_bf16 v[252:255], a[4:7], v[132:135], 0
    ds_read_b128 a[52:55], v9 offset:18432
    s_waitcnt lgkmcnt(8)
    v_mfma_f32_16x16x32_bf16 v[240:243], a[16:19], v[136:139], v[240:243]
    ds_read_b128 a[40:43], v10 offset:16384
    buffer_load_dwordx4 v6, s[8:11], s58 offen offset:2048 lds
    v_mfma_f32_16x16x32_bf16 v[244:247], a[20:23], v[136:139], v[244:247]
    ds_read_b128 a[44:47], v10 offset:18432
    v_mfma_f32_16x16x32_bf16 v[248:251], a[16:19], v[140:143], v[248:251]
    ds_read_b128 a[56:59], v11 offset:16384
    buffer_load_dwordx4 v7, s[8:11], s58 offen offset:3072 lds
    v_mfma_f32_16x16x32_bf16 v[252:255], a[20:23], v[140:143], v[252:255]
    ds_read_b128 a[60:63], v11 offset:18432
    s_waitcnt vmcnt(8)
    s_barrier
    s_waitcnt lgkmcnt(6)
    v_mfma_f32_16x16x32_bf16 v[240:243], a[32:35], v[144:147], v[240:243]
    ds_read_b128 a[64:67], v8 offset:32768
    s_add_u32 m0, s62, 81920
    s_nop 0
    buffer_load_dwordx4 v4, s[8:11], s59 offen offset:0 lds
    v_mfma_f32_16x16x32_bf16 v[244:247], a[36:39], v[144:147], v[244:247]
    ds_read_b128 a[68:71], v8 offset:34816
    v_mfma_f32_16x16x32_bf16 v[248:251], a[32:35], v[148:151], v[248:251]
    ds_read_b128 a[80:83], v9 offset:32768
    buffer_load_dwordx4 v5, s[8:11], s59 offen offset:1024 lds
    v_mfma_f32_16x16x32_bf16 v[252:255], a[36:39], v[148:151], v[252:255]
    ds_read_b128 a[84:87], v9 offset:34816
    s_waitcnt lgkmcnt(8)
    v_mfma_f32_16x16x32_bf16 v[240:243], a[48:51], v[152:155], v[240:243]
    ds_read_b128 a[72:75], v10 offset:32768
    buffer_load_dwordx4 v6, s[8:11], s59 offen offset:2048 lds
    v_mfma_f32_16x16x32_bf16 v[244:247], a[52:55], v[152:155], v[244:247]
    ds_read_b128 a[76:79], v10 offset:34816
    v_mfma_f32_16x16x32_bf16 v[248:251], a[48:51], v[156:159], v[248:251]
    ds_read_b128 a[88:91], v11 offset:32768
    buffer_load_dwordx4 v7, s[8:11], s59 offen offset:3072 lds
    v_mfma_f32_16x16x32_bf16 v[252:255], a[52:55], v[156:159], v[252:255]
    ds_read_b128 a[92:95], v11 offset:34816
    s_waitcnt vmcnt(8)
    s_barrier
    s_waitcnt lgkmcnt(6)
    v_mfma_f32_16x16x32_bf16 v[240:243], a[64:67], v[160:163], v[240:243]
    ds_read_b128 a[96:99], v8 offset:49152
    s_add_u32 m0, s62, 98304
    s_nop 0
    buffer_load_dwordx4 v4, s[8:11], s60 offen offset:0 lds
    v_mfma_f32_16x16x32_bf16 v[244:247], a[68:71], v[160:163], v[244:247]
    ds_read_b128 a[100:103], v8 offset:51200
    v_mfma_f32_16x16x32_bf16 v[248:251], a[64:67], v[164:167], v[248:251]
    ds_read_b128 a[112:115], v9 offset:49152
    buffer_load_dwordx4 v5, s[8:11], s60 offen offset:1024 lds
    v_mfma_f32_16x16x32_bf16 v[252:255], a[68:71], v[164:167], v[252:255]
    ds_read_b128 a[116:119], v9 offset:51200
    s_waitcnt lgkmcnt(8)
    v_mfma_f32_16x16x32_bf16 v[240:243], a[80:83], v[168:171], v[240:243]
    ds_read_b128 a[104:107], v10 offset:49152
    buffer_load_dwordx4 v6, s[8:11], s60 offen offset:2048 lds
    v_mfma_f32_16x16x32_bf16 v[244:247], a[84:87], v[168:171], v[244:247]
    ds_read_b128 a[108:111], v10 offset:51200
    v_mfma_f32_16x16x32_bf16 v[248:251], a[80:83], v[172:175], v[248:251]
    ds_read_b128 a[120:123], v11 offset:49152
    buffer_load_dwordx4 v7, s[8:11], s60 offen offset:3072 lds
    v_mfma_f32_16x16x32_bf16 v[252:255], a[84:87], v[172:175], v[252:255]
    ds_read_b128 a[124:127], v11 offset:51200
    v_add_u32 v8, 65536, v8
    v_add_u32 v9, 65536, v9
    v_add_u32 v10, 65536, v10
    v_add_u32 v11, 65536, v11
    s_waitcnt vmcnt(8)
    s_barrier
    s_waitcnt lgkmcnt(6)
    v_mfma_f32_16x16x32_bf16 v[240:243], a[96:99], v[176:179], v[240:243]
    ds_read_b128 a[128:131], v8 offset:0
    s_add_u32 m0, s6, 16384
    s_nop 0
    buffer_load_dwordx4 v12, s[12:15], s40 offen offset:0 lds
    v_mfma_f32_16x16x32_bf16 v[244:247], a[100:103], v[176:179], v[244:247]
    ds_read_b128 a[132:135], v8 offset:2048
    v_mfma_f32_16x16x32_bf16 v[248:251], a[96:99], v[180:183], v[248:251]
    ds_read_b128 a[144:147], v9 offset:0
    buffer_load_dwordx4 v13, s[12:15], s40 offen offset:1024 lds
    v_mfma_f32_16x16x32_bf16 v[252:255], a[100:103], v[180:183], v[252:255]
    ds_read_b128 a[148:151], v9 offset:2048
    s_waitcnt lgkmcnt(8)
    v_mfma_f32_16x16x32_bf16 v[240:243], a[112:115], v[184:187], v[240:243]
    ds_read_b128 a[136:139], v10 offset:0
    buffer_load_dwordx4 v14, s[12:15], s40 offen offset:2048 lds
    v_mfma_f32_16x16x32_bf16 v[244:247], a[116:119], v[184:187], v[244:247]
    ds_read_b128 a[140:143], v10 offset:2048
    v_mfma_f32_16x16x32_bf16 v[248:251], a[112:115], v[188:191], v[248:251]
    ds_read_b128 a[152:155], v11 offset:0
    buffer_load_dwordx4 v15, s[12:15], s40 offen offset:3072 lds
    v_mfma_f32_16x16x32_bf16 v[252:255], a[116:119], v[188:191], v[252:255]
    ds_read_b128 a[156:159], v11 offset:2048
    s_waitcnt vmcnt(8)
    s_barrier
    s_waitcnt lgkmcnt(6)
    v_mfma_f32_16x16x32_bf16 v[240:243], a[128:131], v[192:195], v[240:243]
    ds_read_b128 a[160:163], v8 offset:16384
    s_add_u32 m0, s6, 32768
    s_nop 0
    buffer_load_dwordx4 v12, s[12:15], s41 offen offset:0 lds
    v_mfma_f32_16x16x32_bf16 v[244:247], a[132:135], v[192:195], v[244:247]
    ds_read_b128 a[164:167], v8 offset:18432
    v_mfma_f32_16x16x32_bf16 v[248:251], a[128:131], v[196:199], v[248:251]
    ds_read_b128 a[176:179], v9 offset:16384
    buffer_load_dwordx4 v13, s[12:15], s41 offen offset:1024 lds
    v_mfma_f32_16x16x32_bf16 v[252:255], a[132:135], v[196:199], v[252:255]
    ds_read_b128 a[180:183], v9 offset:18432
    s_waitcnt lgkmcnt(8)
    v_mfma_f32_16x16x32_bf16 v[240:243], a[144:147], v[200:203], v[240:243]
    ds_read_b128 a[168:171], v10 offset:16384
    buffer_load_dwordx4 v14, s[12:15], s41 offen offset:2048 lds
    v_mfma_f32_16x16x32_bf16 v[244:247], a[148:151], v[200:203], v[244:247]
    ds_read_b128 a[172:175], v10 offset:18432
    v_mfma_f32_16x16x32_bf16 v[248:251], a[144:147], v[204:207], v[248:251]
    ds_read_b128 a[184:187], v11 offset:16384
    buffer_load_dwordx4 v15, s[12:15], s41 offen offset:3072 lds
    v_mfma_f32_16x16x32_bf16 v[252:255], a[148:151], v[204:207], v[252:255]
    ds_read_b128 a[188:191], v11 offset:18432
    s_waitcnt vmcnt(8)
    s_barrier
    s_waitcnt lgkmcnt(6)
    v_mfma_f32_16x16x32_bf16 v[240:243], a[160:163], v[208:211], v[240:243]
    ds_read_b128 a[192:195], v8 offset:32768
    s_add_u32 m0, s6, 49152
    s_nop 0
    buffer_load_dwordx4 v12, s[12:15], s42 offen offset:0 lds
    v_mfma_f32_16x16x32_bf16 v[244:247], a[164:167], v[208:211], v[244:247]
    ds_read_b128 a[196:199], v8 offset:34816
    v_mfma_f32_16x16x32_bf16 v[248:251], a[160:163], v[212:215], v[248:251]
    ds_read_b128 a[208:211], v9 offset:32768
    buffer_load_dwordx4 v13, s[12:15], s42 offen offset:1024 lds
    v_mfma_f32_16x16x32_bf16 v[252:255], a[164:167], v[212:215], v[252:255]
    ds_read_b128 a[212:215], v9 offset:34816
    s_waitcnt lgkmcnt(8)
    v_mfma_f32_16x16x32_bf16 v[240:243], a[176:179], v[216:219], v[240:243]
    ds_read_b128 a[200:203], v10 offset:32768
    buffer_load_dwordx4 v14, s[12:15], s42 offen offset:2048 lds
    v_mfma_f32_16x16x32_bf16 v[244:247], a[180:183], v[216:219], v[244:247]
    ds_read_b128 a[204:207], v10 offset:34816
    v_mfma_f32_16x16x32_bf16 v[248:251], a[176:179], v[220:223], v[248:251]
    ds_read_b128 a[216:219], v11 offset:32768
    buffer_load_dwordx4 v15, s[12:15], s42 offen offset:3072 lds
    v_mfma_f32_16x16x32_bf16 v[252:255], a[180:183], v[220:223], v[252:255]
    ds_read_b128 a[220:223], v11 offset:34816
    s_waitcnt lgkmcnt(6)
    v_mfma_f32_16x16x32_bf16 v[240:243], a[192:195], v[224:227], v[240:243]
    v_mfma_f32_16x16x32_bf16 v[244:247], a[196:199], v[224:227], v[244:247]
    v_mfma_f32_16x16x32_bf16 v[248:251], a[192:195], v[228:231], v[248:251]
    v_mfma_f32_16x16x32_bf16 v[252:255], a[196:199], v[228:231], v[252:255]
    s_waitcnt lgkmcnt(4)
    v_mfma_f32_16x16x32_bf16 v[240:243], a[208:211], v[232:235], v[240:243]
    v_mfma_f32_16x16x32_bf16 v[244:247], a[212:215], v[232:235], v[244:247]
    v_mfma_f32_16x16x32_bf16 v[248:251], a[208:211], v[236:239], v[248:251]
    v_mfma_f32_16x16x32_bf16 v[252:255], a[212:215], v[236:239], v[252:255]
    v_add_u32 v9, s38, v31
    v_add_u32 v10, s35, v31
    s_lshl_b32 s58, s32, 14
    v_lshrrev_b32 v6, 1, v38
    v_mul_u32_u24 v6, 114688, v6
    v_and_b32 v7, 1, v0
    v_lshl_add_u32 v6, v7, 6, v6
    v_cvt_pk_bf16_f32 v192, v240, v241
    v_cvt_pk_bf16_f32 v193, v242, v243
    v_cvt_pk_bf16_f32 v194, v244, v245
    v_cvt_pk_bf16_f32 v195, v246, v247
    v_cvt_pk_bf16_f32 v196, v248, v249
    v_cvt_pk_bf16_f32 v197, v250, v251
    v_cvt_pk_bf16_f32 v198, v252, v253
    v_cvt_pk_bf16_f32 v199, v254, v255
    v_lshl_add_u32 v6, v39, 4, v6
    s_lshl_b32 s3, s30, 13
    v_mfma_f32_16x16x32_bf16 v[200:203], v[192:195], v[26:29], 0
    v_mfma_f32_16x16x32_bf16 v[204:207], v[196:199], v[26:29], 0
    v_mfma_f32_16x16x32_bf16 v[208:211], v[192:195], v[34:37], 0
    v_mfma_f32_16x16x32_bf16 v[212:215], v[196:199], v[34:37], 0
    s_lshl_b32 s34, s61, 7
    s_add_u32 s3, s3, s34
    s_add_u32 s3, s3, 7340032
    v_add_u32 v4, s3, v6
    v_add_u32 v11, 917504, v4
    v_cvt_pk_bf16_f32 v216, v200, v201
    v_cvt_pk_bf16_f32 v217, v202, v203
    v_cvt_pk_bf16_f32 v218, v204, v205
    v_cvt_pk_bf16_f32 v219, v206, v207
    v_and_b32 v216, -2, v216
    buffer_store_dwordx4 v[216:219], v4, s[20:23], 0 offen sc1
    v_cvt_pk_bf16_f32 v220, v208, v209
    v_cvt_pk_bf16_f32 v221, v210, v211
    v_cvt_pk_bf16_f32 v222, v212, v213
    v_cvt_pk_bf16_f32 v223, v214, v215
    v_and_b32 v220, -2, v220
    buffer_store_dwordx4 v[220:223], v11, s[20:23], 0 offen sc1
    s_waitcnt vmcnt(10) lgkmcnt(0)
    s_barrier
    ds_read_b64_tr_b16 v[44:45], v16 offset:16384
    ds_read_b64_tr_b16 v[46:47], v16 offset:16896
    ds_read_b64_tr_b16 v[48:49], v16 offset:24576
    ds_read_b64_tr_b16 v[50:51], v16 offset:25088
    ds_read_b64_tr_b16 v[52:53], v17 offset:16384
    ds_read_b64_tr_b16 v[54:55], v17 offset:16896
    ds_read_b64_tr_b16 v[56:57], v17 offset:24576
    ds_read_b64_tr_b16 v[58:59], v17 offset:25088
    s_waitcnt lgkmcnt(6)
TICK_0:
    v_mfma_f32_16x16x32_bf16 v[128:131], v[44:47], a[0:3], 0
    ds_read_b64_tr_b16 v[60:61], v16 offset:20480
    s_add_u32 m0, s6, 0
    v_mfma_f32_16x16x32_bf16 v[144:147], v[44:47], a[4:7], 0
    ds_read_b64_tr_b16 v[62:63], v16 offset:20992
    buffer_load_dwordx4 v12, s[12:15], s43 offen offset:0 lds
    v_mfma_f32_16x16x32_bf16 v[160:163], v[44:47], a[8:11], 0
    s_mov_b32 s35, 0x9E3779B1
    v_mul_lo_u32 v30, v30, s35
    v_add_u32 v30, 0x7F4A7C15, v30
    v_mfma_f32_16x16x32_bf16 v[176:179], v[44:47], a[12:15], 0
    s_waitcnt lgkmcnt(6)
    v_mov_b32 v31, v30
    s_mul_i32 s3, s29, 1792
TICK_1:
    v_mfma_f32_16x16x32_bf16 v[136:139], v[48:51], a[0:3], 0
    ds_read_b64_tr_b16 v[44:45], v16 offset:28672
    buffer_load_dwordx4 v13, s[12:15], s43 offen offset:1024 lds
    v_mfma_f32_16x16x32_bf16 v[152:155], v[48:51], a[4:7], 0
    ds_read_b64_tr_b16 v[46:47], v16 offset:29184
    s_lshl_b32 s34, s30, 7
    v_mfma_f32_16x16x32_bf16 v[168:171], v[48:51], a[8:11], 0
    s_add_u32 s3, s3, s34
    s_add_u32 s55, s3, 11108352
    v_readfirstlane_b32 s71, v30
    v_mfma_f32_16x16x32_bf16 v[184:187], v[48:51], a[12:15], 0
    s_waitcnt lgkmcnt(6)
    s_cmp_eq_u32 s28, 0
    s_cselect_b32 s3, s55, 2147483392
TICK_2:
    v_mfma_f32_16x16x32_bf16 v[132:135], v[52:55], a[0:3], 0
    ds_read_b64_tr_b16 v[48:49], v17 offset:20480
    buffer_load_dwordx4 v14, s[12:15], s43 offen offset:2048 lds
    v_mfma_f32_16x16x32_bf16 v[148:151], v[52:55], a[4:7], 0
    ds_read_b64_tr_b16 v[50:51], v17 offset:20992
    v_lshl_add_u32 v7, v0, 3, s3
    v_mfma_f32_16x16x32_bf16 v[164:167], v[52:55], a[8:11], 0
    v_mov_b32 v6, 2147483392
    v_cmp_gt_u32 vcc, 16, v0
    v_mfma_f32_16x16x32_bf16 v[180:183], v[52:55], a[12:15], 0
    s_waitcnt lgkmcnt(6)
    s_lshl_b32 s100, s29, 1
    s_add_u32 s100, s100, s31
TICK_3:
    v_mfma_f32_16x16x32_bf16 v[140:143], v[56:59], a[0:3], 0
    ds_read_b64_tr_b16 v[52:53], v17 offset:28672
    buffer_load_dwordx4 v15, s[12:15], s43 offen offset:3072 lds
    v_mfma_f32_16x16x32_bf16 v[156:159], v[56:59], a[4:7], 0
    ds_read_b64_tr_b16 v[54:55], v17 offset:29184
    v_cndmask_b32 v5, v6, v7, vcc
    v_mfma_f32_16x16x32_bf16 v[172:175], v[56:59], a[8:11], 0
    v_mov_b32 v236, -1
    v_mov_b32 v237, -1
    v_mfma_f32_16x16x32_bf16 v[188:191], v[56:59], a[12:15], 0
    s_waitcnt vmcnt(10) lgkmcnt(0)
    v_mov_b32 v238, -1
    v_mov_b32 v239, -1
TICK_4:
    v_mfma_f32_16x16x32_bf16 v[128:131], v[60:63], a[16:19], v[128:131]
    s_barrier
    ds_read_b64_tr_b16 v[56:57], v16 offset:32768
    v_mfma_f32_16x16x32_bf16 v[144:147], v[60:63], a[20:23], v[144:147]
    ds_read_b64_tr_b16 v[58:59], v16 offset:33280
    s_mul_i32 s3, s29, 7
    v_mfma_f32_16x16x32_bf16 v[160:163], v[60:63], a[24:27], v[160:163]
    s_add_u32 s3, s3, s32
    s_lshl_b32 s3, s3, 1
    s_add_u32 s3, s3, s31
    v_mfma_f32_16x16x32_bf16 v[176:179], v[60:63], a[28:31], v[176:179]
    s_lshl_b32 s3, s3, 2
    s_add_u32 s3, s3, s28
TICK_5:
    v_mfma_f32_16x16x32_bf16 v[136:139], v[44:47], a[16:19], v[136:139]
    ds_read_b64_tr_b16 v[60:61], v16 offset:40960
    s_add_u32 m0, s6, 16384
    v_mfma_f32_16x16x32_bf16 v[152:155], v[44:47], a[20:23], v[152:155]
    ds_read_b64_tr_b16 v[62:63], v16 offset:41472
    buffer_load_dwordx4 v12, s[12:15], s44 offen offset:0 lds
    v_mfma_f32_16x16x32_bf16 v[168:171], v[44:47], a[24:27], v[168:171]
    s_lshl_b32 s3, s3, 11
    s_add_u32 s3, s3, 11796480
    s_xor_b32 s59, s3, 8192
    v_mfma_f32_16x16x32_bf16 v[184:187], v[44:47], a[28:31], v[184:187]
    s_lshr_b32 s57, s61, 1
    v_add_u32 v40, 65536, v22
TICK_6:
    v_mfma_f32_16x16x32_bf16 v[132:135], v[48:51], a[16:19], v[132:135]
    ds_read_b64_tr_b16 v[44:45], v17 offset:32768
    v_add_u32 v41, 65536, v23
    v_mfma_f32_16x16x32_bf16 v[148:151], v[48:51], a[20:23], v[148:151]
    ds_read_b64_tr_b16 v[46:47], v17 offset:33280
    v_add_u32 v42, 65536, v24
    v_mfma_f32_16x16x32_bf16 v[164:167], v[48:51], a[24:27], v[164:167]
    v_add_u32 v43, 65536, v25
    v_cmp_eq_u32 s[36:37], 0, v0
    v_mfma_f32_16x16x32_bf16 v[180:183], v[48:51], a[28:31], v[180:183]
    s_mov_b32 s70, s71
    s_lshl_b32 s3, s57, 1
TICK_7:
    v_mfma_f32_16x16x32_bf16 v[140:143], v[52:55], a[16:19], v[140:143]
    ds_read_b64_tr_b16 v[48:49], v17 offset:40960
    buffer_load_dwordx4 v13, s[12:15], s44 offen offset:1024 lds
    v_mfma_f32_16x16x32_bf16 v[156:159], v[52:55], a[20:23], v[156:159]
    ds_read_b64_tr_b16 v[50:51], v17 offset:41472
    s_add_u32 s3, s3, s31
    v_mfma_f32_16x16x32_bf16 v[172:175], v[52:55], a[24:27], v[172:175]
    s_mul_i32 s101, s3, 3584
    s_add_u32 s101, s101, 11534336
    s_lshl_b32 s3, s57, 2
    v_mfma_f32_16x16x32_bf16 v[188:191], v[52:55], a[28:31], v[188:191]
    s_waitcnt lgkmcnt(6)
    s_add_u32 s3, s3, s31
    s_lshl_b32 s3, s3, 8
TICK_8:
    v_mfma_f32_16x16x32_bf16 v[128:131], v[56:59], a[32:35], v[128:131]
    ds_read_b64_tr_b16 v[52:53], v16 offset:36864
    s_add_u32 s39, s3, 11075584
    v_mfma_f32_16x16x32_bf16 v[144:147], v[56:59], a[36:39], v[144:147]
    ds_read_b64_tr_b16 v[54:55], v16 offset:37376
    s_lshl_b32 s34, s33, 3
    v_mfma_f32_16x16x32_bf16 v[160:163], v[56:59], a[40:43], v[160:163]
    s_add_u32 s34, s34, s32
    s_lshl_b32 s3, s34, 2
    s_add_u32 s3, s39, s3
    v_mfma_f32_16x16x32_bf16 v[176:179], v[56:59], a[44:47], v[176:179]
    s_waitcnt lgkmcnt(6)
    v_mov_b32 v7, s3
    v_cndmask_b32 v28, v6, v7, s[36:37]
TICK_9:
    v_mfma_f32_16x16x32_bf16 v[136:139], v[60:63], a[32:35], v[136:139]
    ds_read_b64_tr_b16 v[56:57], v16 offset:45056
    buffer_load_dwordx4 v14, s[12:15], s44 offen offset:2048 lds
    v_mfma_f32_16x16x32_bf16 v[152:155], v[60:63], a[36:39], v[152:155]
    ds_read_b64_tr_b16 v[58:59], v16 offset:45568
    s_sub_u32 s34, s34, s33
    v_mfma_f32_16x16x32_bf16 v[168:171], v[60:63], a[40:43], v[168:171]
    s_lshl_b32 s34, s34, 8
    s_add_u32 s30, s101, s34
    v_lshl_add_u32 v7, v0, 3, s30
    v_mfma_f32_16x16x32_bf16 v[184:187], v[60:63], a[44:47], v[184:187]
    s_waitcnt lgkmcnt(6)
    v_cndmask_b32 v29, v6, v7, vcc
    s_mul_i32 s3, s57, 229376
TICK_10:
    v_mfma_f32_16x16x32_bf16 v[132:135], v[44:47], a[32:35], v[132:135]
    ds_read_b64_tr_b16 v[60:61], v17 offset:36864
    s_lshl_b32 s34, s4, 12
    v_mfma_f32_16x16x32_bf16 v[148:151], v[44:47], a[36:39], v[148:151]
    ds_read_b64_tr_b16 v[62:63], v17 offset:37376
    s_add_u32 s3, s3, s34
    v_mfma_f32_16x16x32_bf16 v[164:167], v[44:47], a[40:43], v[164:167]
    s_mov_b64 exec, 0x2aaa2aaa
    buffer_load_dword v3, v10, s[12:15], 0 offen
    s_mov_b64 exec, -1
    v_mfma_f32_16x16x32_bf16 v[180:183], v[44:47], a[44:47], v[180:183]
    s_waitcnt lgkmcnt(6)
    v_add_u32 v26, s3, v32
    v_xor_b32 v34, 6144, v26
TICK_11:
    v_mfma_f32_16x16x32_bf16 v[140:143], v[48:51], a[32:35], v[140:143]
    ds_read_b64_tr_b16 v[44:45], v17 offset:45056
    buffer_load_dwordx4 v15, s[12:15], s44 offen offset:3072 lds
    v_mfma_f32_16x16x32_bf16 v[156:159], v[48:51], a[36:39], v[156:159]
    ds_read_b64_tr_b16 v[46:47], v17 offset:45568
    s_lshl_b32 s34, s32, 14
    v_mfma_f32_16x16x32_bf16 v[172:175], v[48:51], a[40:43], v[172:175]
    s_add_u32 s56, s3, s34
    s_add_u32 s57, s56, 8192
    s_mov_b32 s60, 0xbfb8aa3b
    v_mfma_f32_16x16x32_bf16 v[188:191], v[48:51], a[44:47], v[188:191]
    s_waitcnt vmcnt(9)
    s_waitcnt lgkmcnt(0)
    s_mov_b32 s61, s60
TICK_12:
    v_mfma_f32_16x16x32_bf16 v[128:131], v[52:55], a[48:51], v[128:131]
    s_barrier
    ds_read_b64_tr_b16 v[48:49], v16 offset:49152
    v_mfma_f32_16x16x32_bf16 v[144:147], v[52:55], a[52:55], v[144:147]
    ds_read_b64_tr_b16 v[50:51], v16 offset:49664
    v_lshrrev_b32 v7, 2, v38
    v_mfma_f32_16x16x32_bf16 v[160:163], v[52:55], a[56:59], v[160:163]
    v_mul_u32_u24 v7, 114688, v7
    v_and_b32 v6, 3, v0
    v_mfma_f32_16x16x32_bf16 v[176:179], v[52:55], a[60:63], v[176:179]
    v_lshl_add_u32 v8, v39, 2, v6
    v_lshl_add_u32 v8, v8, 4, v7
TICK_13:
    v_mfma_f32_16x16x32_bf16 v[136:139], v[56:59], a[48:51], v[136:139]
    ds_read_b64_tr_b16 v[52:53], v16 offset:57344
    s_add_u32 m0, s6, 32768
    v_mfma_f32_16x16x32_bf16 v[152:155], v[56:59], a[52:55], v[152:155]
    ds_read_b64_tr_b16 v[54:55], v16 offset:57856
    buffer_load_dwordx4 v12, s[12:15], s45 offen offset:0 lds
    v_mfma_f32_16x16x32_bf16 v[168:171], v[56:59], a[56:59], v[168:171]
    s_mul_i32 s3, s28, 458752
    s_lshl_b32 s34, s100, 8
    s_add_u32 s3, s3, s34
    v_mfma_f32_16x16x32_bf16 v[184:187], v[56:59], a[60:63], v[184:187]
    buffer_store_dwordx2 v[30:31], v5, s[20:23], 0 offen sc1
TICK_14:
    v_mfma_f32_16x16x32_bf16 v[132:135], v[60:63], a[48:51], v[132:135]
    ds_read_b64_tr_b16 v[56:57], v17 offset:49152
    s_add_u32 s3, s3, 7340032
    v_mfma_f32_16x16x32_bf16 v[148:151], v[60:63], a[52:55], v[148:151]
    ds_read_b64_tr_b16 v[58:59], v17 offset:49664
    v_add_u32 v33, s3, v8
    v_mfma_f32_16x16x32_bf16 v[164:167], v[60:63], a[56:59], v[164:167]
    v_and_b32 v7, 7, v0
    v_mul_u32_u24 v7, 57344, v7
    v_mfma_f32_16x16x32_bf16 v[180:183], v[60:63], a[60:63], v[180:183]
    s_add_u32 s3, s3, 16576
    v_add_u32 v35, s3, v7
TICK_15:
    v_mfma_f32_16x16x32_bf16 v[140:143], v[44:47], a[48:51], v[140:143]
    ds_read_b64_tr_b16 v[60:61], v17 offset:57344
    buffer_load_dwordx4 v13, s[12:15], s45 offen offset:1024 lds
    v_mfma_f32_16x16x32_bf16 v[156:159], v[44:47], a[52:55], v[156:159]
    ds_read_b64_tr_b16 v[62:63], v17 offset:57856
    s_mov_b32 s4, s31
    v_mfma_f32_16x16x32_bf16 v[172:175], v[44:47], a[56:59], v[172:175]
    s_lshl_b32 s31, s28, 10
    s_add_u32 s31, s31, 98304
    s_mul_i32 s3, s29, 1792
    v_mfma_f32_16x16x32_bf16 v[188:191], v[44:47], a[60:63], v[188:191]
    s_waitcnt lgkmcnt(6)
    s_add_u32 s3, s3, 11108352
    v_min_u32 v7, 13, v0
TICK_16:
    v_mfma_f32_16x16x32_bf16 v[128:131], v[48:51], a[64:67], v[128:131]
    ds_read_b64_tr_b16 v[44:45], v16 offset:53248
    v_lshl_add_u32 v27, v7, 7, s3
    v_mfma_f32_16x16x32_bf16 v[144:147], v[48:51], a[68:71], v[144:147]
    ds_read_b64_tr_b16 v[46:47], v16 offset:53760
    s_lshl_b32 s29, s33, 5
    v_mfma_f32_16x16x32_bf16 v[160:163], v[48:51], a[72:75], v[160:163]
    s_add_u32 s29, s29, s39
    v_mfma_f32_16x16x32_bf16 v[176:179], v[48:51], a[76:79], v[176:179]
    s_waitcnt lgkmcnt(6)
TICK_17:
    v_mfma_f32_16x16x32_bf16 v[136:139], v[52:55], a[64:67], v[136:139]
    ds_read_b64_tr_b16 v[48:49], v16 offset:61440
    buffer_load_dwordx4 v14, s[12:15], s45 offen offset:2048 lds
    v_mfma_f32_16x16x32_bf16 v[152:155], v[52:55], a[68:71], v[152:155]
    ds_read_b64_tr_b16 v[50:51], v16 offset:61952
    v_mfma_f32_16x16x32_bf16 v[168:171], v[52:55], a[72:75], v[168:171]
    v_mfma_f32_16x16x32_bf16 v[184:187], v[52:55], a[76:79], v[184:187]
    s_waitcnt lgkmcnt(6)
TICK_18:
    v_mfma_f32_16x16x32_bf16 v[132:135], v[56:59], a[64:67], v[132:135]
    ds_read_b64_tr_b16 v[52:53], v17 offset:53248
    v_mfma_f32_16x16x32_bf16 v[148:151], v[56:59], a[68:71], v[148:151]
    ds_read_b64_tr_b16 v[54:55], v17 offset:53760
    v_mfma_f32_16x16x32_bf16 v[164:167], v[56:59], a[72:75], v[164:167]
    v_mfma_f32_16x16x32_bf16 v[180:183], v[56:59], a[76:79], v[180:183]
    s_waitcnt lgkmcnt(6)
TICK_19:
    v_mfma_f32_16x16x32_bf16 v[140:143], v[60:63], a[64:67], v[140:143]
    ds_read_b64_tr_b16 v[56:57], v17 offset:61440
    buffer_load_dwordx4 v15, s[12:15], s45 offen offset:3072 lds
    v_mfma_f32_16x16x32_bf16 v[156:159], v[60:63], a[68:71], v[156:159]
    ds_read_b64_tr_b16 v[58:59], v17 offset:61952
    v_mfma_f32_16x16x32_bf16 v[172:175], v[60:63], a[72:75], v[172:175]
    v_mfma_f32_16x16x32_bf16 v[188:191], v[60:63], a[76:79], v[188:191]
    s_waitcnt vmcnt(10) lgkmcnt(0)
TICK_20:
    v_mfma_f32_16x16x32_bf16 v[128:131], v[44:47], a[80:83], v[128:131]
    s_barrier
    ds_read_b64_tr_b16 v[60:61], v16 offset:0
    v_mfma_f32_16x16x32_bf16 v[144:147], v[44:47], a[84:87], v[144:147]
    ds_read_b64_tr_b16 v[62:63], v16 offset:512
    s_lshl_b32 s3, s32, 2
    v_mfma_f32_16x16x32_bf16 v[160:163], v[44:47], a[88:91], v[160:163]
    s_add_u32 s3, s3, s28
    s_lshl_b32 s3, s3, 4
    v_mfma_f32_16x16x32_bf16 v[176:179], v[44:47], a[92:95], v[176:179]
TICK_21:
    v_mfma_f32_16x16x32_bf16 v[136:139], v[48:51], a[80:83], v[136:139]
    ds_read_b64_tr_b16 v[44:45], v16 offset:8192
    s_add_u32 m0, s6, 49152
    v_mfma_f32_16x16x32_bf16 v[152:155], v[48:51], a[84:87], v[152:155]
    ds_read_b64_tr_b16 v[46:47], v16 offset:8704
    buffer_load_dwordx4 v12, s[12:15], s46 offen offset:0 lds
    v_mfma_f32_16x16x32_bf16 v[168:171], v[48:51], a[88:91], v[168:171]
    v_add_u32 v216, s3, v38
    v_cvt_f32_u32 v216, v216
    v_mfma_f32_16x16x32_bf16 v[184:187], v[48:51], a[92:95], v[184:187]
    v_mul_f32 v214, 0x3b124925, v216
TICK_22:
    v_mfma_f32_16x16x32_bf16 v[132:135], v[52:55], a[80:83], v[132:135]
    ds_read_b64_tr_b16 v[48:49], v17 offset:0
    v_mul_f32 v215, 0x3c800000, v216
    v_mfma_f32_16x16x32_bf16 v[148:151], v[52:55], a[84:87], v[148:151]
    ds_read_b64_tr_b16 v[50:51], v17 offset:512
    v_mfma_f32_16x16x32_bf16 v[164:167], v[52:55], a[88:91], v[164:167]
    s_mov_b64 exec, 0x3fff
    buffer_load_dword v2, v9, s[16:19], 0 offen
    s_mov_b64 exec, -1
    v_mfma_f32_16x16x32_bf16 v[180:183], v[52:55], a[92:95], v[180:183]
    v_cos_f32 v208, v214
TICK_23:
    v_mfma_f32_16x16x32_bf16 v[140:143], v[56:59], a[80:83], v[140:143]
    ds_read_b64_tr_b16 v[52:53], v17 offset:8192
    buffer_load_dwordx4 v13, s[12:15], s46 offen offset:1024 lds
    v_mfma_f32_16x16x32_bf16 v[156:159], v[56:59], a[84:87], v[156:159]
    ds_read_b64_tr_b16 v[54:55], v17 offset:8704
    v_mfma_f32_16x16x32_bf16 v[172:175], v[56:59], a[88:91], v[172:175]
    v_sin_f32 v210, v214
    v_mfma_f32_16x16x32_bf16 v[188:191], v[56:59], a[92:95], v[188:191]
    s_waitcnt lgkmcnt(6)
    v_mul_u32_u24 v216, 28, v39
    v_cvt_f32_u32 v216, v216
TICK_24:
    v_mfma_f32_16x16x32_bf16 v[128:131], v[60:63], a[96:99], v[128:131]
    ds_read_b64_tr_b16 v[56:57], v16 offset:4096
    v_add_f32 v212, v208, v208
    v_mfma_f32_16x16x32_bf16 v[144:147], v[60:63], a[100:103], v[144:147]
    ds_read_b64_tr_b16 v[58:59], v16 offset:4608
    v_lshlrev_b32 v217, 31, v0
    v_mfma_f32_16x16x32_bf16 v[160:163], v[60:63], a[104:107], v[160:163]
    v_xor_b32 v217, 0xbf800000, v217
    v_mfma_f32_16x16x32_bf16 v[176:179], v[60:63], a[108:111], v[176:179]
    s_waitcnt lgkmcnt(6)
TICK_25:
    v_mfma_f32_16x16x32_bf16 v[136:139], v[44:47], a[96:99], v[136:139]
    ds_read_b64_tr_b16 v[60:61], v16 offset:12288
    buffer_load_dwordx4 v14, s[12:15], s46 offen offset:2048 lds
    v_mfma_f32_16x16x32_bf16 v[152:155], v[44:47], a[100:103], v[152:155]
    ds_read_b64_tr_b16 v[62:63], v16 offset:12800
    s_mov_b64 s[0:1], 0xffff
    v_mfma_f32_16x16x32_bf16 v[168:171], v[44:47], a[104:107], v[168:171]
    v_mul_f32 v196, v216, v214
    v_add_f32 v197, v196, v215
    v_mfma_f32_16x16x32_bf16 v[184:187], v[44:47], a[108:111], v[184:187]
    s_waitcnt lgkmcnt(6)
TICK_26:
    v_mfma_f32_16x16x32_bf16 v[132:135], v[48:51], a[96:99], v[132:135]
    ds_read_b64_tr_b16 v[44:45], v17 offset:4096
    v_fma_f32 v198, 2.0, v215, v196
    v_mfma_f32_16x16x32_bf16 v[148:151], v[48:51], a[100:103], v[148:151]
    ds_read_b64_tr_b16 v[46:47], v17 offset:4608
    v_add_f32 v199, v198, v215
    v_mfma_f32_16x16x32_bf16 v[164:167], v[48:51], a[104:107], v[164:167]
    v_cos_f32 v192, v196
    v_mfma_f32_16x16x32_bf16 v[180:183], v[48:51], a[108:111], v[180:183]
    s_waitcnt lgkmcnt(6)
TICK_27:
    v_mfma_f32_16x16x32_bf16 v[140:143], v[52:55], a[96:99], v[140:143]
    ds_read_b64_tr_b16 v[48:49], v17 offset:12288
    buffer_load_dwordx4 v15, s[12:15], s46 offen offset:3072 lds
    v_mfma_f32_16x16x32_bf16 v[156:159], v[52:55], a[100:103], v[156:159]
    ds_read_b64_tr_b16 v[50:51], v17 offset:12800
    v_mfma_f32_16x16x32_bf16 v[172:175], v[52:55], a[104:107], v[172:175]
    v_sin_f32 v196, v196
    v_mfma_f32_16x16x32_bf16 v[188:191], v[52:55], a[108:111], v[188:191]
    s_waitcnt vmcnt(10) lgkmcnt(0)
    v_cos_f32 v193, v197
TICK_28:
    v_mfma_f32_16x16x32_bf16 v[128:131], v[56:59], a[112:115], v[128:131]
    s_barrier
    ds_read_b64_tr_b16 v[52:53], v16 offset:16384
    v_mfma_f32_16x16x32_bf16 v[144:147], v[56:59], a[116:119], v[144:147]
    ds_read_b64_tr_b16 v[54:55], v16 offset:16896
    v_mfma_f32_16x16x32_bf16 v[160:163], v[56:59], a[120:123], v[160:163]
    v_sin_f32 v197, v197
    v_mfma_f32_16x16x32_bf16 v[176:179], v[56:59], a[124:127], v[176:179]
    v_cos_f32 v194, v198
TICK_29:
    v_mfma_f32_16x16x32_bf16 v[136:139], v[60:63], a[112:115], v[136:139]
    ds_read_b64_tr_b16 v[56:57], v16 offset:24576
    s_add_u32 m0, s6, 0
    v_mfma_f32_16x16x32_bf16 v[152:155], v[60:63], a[116:119], v[152:155]
    ds_read_b64_tr_b16 v[58:59], v16 offset:25088
    buffer_load_dwordx4 v12, s[12:15], s47 offen offset:0 lds
    v_mfma_f32_16x16x32_bf16 v[168:171], v[60:63], a[120:123], v[168:171]
    v_sin_f32 v198, v198
    v_mfma_f32_16x16x32_bf16 v[184:187], v[60:63], a[124:127], v[184:187]
    v_cos_f32 v195, v199
TICK_30:
    v_mfma_f32_16x16x32_bf16 v[132:135], v[44:47], a[112:115], v[132:135]
    ds_read_b64_tr_b16 v[60:61], v17 offset:16384
    v_mfma_f32_16x16x32_bf16 v[148:151], v[44:47], a[116:119], v[148:151]
    ds_read_b64_tr_b16 v[62:63], v17 offset:16896
    v_mfma_f32_16x16x32_bf16 v[164:167], v[44:47], a[120:123], v[164:167]
    v_sin_f32 v199, v199
    v_mfma_f32_16x16x32_bf16 v[180:183], v[44:47], a[124:127], v[180:183]
    v_cndmask_b32 v218, v196, v217, s[0:1]
    v_cvt_pk_bf16_f32 v64, v192, v193
TICK_31:
    v_mfma_f32_16x16x32_bf16 v[140:143], v[48:51], a[112:115], v[140:143]
    ds_read_b64_tr_b16 v[44:45], v17 offset:24576
    buffer_load_dwordx4 v13, s[12:15], s47 offen offset:1024 lds
    v_mfma_f32_16x16x32_bf16 v[156:159], v[48:51], a[116:119], v[156:159]
    ds_read_b64_tr_b16 v[46:47], v17 offset:25088
    v_cvt_pk_bf16_f32 v65, v194, v195
    v_mfma_f32_16x16x32_bf16 v[172:175], v[48:51], a[120:123], v[172:175]
    v_cvt_pk_bf16_f32 v66, -v218, -v197
    v_cvt_pk_bf16_f32 v67, -v198, -v199
    v_mfma_f32_16x16x32_bf16 v[188:191], v[48:51], a[124:127], v[188:191]
    s_waitcnt lgkmcnt(6)
TICK_32:
    v_mfma_f32_16x16x32_bf16 v[128:131], v[52:55], a[128:131], v[128:131]
    ds_read_b64_tr_b16 v[48:49], v16 offset:20480
    v_mul_f32 v200, v208, v192
    v_mfma_f32_16x16x32_bf16 v[144:147], v[52:55], a[132:135], v[144:147]
    ds_read_b64_tr_b16 v[50:51], v16 offset:20992
    v_mul_f32 v201, v208, v193
    v_mfma_f32_16x16x32_bf16 v[160:163], v[52:55], a[136:139], v[160:163]
    v_mul_f32 v204, v208, v196
    v_mfma_f32_16x16x32_bf16 v[176:179], v[52:55], a[140:143], v[176:179]
    s_waitcnt lgkmcnt(6)
TICK_33:
    v_mfma_f32_16x16x32_bf16 v[136:139], v[56:59], a[128:131], v[136:139]
    ds_read_b64_tr_b16 v[52:53], v16 offset:28672
    buffer_load_dwordx4 v14, s[12:15], s47 offen offset:2048 lds
    v_mfma_f32_16x16x32_bf16 v[152:155], v[56:59], a[132:135], v[152:155]
    ds_read_b64_tr_b16 v[54:55], v16 offset:29184
    v_mul_f32 v205, v208, v197
    v_mfma_f32_16x16x32_bf16 v[168:171], v[56:59], a[136:139], v[168:171]
    v_mul_f32 v202, v208, v194
    v_mul_f32 v203, v208, v195
    v_mfma_f32_16x16x32_bf16 v[184:187], v[56:59], a[140:143], v[184:187]
    s_waitcnt lgkmcnt(6)
TICK_34:
    v_mfma_f32_16x16x32_bf16 v[132:135], v[60:63], a[128:131], v[132:135]
    ds_read_b64_tr_b16 v[56:57], v17 offset:20480
    v_mul_f32 v206, v208, v198
    v_mfma_f32_16x16x32_bf16 v[148:151], v[60:63], a[132:135], v[148:151]
    ds_read_b64_tr_b16 v[58:59], v17 offset:20992
    v_mul_f32 v207, v208, v199
    v_mfma_f32_16x16x32_bf16 v[164:167], v[60:63], a[136:139], v[164:167]
    v_fma_f32 v200, -v210, v196, v200
    v_mfma_f32_16x16x32_bf16 v[180:183], v[60:63], a[140:143], v[180:183]
    s_waitcnt lgkmcnt(6)
TICK_35:
    v_mfma_f32_16x16x32_bf16 v[140:143], v[44:47], a[128:131], v[140:143]
    ds_read_b64_tr_b16 v[60:61], v17 offset:28672
    buffer_load_dwordx4 v15, s[12:15], s47 offen offset:3072 lds
    v_mfma_f32_16x16x32_bf16 v[156:159], v[44:47], a[132:135], v[156:159]
    ds_read_b64_tr_b16 v[62:63], v17 offset:29184
    v_fma_f32 v201, -v210, v197, v201
    v_mfma_f32_16x16x32_bf16 v[172:175], v[44:47], a[136:139], v[172:175]
    v_fma_f32 v204, v210, v192, v204
    v_fma_f32 v205, v210, v193, v205
    v_mfma_f32_16x16x32_bf16 v[188:191], v[44:47], a[140:143], v[188:191]
    s_waitcnt vmcnt(9) lgkmcnt(0)
TICK_36:
    v_mfma_f32_16x16x32_bf16 v[128:131], v[48:51], a[144:147], v[128:131]
    s_barrier
    ds_read_b64_tr_b16 v[44:45], v16 offset:32768
    v_mfma_f32_16x16x32_bf16 v[144:147], v[48:51], a[148:151], v[144:147]
    ds_read_b64_tr_b16 v[46:47], v16 offset:33280
    v_fma_f32 v202, -v210, v198, v202
    v_mfma_f32_16x16x32_bf16 v[160:163], v[48:51], a[152:155], v[160:163]
    v_fma_f32 v203, -v210, v199, v203
    v_fma_f32 v206, v210, v194, v206
    v_mfma_f32_16x16x32_bf16 v[176:179], v[48:51], a[156:159], v[176:179]
TICK_37:
    v_mfma_f32_16x16x32_bf16 v[136:139], v[52:55], a[144:147], v[136:139]
    ds_read_b64_tr_b16 v[48:49], v16 offset:40960
    s_add_u32 m0, s6, 16384
    v_mfma_f32_16x16x32_bf16 v[152:155], v[52:55], a[148:151], v[152:155]
    ds_read_b64_tr_b16 v[50:51], v16 offset:41472
    buffer_load_dwordx4 v12, s[12:15], s48 offen offset:0 lds
    v_mfma_f32_16x16x32_bf16 v[168:171], v[52:55], a[152:155], v[168:171]
    v_fma_f32 v207, v210, v195, v207
    v_cvt_pk_bf16_f32 v68, v200, v201
    v_mfma_f32_16x16x32_bf16 v[184:187], v[52:55], a[156:159], v[184:187]
    v_cvt_pk_bf16_f32 v69, v202, v203
TICK_38:
    v_mfma_f32_16x16x32_bf16 v[132:135], v[56:59], a[144:147], v[132:135]
    ds_read_b64_tr_b16 v[52:53], v17 offset:32768
    v_cvt_pk_bf16_f32 v70, -v204, -v205
    v_mfma_f32_16x16x32_bf16 v[148:151], v[56:59], a[148:151], v[148:151]
    ds_read_b64_tr_b16 v[54:55], v17 offset:33280
    v_cvt_pk_bf16_f32 v71, -v206, -v207
    v_mfma_f32_16x16x32_bf16 v[164:167], v[56:59], a[152:155], v[164:167]
    v_fma_f32 v192, v212, v200, -v192
    v_mfma_f32_16x16x32_bf16 v[180:183], v[56:59], a[156:159], v[180:183]
TICK_39:
    v_mfma_f32_16x16x32_bf16 v[140:143], v[60:63], a[144:147], v[140:143]
    ds_read_b64_tr_b16 v[56:57], v17 offset:40960
    buffer_load_dwordx4 v13, s[12:15], s48 offen offset:1024 lds
    v_mfma_f32_16x16x32_bf16 v[156:159], v[60:63], a[148:151], v[156:159]
    ds_read_b64_tr_b16 v[58:59], v17 offset:41472
    v_fma_f32 v193, v212, v201, -v193
    v_mfma_f32_16x16x32_bf16 v[172:175], v[60:63], a[152:155], v[172:175]
    v_fma_f32 v194, v212, v202, -v194
    v_fma_f32 v195, v212, v203, -v195
    v_mfma_f32_16x16x32_bf16 v[188:191], v[60:63], a[156:159], v[188:191]
    s_waitcnt lgkmcnt(6)
TICK_40:
    v_mfma_f32_16x16x32_bf16 v[128:131], v[44:47], a[160:163], v[128:131]
    ds_read_b64_tr_b16 v[60:61], v16 offset:36864
    s_add_u32 m0, s62, 0
    v_mfma_f32_16x16x32_bf16 v[144:147], v[44:47], a[164:167], v[144:147]
    ds_read_b64_tr_b16 v[62:63], v16 offset:37376
    s_sub_u32 s7, s66, s65
    v_mfma_f32_16x16x32_bf16 v[160:163], v[44:47], a[168:171], v[160:163]
    s_mul_i32 s7, s7, s63
    s_add_u32 s7, s7, s65
    s_mul_i32 s7, s7, 7
    v_mfma_f32_16x16x32_bf16 v[176:179], v[44:47], a[172:175], v[176:179]
    buffer_load_dwordx4 v18, s[16:19], s7 offen offset:0 lds
    s_waitcnt lgkmcnt(6)
TICK_41:
    v_mfma_f32_16x16x32_bf16 v[136:139], v[48:51], a[160:163], v[136:139]
    ds_read_b64_tr_b16 v[44:45], v16 offset:45056
    s_add_u32 m0, s6, 16384
    v_mfma_f32_16x16x32_bf16 v[152:155], v[48:51], a[164:167], v[152:155]
    ds_read_b64_tr_b16 v[46:47], v16 offset:45568
    buffer_load_dwordx4 v14, s[12:15], s48 offen offset:2048 lds
    v_mfma_f32_16x16x32_bf16 v[168:171], v[48:51], a[168:171], v[168:171]
    v_fma_f32 v196, v212, v204, -v196
    v_fma_f32 v197, v212, v205, -v197
    v_mfma_f32_16x16x32_bf16 v[184:187], v[48:51], a[172:175], v[184:187]
    s_waitcnt lgkmcnt(6)
    v_fma_f32 v198, v212, v206, -v198
TICK_42:
    v_mfma_f32_16x16x32_bf16 v[132:135], v[52:55], a[160:163], v[132:135]
    ds_read_b64_tr_b16 v[48:49], v17 offset:36864
    s_add_u32 m0, s62, 0
    v_mfma_f32_16x16x32_bf16 v[148:151], v[52:55], a[164:167], v[148:151]
    ds_read_b64_tr_b16 v[50:51], v17 offset:37376
    buffer_load_dwordx4 v19, s[16:19], s7 offen offset:1024 lds
    v_mfma_f32_16x16x32_bf16 v[164:167], v[52:55], a[168:171], v[164:167]
    v_fma_f32 v199, v212, v207, -v199
    v_cvt_pk_bf16_f32 v72, v192, v193
    v_mfma_f32_16x16x32_bf16 v[180:183], v[52:55], a[172:175], v[180:183]
    s_waitcnt lgkmcnt(6)
    v_cvt_pk_bf16_f32 v73, v194, v195
TICK_43:
    v_mfma_f32_16x16x32_bf16 v[140:143], v[56:59], a[160:163], v[140:143]
    ds_read_b64_tr_b16 v[52:53], v17 offset:45056
    s_add_u32 m0, s6, 16384
    v_mfma_f32_16x16x32_bf16 v[156:159], v[56:59], a[164:167], v[156:159]
    ds_read_b64_tr_b16 v[54:55], v17 offset:45568
    buffer_load_dwordx4 v15, s[12:15], s48 offen offset:3072 lds
    v_mfma_f32_16x16x32_bf16 v[172:175], v[56:59], a[168:171], v[172:175]
    v_cvt_pk_bf16_f32 v74, -v196, -v197
    v_cvt_pk_bf16_f32 v75, -v198, -v199
    v_mfma_f32_16x16x32_bf16 v[188:191], v[56:59], a[172:175], v[188:191]
    s_waitcnt vmcnt(10) lgkmcnt(0)
    v_fma_f32 v200, v212, v192, -v200
TICK_44:
    v_mfma_f32_16x16x32_bf16 v[128:131], v[60:63], a[176:179], v[128:131]
    s_barrier
    ds_read_b64_tr_b16 v[56:57], v16 offset:49152
    v_mfma_f32_16x16x32_bf16 v[144:147], v[60:63], a[180:183], v[144:147]
    ds_read_b64_tr_b16 v[58:59], v16 offset:49664
    s_add_u32 m0, s62, 0
    v_mfma_f32_16x16x32_bf16 v[160:163], v[60:63], a[184:187], v[160:163]
    buffer_load_dwordx4 v20, s[16:19], s7 offen offset:2048 lds
    v_fma_f32 v201, v212, v193, -v201
    v_mfma_f32_16x16x32_bf16 v[176:179], v[60:63], a[188:191], v[176:179]
    v_fma_f32 v202, v212, v194, -v202
    v_fma_f32 v203, v212, v195, -v203
TICK_45:
    v_mfma_f32_16x16x32_bf16 v[136:139], v[44:47], a[176:179], v[136:139]
    ds_read_b64_tr_b16 v[60:61], v16 offset:57344
    s_add_u32 m0, s6, 32768
    v_mfma_f32_16x16x32_bf16 v[152:155], v[44:47], a[180:183], v[152:155]
    ds_read_b64_tr_b16 v[62:63], v16 offset:57856
    buffer_load_dwordx4 v12, s[12:15], s49 offen offset:0 lds
    v_mfma_f32_16x16x32_bf16 v[168:171], v[44:47], a[184:187], v[168:171]
    v_fma_f32 v204, v212, v196, -v204
    v_fma_f32 v205, v212, v197, -v205
    v_mfma_f32_16x16x32_bf16 v[184:187], v[44:47], a[188:191], v[184:187]
    v_fma_f32 v206, v212, v198, -v206
TICK_46:
    v_mfma_f32_16x16x32_bf16 v[132:135], v[48:51], a[176:179], v[132:135]
    ds_read_b64_tr_b16 v[44:45], v17 offset:49152
    s_add_u32 m0, s62, 0
    v_mfma_f32_16x16x32_bf16 v[148:151], v[48:51], a[180:183], v[148:151]
    ds_read_b64_tr_b16 v[46:47], v17 offset:49664
    buffer_load_dwordx4 v21, s[16:19], s7 offen offset:3072 lds
    v_mfma_f32_16x16x32_bf16 v[164:167], v[48:51], a[184:187], v[164:167]
    v_fma_f32 v207, v212, v199, -v207
    v_cvt_pk_bf16_f32 v76, v200, v201
    v_mfma_f32_16x16x32_bf16 v[180:183], v[48:51], a[188:191], v[180:183]
    v_cvt_pk_bf16_f32 v77, v202, v203
TICK_47:
    v_mfma_f32_16x16x32_bf16 v[140:143], v[52:55], a[176:179], v[140:143]
    ds_read_b64_tr_b16 v[48:49], v17 offset:57344
    s_add_u32 m0, s6, 32768
    v_mfma_f32_16x16x32_bf16 v[156:159], v[52:55], a[180:183], v[156:159]
    ds_read_b64_tr_b16 v[50:51], v17 offset:57856
    buffer_load_dwordx4 v13, s[12:15], s49 offen offset:1024 lds
    v_mfma_f32_16x16x32_bf16 v[172:175], v[52:55], a[184:187], v[172:175]
    v_cvt_pk_bf16_f32 v78, -v204, -v205
    v_cvt_pk_bf16_f32 v79, -v206, -v207
    v_mfma_f32_16x16x32_bf16 v[188:191], v[52:55], a[188:191], v[188:191]
    s_waitcnt lgkmcnt(6)
    v_fma_f32 v192, v212, v200, -v192
TICK_48:
    v_mfma_f32_16x16x32_bf16 v[128:131], v[56:59], a[192:195], v[128:131]
    ds_read_b64_tr_b16 v[52:53], v16 offset:53248
    s_add_u32 m0, s62, 16384
    v_mfma_f32_16x16x32_bf16 v[144:147], v[56:59], a[196:199], v[144:147]
    ds_read_b64_tr_b16 v[54:55], v16 offset:53760
    s_sub_u32 s7, s68, s67
    v_mfma_f32_16x16x32_bf16 v[160:163], v[56:59], a[200:203], v[160:163]
    s_mul_i32 s7, s7, s63
    s_add_u32 s7, s7, s67
    s_mul_i32 s7, s7, 7
    v_mfma_f32_16x16x32_bf16 v[176:179], v[56:59], a[204:207], v[176:179]
    buffer_load_dwordx4 v18, s[16:19], s7 offen offset:0 lds
    s_waitcnt lgkmcnt(6)
TICK_49:
    v_mfma_f32_16x16x32_bf16 v[136:139], v[60:63], a[192:195], v[136:139]
    ds_read_b64_tr_b16 v[56:57], v16 offset:61440
    s_add_u32 m0, s6, 32768
    v_mfma_f32_16x16x32_bf16 v[152:155], v[60:63], a[196:199], v[152:155]
    ds_read_b64_tr_b16 v[58:59], v16 offset:61952
    buffer_load_dwordx4 v14, s[12:15], s49 offen offset:2048 lds
    v_mfma_f32_16x16x32_bf16 v[168:171], v[60:63], a[200:203], v[168:171]
    v_fma_f32 v193, v212, v201, -v193
    v_fma_f32 v194, v212, v202, -v194
    v_mfma_f32_16x16x32_bf16 v[184:187], v[60:63], a[204:207], v[184:187]
    s_waitcnt lgkmcnt(6)
    v_fma_f32 v195, v212, v203, -v195
TICK_50:
    v_mfma_f32_16x16x32_bf16 v[132:135], v[44:47], a[192:195], v[132:135]
    ds_read_b64_tr_b16 v[60:61], v17 offset:53248
    s_add_u32 m0, s62, 16384
    v_mfma_f32_16x16x32_bf16 v[148:151], v[44:47], a[196:199], v[148:151]
    ds_read_b64_tr_b16 v[62:63], v17 offset:53760
    buffer_load_dwordx4 v19, s[16:19], s7 offen offset:1024 lds
    v_mfma_f32_16x16x32_bf16 v[164:167], v[44:47], a[200:203], v[164:167]
    v_fma_f32 v196, v212, v204, -v196
    v_fma_f32 v197, v212, v205, -v197
    v_mfma_f32_16x16x32_bf16 v[180:183], v[44:47], a[204:207], v[180:183]
    s_waitcnt lgkmcnt(6)
    v_fma_f32 v198, v212, v206, -v198
TICK_51:
    v_mfma_f32_16x16x32_bf16 v[140:143], v[48:51], a[192:195], v[140:143]
    ds_read_b64_tr_b16 v[44:45], v17 offset:61440
    s_add_u32 m0, s6, 32768
    v_mfma_f32_16x16x32_bf16 v[156:159], v[48:51], a[196:199], v[156:159]
    ds_read_b64_tr_b16 v[46:47], v17 offset:61952
    buffer_load_dwordx4 v15, s[12:15], s49 offen offset:3072 lds
    v_mfma_f32_16x16x32_bf16 v[172:175], v[48:51], a[200:203], v[172:175]
    v_fma_f32 v199, v212, v207, -v199
    v_cvt_pk_bf16_f32 v80, v192, v193
    v_mfma_f32_16x16x32_bf16 v[188:191], v[48:51], a[204:207], v[188:191]
    s_waitcnt vmcnt(14) lgkmcnt(0)
    v_cvt_pk_bf16_f32 v81, v194, v195
TICK_52:
    v_mfma_f32_16x16x32_bf16 v[128:131], v[52:55], a[208:211], v[128:131]
    s_barrier
    ds_read_b64_tr_b16 v[48:49], v16 offset:0
    v_mfma_f32_16x16x32_bf16 v[144:147], v[52:55], a[212:215], v[144:147]
    ds_read_b64_tr_b16 v[50:51], v16 offset:512
    buffer_load_dword v36, v27, s[20:23], 0 offen sc1
    v_mfma_f32_16x16x32_bf16 v[160:163], v[52:55], a[216:219], v[160:163]
    v_cvt_pk_bf16_f32 v82, -v196, -v197
    v_cvt_pk_bf16_f32 v83, -v198, -v199
    v_mfma_f32_16x16x32_bf16 v[176:179], v[52:55], a[220:223], v[176:179]
    v_fma_f32 v200, v212, v192, -v200
TICK_53:
    v_mfma_f32_16x16x32_bf16 v[136:139], v[56:59], a[208:211], v[136:139]
    ds_read_b64_tr_b16 v[52:53], v16 offset:8192
    s_add_u32 m0, s6, 49152
    v_mfma_f32_16x16x32_bf16 v[152:155], v[56:59], a[212:215], v[152:155]
    ds_read_b64_tr_b16 v[54:55], v16 offset:8704
    buffer_load_dwordx4 v12, s[12:15], s50 offen offset:0 lds
    v_mfma_f32_16x16x32_bf16 v[168:171], v[56:59], a[216:219], v[168:171]
    v_fma_f32 v201, v212, v193, -v201
    v_fma_f32 v202, v212, v194, -v202
    v_mfma_f32_16x16x32_bf16 v[184:187], v[56:59], a[220:223], v[184:187]
    v_fma_f32 v203, v212, v195, -v203
TICK_54:
    v_mfma_f32_16x16x32_bf16 v[132:135], v[60:63], a[208:211], v[132:135]
    ds_read_b64_tr_b16 v[56:57], v17 offset:0
    buffer_load_dwordx4 v13, s[12:15], s50 offen offset:1024 lds
    v_mfma_f32_16x16x32_bf16 v[148:151], v[60:63], a[212:215], v[148:151]
    ds_read_b64_tr_b16 v[58:59], v17 offset:512
    v_fma_f32 v204, v212, v196, -v204
    v_mfma_f32_16x16x32_bf16 v[164:167], v[60:63], a[216:219], v[164:167]
    v_fma_f32 v205, v212, v197, -v205
    v_fma_f32 v206, v212, v198, -v206
    v_mfma_f32_16x16x32_bf16 v[180:183], v[60:63], a[220:223], v[180:183]
TICK_55:
    v_mfma_f32_16x16x32_bf16 v[140:143], v[44:47], a[208:211], v[140:143]
    ds_read_b64_tr_b16 v[60:61], v17 offset:8192
    buffer_load_dwordx4 v14, s[12:15], s50 offen offset:2048 lds
    v_mfma_f32_16x16x32_bf16 v[156:159], v[44:47], a[212:215], v[156:159]
    ds_read_b64_tr_b16 v[62:63], v17 offset:8704
    v_fma_f32 v207, v212, v199, -v207
    v_mfma_f32_16x16x32_bf16 v[172:175], v[44:47], a[216:219], v[172:175]
    v_cvt_pk_bf16_f32 v84, v200, v201
    v_cvt_pk_bf16_f32 v85, v202, v203
    v_mfma_f32_16x16x32_bf16 v[188:191], v[44:47], a[220:223], v[188:191]
    s_waitcnt lgkmcnt(6)
    buffer_load_dwordx4 v15, s[12:15], s50 offen offset:3072 lds
    v_pk_mul_f32 v[4:5], s[60:61], v[128:129]
    v_pk_mul_f32 v[6:7], s[60:61], v[130:131]
    v_pk_mul_f32 v[8:9], s[60:61], v[132:133]
    v_pk_mul_f32 v[10:11], s[60:61], v[134:135]
    s_add_u32 m0, s62, 16384
    s_nop 0
    buffer_load_dwordx4 v20, s[16:19], s7 offen offset:2048 lds
    v_exp_f32 v4, v4
    v_exp_f32 v5, v5
    v_exp_f32 v6, v6
    v_exp_f32 v7, v7
    v_exp_f32 v8, v8
    v_exp_f32 v9, v9
    v_exp_f32 v10, v10
    v_exp_f32 v11, v11
    v_pk_mul_f32 v[128:129], v[128:129], v[136:137]
    v_pk_mul_f32 v[130:131], v[130:131], v[138:139]
    v_pk_mul_f32 v[132:133], v[132:133], v[140:141]
    v_pk_mul_f32 v[134:135], v[134:135], v[142:143]
    v_pk_add_f32 v[4:5], v[4:5], 1.0 op_sel_hi:[1,0]
    v_pk_add_f32 v[6:7], v[6:7], 1.0 op_sel_hi:[1,0]
    v_pk_add_f32 v[8:9], v[8:9], 1.0 op_sel_hi:[1,0]
    v_pk_add_f32 v[10:11], v[10:11], 1.0 op_sel_hi:[1,0]
    v_rcp_f32 v4, v4
    v_rcp_f32 v5, v5
    v_rcp_f32 v6, v6
    v_rcp_f32 v7, v7
    v_rcp_f32 v8, v8
    v_rcp_f32 v9, v9
    v_rcp_f32 v10, v10
    v_rcp_f32 v11, v11
    v_pk_mul_f32 v[128:129], v[128:129], v[4:5]
    v_pk_mul_f32 v[130:131], v[130:131], v[6:7]
    v_pk_mul_f32 v[132:133], v[132:133], v[8:9]
    v_pk_mul_f32 v[134:135], v[134:135], v[10:11]
    v_cvt_pk_bf16_f32 v240, v128, v129
    v_cvt_pk_bf16_f32 v241, v130, v131
    v_cvt_pk_bf16_f32 v242, v132, v133
    v_cvt_pk_bf16_f32 v243, v134, v135
    buffer_store_dwordx4 v[240:243], v32, s[20:23], s56 offen offset:0 sc1
    buffer_store_dwordx4 v[236:239], v32, s[20:23], s59 offen offset:0 sc1
    v_pk_mul_f32 v[4:5], s[60:61], v[144:145]
    v_pk_mul_f32 v[6:7], s[60:61], v[146:147]
    v_pk_mul_f32 v[8:9], s[60:61], v[148:149]
    v_pk_mul_f32 v[10:11], s[60:61], v[150:151]
    v_exp_f32 v4, v4
    v_exp_f32 v5, v5
    v_exp_f32 v6, v6
    v_exp_f32 v7, v7
    v_exp_f32 v8, v8
    v_exp_f32 v9, v9
    v_exp_f32 v10, v10
    v_exp_f32 v11, v11
    v_pk_mul_f32 v[144:145], v[144:145], v[152:153]
    v_pk_mul_f32 v[146:147], v[146:147], v[154:155]
    v_pk_mul_f32 v[148:149], v[148:149], v[156:157]
    v_pk_mul_f32 v[150:151], v[150:151], v[158:159]
    v_pk_add_f32 v[4:5], v[4:5], 1.0 op_sel_hi:[1,0]
    v_pk_add_f32 v[6:7], v[6:7], 1.0 op_sel_hi:[1,0]
    v_pk_add_f32 v[8:9], v[8:9], 1.0 op_sel_hi:[1,0]
    v_pk_add_f32 v[10:11], v[10:11], 1.0 op_sel_hi:[1,0]
    v_rcp_f32 v4, v4
    v_rcp_f32 v5, v5
    v_rcp_f32 v6, v6
    v_rcp_f32 v7, v7
    v_rcp_f32 v8, v8
    v_rcp_f32 v9, v9
    v_rcp_f32 v10, v10
    v_rcp_f32 v11, v11
    v_pk_mul_f32 v[144:145], v[144:145], v[4:5]
    v_pk_mul_f32 v[146:147], v[146:147], v[6:7]
    v_pk_mul_f32 v[148:149], v[148:149], v[8:9]
    v_pk_mul_f32 v[150:151], v[150:151], v[10:11]
    v_cvt_pk_bf16_f32 v244, v144, v145
    v_cvt_pk_bf16_f32 v245, v146, v147
    v_cvt_pk_bf16_f32 v246, v148, v149
    v_cvt_pk_bf16_f32 v247, v150, v151
    buffer_store_dwordx4 v[244:247], v32, s[20:23], s56 offen offset:1024 sc1
    buffer_store_dwordx4 v[236:239], v32, s[20:23], s59 offen offset:1024 sc1
    v_pk_mul_f32 v[4:5], s[60:61], v[160:161]
    v_pk_mul_f32 v[6:7], s[60:61], v[162:163]
    v_pk_mul_f32 v[8:9], s[60:61], v[164:165]
    v_pk_mul_f32 v[10:11], s[60:61], v[166:167]
    buffer_load_dwordx4 v21, s[16:19], s7 offen offset:3072 lds
    v_exp_f32 v4, v4
    v_exp_f32 v5, v5
    v_exp_f32 v6, v6
    v_exp_f32 v7, v7
    v_exp_f32 v8, v8
    v_exp_f32 v9, v9
    v_exp_f32 v10, v10
    v_exp_f32 v11, v11
    v_pk_mul_f32 v[160:161], v[160:161], v[168:169]
    v_pk_mul_f32 v[162:163], v[162:163], v[170:171]
    v_pk_mul_f32 v[164:165], v[164:165], v[172:173]
    v_pk_mul_f32 v[166:167], v[166:167], v[174:175]
    v_pk_add_f32 v[4:5], v[4:5], 1.0 op_sel_hi:[1,0]
    v_pk_add_f32 v[6:7], v[6:7], 1.0 op_sel_hi:[1,0]
    v_pk_add_f32 v[8:9], v[8:9], 1.0 op_sel_hi:[1,0]
    v_pk_add_f32 v[10:11], v[10:11], 1.0 op_sel_hi:[1,0]
    v_rcp_f32 v4, v4
    v_rcp_f32 v5, v5
    v_rcp_f32 v6, v6
    v_rcp_f32 v7, v7
    v_rcp_f32 v8, v8
    v_rcp_f32 v9, v9
    v_rcp_f32 v10, v10
    v_rcp_f32 v11, v11
    v_pk_mul_f32 v[160:161], v[160:161], v[4:5]
    v_pk_mul_f32 v[162:163], v[162:163], v[6:7]
    v_pk_mul_f32 v[164:165], v[164:165], v[8:9]
    v_pk_mul_f32 v[166:167], v[166:167], v[10:11]
    v_cvt_pk_bf16_f32 v248, v160, v161
    v_cvt_pk_bf16_f32 v249, v162, v163
    v_cvt_pk_bf16_f32 v250, v164, v165
    v_cvt_pk_bf16_f32 v251, v166, v167
    buffer_store_dwordx4 v[248:251], v32, s[20:23], s56 offen offset:2048 sc1
    v_pk_mul_f32 v[4:5], s[60:61], v[176:177]
    v_pk_mul_f32 v[6:7], s[60:61], v[178:179]
    v_pk_mul_f32 v[8:9], s[60:61], v[180:181]
    v_pk_mul_f32 v[10:11], s[60:61], v[182:183]
    v_exp_f32 v4, v4
    v_exp_f32 v5, v5
    v_exp_f32 v6, v6
    v_exp_f32 v7, v7
    v_exp_f32 v8, v8
    v_exp_f32 v9, v9
    v_exp_f32 v10, v10
    v_exp_f32 v11, v11
    v_pk_mul_f32 v[176:177], v[176:177], v[184:185]
    v_pk_mul_f32 v[178:179], v[178:179], v[186:187]
    v_pk_mul_f32 v[180:181], v[180:181], v[188:189]
    v_pk_mul_f32 v[182:183], v[182:183], v[190:191]
    v_pk_add_f32 v[4:5], v[4:5], 1.0 op_sel_hi:[1,0]
    v_pk_add_f32 v[6:7], v[6:7], 1.0 op_sel_hi:[1,0]
    v_pk_add_f32 v[8:9], v[8:9], 1.0 op_sel_hi:[1,0]
    v_pk_add_f32 v[10:11], v[10:11], 1.0 op_sel_hi:[1,0]
    v_rcp_f32 v4, v4
    v_rcp_f32 v5, v5
    v_rcp_f32 v6, v6
    v_rcp_f32 v7, v7
    v_rcp_f32 v8, v8
    v_rcp_f32 v9, v9
    v_rcp_f32 v10, v10
    v_rcp_f32 v11, v11
    v_pk_mul_f32 v[176:177], v[176:177], v[4:5]
    v_pk_mul_f32 v[178:179], v[178:179], v[6:7]
    v_pk_mul_f32 v[180:181], v[180:181], v[8:9]
    v_pk_mul_f32 v[182:183], v[182:183], v[10:11]
    v_cvt_pk_bf16_f32 v252, v176, v177
    v_cvt_pk_bf16_f32 v253, v178, v179
    v_cvt_pk_bf16_f32 v254, v180, v181
    v_cvt_pk_bf16_f32 v255, v182, v183
    buffer_store_dwordx4 v[252:255], v32, s[20:23], s56 offen offset:3072 sc1
TICK_56:
    v_mfma_f32_16x16x32_bf16 v[128:131], v[48:51], a[0:3], 0
    ds_read_b64_tr_b16 v[44:45], v16 offset:4096
    v_cvt_pk_bf16_f32 v86, -v204, -v205
    v_mfma_f32_16x16x32_bf16 v[144:147], v[48:51], a[4:7], 0
    ds_read_b64_tr_b16 v[46:47], v16 offset:4608
    v_cvt_pk_bf16_f32 v87, -v206, -v207
    v_mfma_f32_16x16x32_bf16 v[160:163], v[48:51], a[8:11], 0
    v_fma_f32 v192, v212, v200, -v192
    v_mfma_f32_16x16x32_bf16 v[176:179], v[48:51], a[12:15], 0
    s_waitcnt lgkmcnt(6)
TICK_57:
    v_mfma_f32_16x16x32_bf16 v[136:139], v[52:55], a[0:3], 0
    ds_read_b64_tr_b16 v[48:49], v16 offset:12288
    v_fma_f32 v193, v212, v201, -v193
    v_mfma_f32_16x16x32_bf16 v[152:155], v[52:55], a[4:7], 0
    ds_read_b64_tr_b16 v[50:51], v16 offset:12800
    v_fma_f32 v194, v212, v202, -v194
    v_mfma_f32_16x16x32_bf16 v[168:171], v[52:55], a[8:11], 0
    v_fma_f32 v195, v212, v203, -v195
    v_mfma_f32_16x16x32_bf16 v[184:187], v[52:55], a[12:15], 0
    s_waitcnt lgkmcnt(6)
TICK_58:
    v_mfma_f32_16x16x32_bf16 v[132:135], v[56:59], a[0:3], 0
    ds_read_b64_tr_b16 v[52:53], v17 offset:4096
    v_fma_f32 v196, v212, v204, -v196
    v_mfma_f32_16x16x32_bf16 v[148:151], v[56:59], a[4:7], 0
    ds_read_b64_tr_b16 v[54:55], v17 offset:4608
    v_fma_f32 v197, v212, v205, -v197
    v_mfma_f32_16x16x32_bf16 v[164:167], v[56:59], a[8:11], 0
    v_fma_f32 v198, v212, v206, -v198
    v_mfma_f32_16x16x32_bf16 v[180:183], v[56:59], a[12:15], 0
    s_waitcnt lgkmcnt(6)
TICK_59:
    v_mfma_f32_16x16x32_bf16 v[140:143], v[60:63], a[0:3], 0
    ds_read_b64_tr_b16 v[56:57], v17 offset:12288
    v_fma_f32 v199, v212, v207, -v199
    v_mfma_f32_16x16x32_bf16 v[156:159], v[60:63], a[4:7], 0
    ds_read_b64_tr_b16 v[58:59], v17 offset:12800
    v_cvt_pk_bf16_f32 v88, v192, v193
    v_mfma_f32_16x16x32_bf16 v[172:175], v[60:63], a[8:11], 0
    v_cvt_pk_bf16_f32 v89, v194, v195
    v_mfma_f32_16x16x32_bf16 v[188:191], v[60:63], a[12:15], 0
    s_waitcnt vmcnt(21) lgkmcnt(0)
TICK_60:
    v_mfma_f32_16x16x32_bf16 v[128:131], v[44:47], a[16:19], v[128:131]
    s_barrier
    ds_read_b64_tr_b16 v[60:61], v16 offset:16384
    v_mfma_f32_16x16x32_bf16 v[144:147], v[44:47], a[20:23], v[144:147]
    ds_read_b64_tr_b16 v[62:63], v16 offset:16896
    v_cvt_pk_bf16_f32 v90, -v196, -v197
    v_mfma_f32_16x16x32_bf16 v[160:163], v[44:47], a[24:27], v[160:163]
    v_cvt_pk_bf16_f32 v91, -v198, -v199
    v_add_f32 v216, 0x42e00000, v216
    v_mfma_f32_16x16x32_bf16 v[176:179], v[44:47], a[28:31], v[176:179]
TICK_61:
    v_mfma_f32_16x16x32_bf16 v[136:139], v[48:51], a[16:19], v[136:139]
    ds_read_b64_tr_b16 v[44:45], v16 offset:24576
    s_add_u32 m0, s6, 0
    v_mfma_f32_16x16x32_bf16 v[152:155], v[48:51], a[20:23], v[152:155]
    ds_read_b64_tr_b16 v[46:47], v16 offset:25088
    buffer_load_dwordx4 v12, s[12:15], s51 offen offset:0 lds
    v_mfma_f32_16x16x32_bf16 v[168:171], v[48:51], a[24:27], v[168:171]
    v_mul_f32 v196, v216, v214
    v_add_f32 v197, v196, v215
    v_mfma_f32_16x16x32_bf16 v[184:187], v[48:51], a[28:31], v[184:187]
    v_fma_f32 v198, 2.0, v215, v196
TICK_62:
    v_mfma_f32_16x16x32_bf16 v[132:135], v[52:55], a[16:19], v[132:135]
    ds_read_b64_tr_b16 v[48:49], v17 offset:16384
    v_add_f32 v199, v198, v215
    v_mfma_f32_16x16x32_bf16 v[148:151], v[52:55], a[20:23], v[148:151]
    ds_read_b64_tr_b16 v[50:51], v17 offset:16896
    v_mfma_f32_16x16x32_bf16 v[164:167], v[52:55], a[24:27], v[164:167]
    v_cos_f32 v192, v196
    v_mfma_f32_16x16x32_bf16 v[180:183], v[52:55], a[28:31], v[180:183]
    v_sin_f32 v196, v196
TICK_63:
    v_mfma_f32_16x16x32_bf16 v[140:143], v[56:59], a[16:19], v[140:143]
    ds_read_b64_tr_b16 v[52:53], v17 offset:24576
    buffer_load_dwordx4 v13, s[12:15], s51 offen offset:1024 lds
    v_mfma_f32_16x16x32_bf16 v[156:159], v[56:59], a[20:23], v[156:159]
    ds_read_b64_tr_b16 v[54:55], v17 offset:25088
    v_mfma_f32_16x16x32_bf16 v[172:175], v[56:59], a[24:27], v[172:175]
    v_cos_f32 v193, v197
    v_mfma_f32_16x16x32_bf16 v[188:191], v[56:59], a[28:31], v[188:191]
    s_waitcnt lgkmcnt(6)
    v_sin_f32 v197, v197
TICK_64:
    v_mfma_f32_16x16x32_bf16 v[128:131], v[60:63], a[32:35], v[128:131]
    ds_read_b64_tr_b16 v[56:57], v16 offset:20480
    v_mfma_f32_16x16x32_bf16 v[144:147], v[60:63], a[36:39], v[144:147]
    ds_read_b64_tr_b16 v[58:59], v16 offset:20992
    v_mfma_f32_16x16x32_bf16 v[160:163], v[60:63], a[40:43], v[160:163]
    v_cos_f32 v194, v198
    v_mfma_f32_16x16x32_bf16 v[176:179], v[60:63], a[44:47], v[176:179]
    s_waitcnt lgkmcnt(6)
    v_sin_f32 v198, v198
TICK_65:
    v_mfma_f32_16x16x32_bf16 v[136:139], v[44:47], a[32:35], v[136:139]
    ds_read_b64_tr_b16 v[60:61], v16 offset:28672
    buffer_load_dwordx4 v14, s[12:15], s51 offen offset:2048 lds
    v_mfma_f32_16x16x32_bf16 v[152:155], v[44:47], a[36:39], v[152:155]
    ds_read_b64_tr_b16 v[62:63], v16 offset:29184
    v_mfma_f32_16x16x32_bf16 v[168:171], v[44:47], a[40:43], v[168:171]
    v_cos_f32 v195, v199
    v_mfma_f32_16x16x32_bf16 v[184:187], v[44:47], a[44:47], v[184:187]
    s_waitcnt lgkmcnt(6)
    v_sin_f32 v199, v199
TICK_66:
    v_mfma_f32_16x16x32_bf16 v[132:135], v[48:51], a[32:35], v[132:135]
    ds_read_b64_tr_b16 v[44:45], v17 offset:20480
    s_add_u32 m0, s62, 32768
    v_mfma_f32_16x16x32_bf16 v[148:151], v[48:51], a[36:39], v[148:151]
    ds_read_b64_tr_b16 v[46:47], v17 offset:20992
    s_sub_u32 s7, s58, s69
    v_mfma_f32_16x16x32_bf16 v[164:167], v[48:51], a[40:43], v[164:167]
    s_add_u32 s7, s7, 8192
    s_mul_i32 s7, s7, s63
    s_add_u32 s7, s7, s69
    v_mfma_f32_16x16x32_bf16 v[180:183], v[48:51], a[44:47], v[180:183]
    s_mul_i32 s7, s7, 7
    s_waitcnt lgkmcnt(6)
    v_cvt_pk_bf16_f32 v92, v192, v193
TICK_67:
    v_mfma_f32_16x16x32_bf16 v[140:143], v[52:55], a[32:35], v[140:143]
    ds_read_b64_tr_b16 v[48:49], v17 offset:28672
    buffer_load_dwordx4 v18, s[16:19], s7 offen offset:0 lds
    v_mfma_f32_16x16x32_bf16 v[156:159], v[52:55], a[36:39], v[156:159]
    ds_read_b64_tr_b16 v[50:51], v17 offset:29184
    s_add_u32 m0, s6, 0
    v_mfma_f32_16x16x32_bf16 v[172:175], v[52:55], a[40:43], v[172:175]
    buffer_load_dwordx4 v15, s[12:15], s51 offen offset:3072 lds
    v_cvt_pk_bf16_f32 v93, v194, v195
    v_mfma_f32_16x16x32_bf16 v[188:191], v[52:55], a[44:47], v[188:191]
    s_waitcnt vmcnt(18) lgkmcnt(0)
    v_cvt_pk_bf16_f32 v94, -v196, -v197
    v_cvt_pk_bf16_f32 v95, -v198, -v199
TICK_68:
    v_mfma_f32_16x16x32_bf16 v[128:131], v[56:59], a[48:51], v[128:131]
    s_barrier
    ds_read_b64_tr_b16 v[52:53], v16 offset:32768
    v_mfma_f32_16x16x32_bf16 v[144:147], v[56:59], a[52:55], v[144:147]
    ds_read_b64_tr_b16 v[54:55], v16 offset:33280
    s_waitcnt vmcnt(17)
    v_mfma_f32_16x16x32_bf16 v[160:163], v[56:59], a[56:59], v[160:163]
    v_cmp_ne_u32 vcc, v30, v36
    s_nop 0
    s_cbranch_vccnz SPIN_ff
BACK_ff:
    v_mfma_f32_16x16x32_bf16 v[176:179], v[56:59], a[60:63], v[176:179]
    s_add_u32 m0, s62, 32768
    v_mul_f32 v200, v208, v192
TICK_69:
    v_mfma_f32_16x16x32_bf16 v[136:139], v[60:63], a[48:51], v[136:139]
    ds_read_b64_tr_b16 v[56:57], v16 offset:40960
    buffer_load_dwordx4 v19, s[16:19], s7 offen offset:1024 lds
    v_mfma_f32_16x16x32_bf16 v[152:155], v[60:63], a[52:55], v[152:155]
    ds_read_b64_tr_b16 v[58:59], v16 offset:41472
    s_add_u32 m0, s6, 16384
    v_mfma_f32_16x16x32_bf16 v[168:171], v[60:63], a[56:59], v[168:171]
    buffer_load_dwordx4 v12, s[12:15], s52 offen offset:0 lds
    v_mul_f32 v201, v208, v193
    v_mfma_f32_16x16x32_bf16 v[184:187], v[60:63], a[60:63], v[184:187]
    v_mul_f32 v204, v208, v196
    v_mul_f32 v205, v208, v197
TICK_70:
    v_mfma_f32_16x16x32_bf16 v[132:135], v[44:47], a[48:51], v[132:135]
    ds_read_b64_tr_b16 v[60:61], v17 offset:32768
    s_add_u32 m0, s62, 32768
    v_mfma_f32_16x16x32_bf16 v[148:151], v[44:47], a[52:55], v[148:151]
    ds_read_b64_tr_b16 v[62:63], v17 offset:33280
    buffer_load_dwordx4 v20, s[16:19], s7 offen offset:2048 lds
    v_mfma_f32_16x16x32_bf16 v[164:167], v[44:47], a[56:59], v[164:167]
    v_mul_f32 v202, v208, v194
    v_mul_f32 v203, v208, v195
    v_mfma_f32_16x16x32_bf16 v[180:183], v[44:47], a[60:63], v[180:183]
    v_mul_f32 v206, v208, v198
TICK_71:
    v_mfma_f32_16x16x32_bf16 v[140:143], v[48:51], a[48:51], v[140:143]
    ds_read_b64_tr_b16 v[44:45], v17 offset:40960
    s_add_u32 m0, s6, 16384
    v_mfma_f32_16x16x32_bf16 v[156:159], v[48:51], a[52:55], v[156:159]
    ds_read_b64_tr_b16 v[46:47], v17 offset:41472
    buffer_load_dwordx4 v13, s[12:15], s52 offen offset:1024 lds
    v_mfma_f32_16x16x32_bf16 v[172:175], v[48:51], a[56:59], v[172:175]
    v_mul_f32 v207, v208, v199
    v_fma_f32 v200, -v210, v196, v200
    v_mfma_f32_16x16x32_bf16 v[188:191], v[48:51], a[60:63], v[188:191]
    s_waitcnt lgkmcnt(6)
    v_fma_f32 v201, -v210, v197, v201
TICK_72:
    v_mfma_f32_16x16x32_bf16 v[128:131], v[52:55], a[64:67], v[128:131]
    ds_read_b64_tr_b16 v[48:49], v16 offset:36864
    s_add_u32 m0, s62, 32768
    v_mfma_f32_16x16x32_bf16 v[144:147], v[52:55], a[68:71], v[144:147]
    ds_read_b64_tr_b16 v[50:51], v16 offset:37376
    buffer_load_dwordx4 v21, s[16:19], s7 offen offset:3072 lds
    v_mfma_f32_16x16x32_bf16 v[160:163], v[52:55], a[72:75], v[160:163]
    v_fma_f32 v204, v210, v192, v204
    v_fma_f32 v205, v210, v193, v205
    v_mfma_f32_16x16x32_bf16 v[176:179], v[52:55], a[76:79], v[176:179]
    s_waitcnt lgkmcnt(6)
    v_fma_f32 v202, -v210, v198, v202
TICK_73:
    v_mfma_f32_16x16x32_bf16 v[136:139], v[56:59], a[64:67], v[136:139]
    ds_read_b64_tr_b16 v[52:53], v16 offset:45056
    s_add_u32 m0, s6, 16384
    v_mfma_f32_16x16x32_bf16 v[152:155], v[56:59], a[68:71], v[152:155]
    ds_read_b64_tr_b16 v[54:55], v16 offset:45568
    buffer_load_dwordx4 v14, s[12:15], s52 offen offset:2048 lds
    v_mfma_f32_16x16x32_bf16 v[168:171], v[56:59], a[72:75], v[168:171]
    v_fma_f32 v203, -v210, v199, v203
    v_fma_f32 v206, v210, v194, v206
    v_mfma_f32_16x16x32_bf16 v[184:187], v[56:59], a[76:79], v[184:187]
    s_waitcnt lgkmcnt(6)
    v_fma_f32 v207, v210, v195, v207
TICK_74:
    v_mfma_f32_16x16x32_bf16 v[132:135], v[60:63], a[64:67], v[132:135]
    ds_read_b64_tr_b16 v[56:57], v17 offset:36864
    s_waitcnt vmcnt(11)
    v_mfma_f32_16x16x32_bf16 v[148:151], v[60:63], a[68:71], v[148:151]
    ds_read_b64_tr_b16 v[58:59], v17 offset:37376
    buffer_store_dword v30, v28, s[20:23], 0 offen offset:0
    v_mfma_f32_16x16x32_bf16 v[164:167], v[60:63], a[72:75], v[164:167]
    v_cvt_pk_bf16_f32 v96, v200, v201
    v_cvt_pk_bf16_f32 v97, v202, v203
    v_mfma_f32_16x16x32_bf16 v[180:183], v[60:63], a[76:79], v[180:183]
    buffer_store_dwordx2 v[30:31], v29, s[20:23], 0 offen sc1
    s_waitcnt lgkmcnt(6)
TICK_75:
    v_mfma_f32_16x16x32_bf16 v[140:143], v[44:47], a[64:67], v[140:143]
    ds_read_b64_tr_b16 v[60:61], v17 offset:45056
    buffer_load_dwordx4 v15, s[12:15], s52 offen offset:3072 lds
    v_mfma_f32_16x16x32_bf16 v[156:159], v[44:47], a[68:71], v[156:159]
    ds_read_b64_tr_b16 v[62:63], v17 offset:45568
    v_cvt_pk_bf16_f32 v98, -v204, -v205
    v_mfma_f32_16x16x32_bf16 v[172:175], v[44:47], a[72:75], v[172:175]
    v_cvt_pk_bf16_f32 v99, -v206, -v207
    v_fma_f32 v192, v212, v200, -v192
    v_mfma_f32_16x16x32_bf16 v[188:191], v[44:47], a[76:79], v[188:191]
    s_waitcnt lgkmcnt(0)
TICK_76:
    v_mfma_f32_16x16x32_bf16 v[128:131], v[48:51], a[80:83], v[128:131]
    s_barrier
    ds_read_b64_tr_b16 v[44:45], v16 offset:49152
    v_mfma_f32_16x16x32_bf16 v[144:147], v[48:51], a[84:87], v[144:147]
    ds_read_b64_tr_b16 v[46:47], v16 offset:49664
    v_xor_b32 v248, 4096, v22
    v_mfma_f32_16x16x32_bf16 v[160:163], v[48:51], a[88:91], v[160:163]
    v_xor_b32 v249, 4096, v23
    v_xor_b32 v250, 4096, v24
    v_mfma_f32_16x16x32_bf16 v[176:179], v[48:51], a[92:95], v[176:179]
    v_xor_b32 v251, 4096, v25
    v_xor_b32 v252, 4096, v40
TICK_77:
    v_mfma_f32_16x16x32_bf16 v[136:139], v[52:55], a[80:83], v[136:139]
    ds_read_b64_tr_b16 v[48:49], v16 offset:57344
    s_add_u32 m0, s6, 32768
    v_mfma_f32_16x16x32_bf16 v[152:155], v[52:55], a[84:87], v[152:155]
    ds_read_b64_tr_b16 v[50:51], v16 offset:57856
    buffer_load_dwordx4 v12, s[12:15], s53 offen offset:0 lds
    v_mfma_f32_16x16x32_bf16 v[168:171], v[52:55], a[88:91], v[168:171]
    v_xor_b32 v253, 4096, v41
    v_xor_b32 v254, 4096, v42
    v_mfma_f32_16x16x32_bf16 v[184:187], v[52:55], a[92:95], v[184:187]
    v_xor_b32 v255, 4096, v43
    v_fma_f32 v193, v212, v201, -v193
TICK_78:
    v_mfma_f32_16x16x32_bf16 v[132:135], v[56:59], a[80:83], v[132:135]
    ds_read_b64_tr_b16 v[52:53], v17 offset:49152
    s_add_u32 m0, s62, 49152
    v_mfma_f32_16x16x32_bf16 v[148:151], v[56:59], a[84:87], v[148:151]
    ds_read_b64_tr_b16 v[54:55], v17 offset:49664
    s_sub_u32 s7, s65, s64
    v_mfma_f32_16x16x32_bf16 v[164:167], v[56:59], a[88:91], v[164:167]
    s_mul_i32 s7, s7, s63
    s_add_u32 s7, s7, s64
    s_add_u32 s7, s7, 8192
    v_mfma_f32_16x16x32_bf16 v[180:183], v[56:59], a[92:95], v[180:183]
    s_mul_i32 s7, s7, 7
    v_fma_f32 v194, v212, v202, -v194
TICK_79:
    v_mfma_f32_16x16x32_bf16 v[140:143], v[60:63], a[80:83], v[140:143]
    ds_read_b64_tr_b16 v[56:57], v17 offset:57344
    buffer_load_dwordx4 v18, s[16:19], s7 offen offset:0 lds
    v_mfma_f32_16x16x32_bf16 v[156:159], v[60:63], a[84:87], v[156:159]
    ds_read_b64_tr_b16 v[58:59], v17 offset:57856
    s_add_u32 m0, s6, 32768
    v_mfma_f32_16x16x32_bf16 v[172:175], v[60:63], a[88:91], v[172:175]
    buffer_load_dwordx4 v13, s[12:15], s53 offen offset:1024 lds
    v_fma_f32 v195, v212, v203, -v195
    v_mfma_f32_16x16x32_bf16 v[188:191], v[60:63], a[92:95], v[188:191]
    s_waitcnt lgkmcnt(6)
    v_fma_f32 v196, v212, v204, -v196
    v_fma_f32 v197, v212, v205, -v197
TICK_80:
    v_mfma_f32_16x16x32_bf16 v[128:131], v[44:47], a[96:99], v[128:131]
    ds_read_b64_tr_b16 v[60:61], v16 offset:53248
    s_add_u32 m0, s62, 49152
    v_mfma_f32_16x16x32_bf16 v[144:147], v[44:47], a[100:103], v[144:147]
    ds_read_b64_tr_b16 v[62:63], v16 offset:53760
    buffer_load_dwordx4 v19, s[16:19], s7 offen offset:1024 lds
    v_mfma_f32_16x16x32_bf16 v[160:163], v[44:47], a[104:107], v[160:163]
    v_fma_f32 v198, v212, v206, -v198
    v_fma_f32 v199, v212, v207, -v199
    v_mfma_f32_16x16x32_bf16 v[176:179], v[44:47], a[108:111], v[176:179]
    s_waitcnt lgkmcnt(6)
    v_cvt_pk_bf16_f32 v100, v192, v193
TICK_81:
    v_mfma_f32_16x16x32_bf16 v[136:139], v[48:51], a[96:99], v[136:139]
    ds_read_b64_tr_b16 v[44:45], v16 offset:61440
    s_add_u32 m0, s6, 32768
    v_mfma_f32_16x16x32_bf16 v[152:155], v[48:51], a[100:103], v[152:155]
    ds_read_b64_tr_b16 v[46:47], v16 offset:61952
    buffer_load_dwordx4 v14, s[12:15], s53 offen offset:2048 lds
    v_mfma_f32_16x16x32_bf16 v[168:171], v[48:51], a[104:107], v[168:171]
    v_cvt_pk_bf16_f32 v101, v194, v195
    v_cvt_pk_bf16_f32 v102, -v196, -v197
    v_mfma_f32_16x16x32_bf16 v[184:187], v[48:51], a[108:111], v[184:187]
    s_waitcnt lgkmcnt(6)
    v_cvt_pk_bf16_f32 v103, -v198, -v199
TICK_82:
    v_mfma_f32_16x16x32_bf16 v[132:135], v[52:55], a[96:99], v[132:135]
    ds_read_b64_tr_b16 v[48:49], v17 offset:53248
    s_add_u32 m0, s62, 49152
    v_mfma_f32_16x16x32_bf16 v[148:151], v[52:55], a[100:103], v[148:151]
    ds_read_b64_tr_b16 v[50:51], v17 offset:53760
    buffer_load_dwordx4 v20, s[16:19], s7 offen offset:2048 lds
    v_mfma_f32_16x16x32_bf16 v[164:167], v[52:55], a[104:107], v[164:167]
    v_fma_f32 v200, v212, v192, -v200
    v_fma_f32 v201, v212, v193, -v201
    v_mfma_f32_16x16x32_bf16 v[180:183], v[52:55], a[108:111], v[180:183]
    s_waitcnt lgkmcnt(6)
    v_fma_f32 v202, v212, v194, -v202
TICK_83:
    v_mfma_f32_16x16x32_bf16 v[140:143], v[56:59], a[96:99], v[140:143]
    ds_read_b64_tr_b16 v[52:53], v17 offset:61440
    s_add_u32 m0, s6, 32768
    v_mfma_f32_16x16x32_bf16 v[156:159], v[56:59], a[100:103], v[156:159]
    ds_read_b64_tr_b16 v[54:55], v17 offset:61952
    buffer_load_dwordx4 v15, s[12:15], s53 offen offset:3072 lds
    v_mfma_f32_16x16x32_bf16 v[172:175], v[56:59], a[104:107], v[172:175]
    v_fma_f32 v203, v212, v195, -v203
    v_fma_f32 v204, v212, v196, -v204
    v_mfma_f32_16x16x32_bf16 v[188:191], v[56:59], a[108:111], v[188:191]
    s_waitcnt vmcnt(16) lgkmcnt(0)
    v_fma_f32 v205, v212, v197, -v205
TICK_84:
    v_mfma_f32_16x16x32_bf16 v[128:131], v[60:63], a[112:115], v[128:131]
    s_barrier
    ds_read_b64_tr_b16 v[56:57], v16 offset:0
    v_mfma_f32_16x16x32_bf16 v[144:147], v[60:63], a[116:119], v[144:147]
    ds_read_b64_tr_b16 v[58:59], v16 offset:512
    s_add_u32 m0, s62, 49152
    v_mfma_f32_16x16x32_bf16 v[160:163], v[60:63], a[120:123], v[160:163]
    buffer_load_dwordx4 v21, s[16:19], s7 offen offset:3072 lds
    v_fma_f32 v206, v212, v198, -v206
    v_mfma_f32_16x16x32_bf16 v[176:179], v[60:63], a[124:127], v[176:179]
    v_fma_f32 v207, v212, v199, -v207
    v_cvt_pk_bf16_f32 v104, v200, v201
TICK_85:
    v_mfma_f32_16x16x32_bf16 v[136:139], v[44:47], a[112:115], v[136:139]
    ds_read_b64_tr_b16 v[60:61], v16 offset:8192
    s_add_u32 m0, s62, 65536
    v_mfma_f32_16x16x32_bf16 v[152:155], v[44:47], a[116:119], v[152:155]
    ds_read_b64_tr_b16 v[62:63], v16 offset:8704
    s_sub_u32 s7, s67, s66
    v_mfma_f32_16x16x32_bf16 v[168:171], v[44:47], a[120:123], v[168:171]
    s_mul_i32 s7, s7, s63
    s_add_u32 s7, s7, s66
    s_add_u32 s7, s7, 8192
    v_mfma_f32_16x16x32_bf16 v[184:187], v[44:47], a[124:127], v[184:187]
    s_mul_i32 s7, s7, 7
    v_cvt_pk_bf16_f32 v105, v202, v203
TICK_86:
    v_mfma_f32_16x16x32_bf16 v[132:135], v[48:51], a[112:115], v[132:135]
    ds_read_b64_tr_b16 v[44:45], v17 offset:0
    buffer_load_dwordx4 v18, s[16:19], s7 offen offset:0 lds
    v_mfma_f32_16x16x32_bf16 v[148:151], v[48:51], a[116:119], v[148:151]
    ds_read_b64_tr_b16 v[46:47], v17 offset:512
    v_cvt_pk_bf16_f32 v106, -v204, -v205
    v_mfma_f32_16x16x32_bf16 v[164:167], v[48:51], a[120:123], v[164:167]
    buffer_load_dwordx4 v19, s[16:19], s7 offen offset:1024 lds
    v_cvt_pk_bf16_f32 v107, -v206, -v207
    v_mfma_f32_16x16x32_bf16 v[180:183], v[48:51], a[124:127], v[180:183]
    v_fma_f32 v192, v212, v200, -v192
TICK_87:
    v_mfma_f32_16x16x32_bf16 v[140:143], v[52:55], a[112:115], v[140:143]
    ds_read_b64_tr_b16 v[48:49], v17 offset:8192
    buffer_load_dwordx4 v20, s[16:19], s7 offen offset:2048 lds
    v_mfma_f32_16x16x32_bf16 v[156:159], v[52:55], a[116:119], v[156:159]
    ds_read_b64_tr_b16 v[50:51], v17 offset:8704
    v_fma_f32 v193, v212, v201, -v193
    v_mfma_f32_16x16x32_bf16 v[172:175], v[52:55], a[120:123], v[172:175]
    v_fma_f32 v194, v212, v202, -v194
    v_fma_f32 v195, v212, v203, -v195
    v_mfma_f32_16x16x32_bf16 v[188:191], v[52:55], a[124:127], v[188:191]
    s_waitcnt lgkmcnt(6)
TICK_88:
    v_mfma_f32_16x16x32_bf16 v[128:131], v[56:59], a[128:131], v[128:131]
    ds_read_b64_tr_b16 v[52:53], v16 offset:4096
    buffer_load_dwordx4 v21, s[16:19], s7 offen offset:3072 lds
    v_mfma_f32_16x16x32_bf16 v[144:147], v[56:59], a[132:135], v[144:147]
    ds_read_b64_tr_b16 v[54:55], v16 offset:4608
    v_fma_f32 v196, v212, v204, -v196
    v_mfma_f32_16x16x32_bf16 v[160:163], v[56:59], a[136:139], v[160:163]
    v_fma_f32 v197, v212, v205, -v197
    v_fma_f32 v198, v212, v206, -v198
    v_mfma_f32_16x16x32_bf16 v[176:179], v[56:59], a[140:143], v[176:179]
    s_waitcnt lgkmcnt(6)
TICK_89:
    v_mfma_f32_16x16x32_bf16 v[136:139], v[60:63], a[128:131], v[136:139]
    ds_read_b64_tr_b16 v[56:57], v16 offset:12288
    s_add_u32 m0, s62, 81920
    v_mfma_f32_16x16x32_bf16 v[152:155], v[60:63], a[132:135], v[152:155]
    ds_read_b64_tr_b16 v[58:59], v16 offset:12800
    s_sub_u32 s7, s69, s68
    v_mfma_f32_16x16x32_bf16 v[168:171], v[60:63], a[136:139], v[168:171]
    s_mul_i32 s7, s7, s63
    s_add_u32 s7, s7, s68
    s_add_u32 s7, s7, 8192
    v_mfma_f32_16x16x32_bf16 v[184:187], v[60:63], a[140:143], v[184:187]
    s_mul_i32 s7, s7, 7
    s_waitcnt lgkmcnt(6)
    v_fma_f32 v199, v212, v207, -v199
TICK_90:
    v_mfma_f32_16x16x32_bf16 v[132:135], v[44:47], a[128:131], v[132:135]
    ds_read_b64_tr_b16 v[60:61], v17 offset:4096
    buffer_load_dwordx4 v18, s[16:19], s7 offen offset:0 lds
    v_mfma_f32_16x16x32_bf16 v[148:151], v[44:47], a[132:135], v[148:151]
    ds_read_b64_tr_b16 v[62:63], v17 offset:4608
    v_cvt_pk_bf16_f32 v108, v192, v193
    v_mfma_f32_16x16x32_bf16 v[164:167], v[44:47], a[136:139], v[164:167]
    v_cvt_pk_bf16_f32 v109, v194, v195
    v_cvt_pk_bf16_f32 v110, -v196, -v197
    v_mfma_f32_16x16x32_bf16 v[180:183], v[44:47], a[140:143], v[180:183]
    s_waitcnt lgkmcnt(6)
TICK_91:
    v_mfma_f32_16x16x32_bf16 v[140:143], v[48:51], a[128:131], v[140:143]
    ds_read_b64_tr_b16 v[44:45], v17 offset:12288
    buffer_load_dwordx4 v19, s[16:19], s7 offen offset:1024 lds
    v_mfma_f32_16x16x32_bf16 v[156:159], v[48:51], a[132:135], v[156:159]
    ds_read_b64_tr_b16 v[46:47], v17 offset:12800
    v_cvt_pk_bf16_f32 v111, -v198, -v199
    v_mfma_f32_16x16x32_bf16 v[172:175], v[48:51], a[136:139], v[172:175]
    v_fma_f32 v200, v212, v192, -v200
    v_fma_f32 v201, v212, v193, -v201
    v_mfma_f32_16x16x32_bf16 v[188:191], v[48:51], a[140:143], v[188:191]
    s_waitcnt vmcnt(14) lgkmcnt(0)
TICK_92:
    v_mfma_f32_16x16x32_bf16 v[128:131], v[52:55], a[144:147], v[128:131]
    s_barrier
    ds_read_b64_tr_b16 v[48:49], v16 offset:16384
    v_mfma_f32_16x16x32_bf16 v[144:147], v[52:55], a[148:151], v[144:147]
    ds_read_b64_tr_b16 v[50:51], v16 offset:16896
    buffer_load_dwordx4 v20, s[16:19], s7 offen offset:2048 lds
    v_mfma_f32_16x16x32_bf16 v[160:163], v[52:55], a[152:155], v[160:163]
    v_fma_f32 v202, v212, v194, -v202
    v_fma_f32 v203, v212, v195, -v203
    v_mfma_f32_16x16x32_bf16 v[176:179], v[52:55], a[156:159], v[176:179]
    v_fma_f32 v204, v212, v196, -v204
TICK_93:
    v_mfma_f32_16x16x32_bf16 v[136:139], v[56:59], a[144:147], v[136:139]
    ds_read_b64_tr_b16 v[52:53], v16 offset:24576
    s_buffer_load_dwordx16 s[40:55], s[20:23], s39 offset:0
    v_mfma_f32_16x16x32_bf16 v[152:155], v[56:59], a[148:151], v[152:155]
    ds_read_b64_tr_b16 v[54:55], v16 offset:25088
    buffer_load_dwordx4 v21, s[16:19], s7 offen offset:3072 lds
    v_mfma_f32_16x16x32_bf16 v[168:171], v[56:59], a[152:155], v[168:171]
    v_fma_f32 v205, v212, v197, -v205
    v_fma_f32 v206, v212, v198, -v206
    v_mfma_f32_16x16x32_bf16 v[184:187], v[56:59], a[156:159], v[184:187]
    v_fma_f32 v207, v212, v199, -v207
TICK_94:
    v_mfma_f32_16x16x32_bf16 v[132:135], v[60:63], a[144:147], v[132:135]
    ds_read_b64_tr_b16 v[56:57], v17 offset:16384
    s_add_u32 m0, s62, 98304
    v_mfma_f32_16x16x32_bf16 v[148:151], v[60:63], a[148:151], v[148:151]
    ds_read_b64_tr_b16 v[58:59], v17 offset:16896
    s_sub_u32 s7, s64, s58
    v_mfma_f32_16x16x32_bf16 v[164:167], v[60:63], a[152:155], v[164:167]
    s_mul_i32 s7, s7, s63
    s_add_u32 s7, s7, s58
    s_mul_i32 s7, s7, 7
    v_mfma_f32_16x16x32_bf16 v[180:183], v[60:63], a[156:159], v[180:183]
    buffer_load_dwordx4 v18, s[16:19], s7 offen offset:0 lds
TICK_95:
    v_mfma_f32_16x16x32_bf16 v[140:143], v[44:47], a[144:147], v[140:143]
    ds_read_b64_tr_b16 v[60:61], v17 offset:24576
    v_cvt_pk_bf16_f32 v112, v200, v201
    v_mfma_f32_16x16x32_bf16 v[156:159], v[44:47], a[148:151], v[156:159]
    ds_read_b64_tr_b16 v[62:63], v17 offset:25088
    v_cvt_pk_bf16_f32 v113, v202, v203
    v_mfma_f32_16x16x32_bf16 v[172:175], v[44:47], a[152:155], v[172:175]
    v_cvt_pk_bf16_f32 v114, -v204, -v205
    v_mfma_f32_16x16x32_bf16 v[188:191], v[44:47], a[156:159], v[188:191]
    s_waitcnt lgkmcnt(6)
TICK_96:
    v_mfma_f32_16x16x32_bf16 v[128:131], v[48:51], a[160:163], v[128:131]
    ds_read_b64_tr_b16 v[44:45], v16 offset:20480
    buffer_load_dwordx4 v19, s[16:19], s7 offen offset:1024 lds
    v_mfma_f32_16x16x32_bf16 v[144:147], v[48:51], a[164:167], v[144:147]
    ds_read_b64_tr_b16 v[46:47], v16 offset:20992
    v_cvt_pk_bf16_f32 v115, -v206, -v207
    v_mfma_f32_16x16x32_bf16 v[160:163], v[48:51], a[168:171], v[160:163]
    v_fma_f32 v192, v212, v200, -v192
    v_fma_f32 v193, v212, v201, -v193
    v_mfma_f32_16x16x32_bf16 v[176:179], v[48:51], a[172:175], v[176:179]
    s_waitcnt lgkmcnt(6)
TICK_97:
    v_mfma_f32_16x16x32_bf16 v[136:139], v[52:55], a[160:163], v[136:139]
    ds_read_b64_tr_b16 v[48:49], v16 offset:28672
    buffer_load_dwordx4 v20, s[16:19], s7 offen offset:2048 lds
    v_mfma_f32_16x16x32_bf16 v[152:155], v[52:55], a[164:167], v[152:155]
    ds_read_b64_tr_b16 v[50:51], v16 offset:29184
    v_fma_f32 v194, v212, v202, -v194
    v_mfma_f32_16x16x32_bf16 v[168:171], v[52:55], a[168:171], v[168:171]
    v_fma_f32 v195, v212, v203, -v195
    v_fma_f32 v196, v212, v204, -v196
    v_mfma_f32_16x16x32_bf16 v[184:187], v[52:55], a[172:175], v[184:187]
    s_waitcnt lgkmcnt(6)
TICK_98:
    v_mfma_f32_16x16x32_bf16 v[132:135], v[56:59], a[160:163], v[132:135]
    ds_read_b64_tr_b16 v[52:53], v17 offset:20480
    buffer_load_dwordx4 v21, s[16:19], s7 offen offset:3072 lds
    v_mfma_f32_16x16x32_bf16 v[148:151], v[56:59], a[164:167], v[148:151]
    ds_read_b64_tr_b16 v[54:55], v17 offset:20992
    v_fma_f32 v197, v212, v205, -v197
    v_mfma_f32_16x16x32_bf16 v[164:167], v[56:59], a[168:171], v[164:167]
    v_fma_f32 v198, v212, v206, -v198
    v_fma_f32 v199, v212, v207, -v199
    v_mfma_f32_16x16x32_bf16 v[180:183], v[56:59], a[172:175], v[180:183]
    s_waitcnt lgkmcnt(6)
TICK_99:
    v_mfma_f32_16x16x32_bf16 v[140:143], v[60:63], a[160:163], v[140:143]
    ds_read_b64_tr_b16 v[56:57], v17 offset:28672
    v_cvt_pk_bf16_f32 v116, v192, v193
    v_mfma_f32_16x16x32_bf16 v[156:159], v[60:63], a[164:167], v[156:159]
    ds_read_b64_tr_b16 v[58:59], v17 offset:29184
    v_cvt_pk_bf16_f32 v117, v194, v195
    v_mfma_f32_16x16x32_bf16 v[172:175], v[60:63], a[168:171], v[172:175]
    v_cvt_pk_bf16_f32 v118, -v196, -v197
    v_mfma_f32_16x16x32_bf16 v[188:191], v[60:63], a[172:175], v[188:191]
    s_waitcnt vmcnt(13) lgkmcnt(0)
TICK_100:
    v_mfma_f32_16x16x32_bf16 v[128:131], v[44:47], a[176:179], v[128:131]
    s_barrier
    ds_read_b64_tr_b16 v[60:61], v16 offset:32768
    v_mfma_f32_16x16x32_bf16 v[144:147], v[44:47], a[180:183], v[144:147]
    ds_read_b64_tr_b16 v[62:63], v16 offset:33280
    s_waitcnt lgkmcnt(0)
    v_mfma_f32_16x16x32_bf16 v[160:163], v[44:47], a[184:187], v[160:163]
    s_xor_b64 s[40:41], s[40:41], s[70:71]
    s_xor_b64 s[42:43], s[42:43], s[70:71]
    s_xor_b64 s[44:45], s[44:45], s[70:71]
    v_mfma_f32_16x16x32_bf16 v[176:179], v[44:47], a[188:191], v[176:179]
    s_xor_b32 s46, s46, s71
    s_or_b64 s[40:41], s[40:41], s[42:43]
TICK_101:
    v_mfma_f32_16x16x32_bf16 v[136:139], v[48:51], a[176:179], v[136:139]
    ds_read_b64_tr_b16 v[44:45], v16 offset:40960
    s_or_b32 s44, s44, s46
    v_mfma_f32_16x16x32_bf16 v[152:155], v[48:51], a[180:183], v[152:155]
    ds_read_b64_tr_b16 v[46:47], v16 offset:41472
    s_or_b64 s[40:41], s[40:41], s[44:45]
    v_mfma_f32_16x16x32_bf16 v[168:171], v[48:51], a[184:187], v[168:171]
    s_xor_b64 s[48:49], s[48:49], s[70:71]
    s_xor_b64 s[50:51], s[50:51], s[70:71]
    s_xor_b64 s[52:53], s[52:53], s[70:71]
    v_mfma_f32_16x16x32_bf16 v[184:187], v[48:51], a[188:191], v[184:187]
    s_xor_b32 s54, s54, s71
    s_or_b64 s[48:49], s[48:49], s[50:51]
TICK_102:
    v_mfma_f32_16x16x32_bf16 v[132:135], v[52:55], a[176:179], v[132:135]
    ds_read_b64_tr_b16 v[48:49], v17 offset:32768
    s_or_b32 s52, s52, s54
    v_mfma_f32_16x16x32_bf16 v[148:151], v[52:55], a[180:183], v[148:151]
    ds_read_b64_tr_b16 v[50:51], v17 offset:33280
    s_or_b64 s[48:49], s[48:49], s[52:53]
    v_mfma_f32_16x16x32_bf16 v[164:167], v[52:55], a[184:187], v[164:167]
    s_or_b64 s[40:41], s[40:41], s[48:49]
    s_cbranch_scc1 SPIN_hf0
BACK_hf0:
    v_cvt_pk_bf16_f32 v119, -v198, -v199
    v_mfma_f32_16x16x32_bf16 v[180:183], v[52:55], a[188:191], v[180:183]
    buffer_load_dwordx4 a[0:3], v34, s[20:23], s58 offen offset:0 sc1
TICK_103:
    v_mfma_f32_16x16x32_bf16 v[140:143], v[56:59], a[176:179], v[140:143]
    ds_read_b64_tr_b16 v[52:53], v17 offset:40960
    buffer_load_dwordx4 a[4:7], v34, s[20:23], s58 offen offset:1024 sc1
    v_mfma_f32_16x16x32_bf16 v[156:159], v[56:59], a[180:183], v[156:159]
    ds_read_b64_tr_b16 v[54:55], v17 offset:41472
    v_mfma_f32_16x16x32_bf16 v[172:175], v[56:59], a[184:187], v[172:175]
    buffer_load_dwordx4 a[16:19], v26, s[20:23], s64 offen offset:0 sc1
    v_mfma_f32_16x16x32_bf16 v[188:191], v[56:59], a[188:191], v[188:191]
TICK_104:
    v_mfma_f32_16x16x32_bf16 v[128:131], v[60:63], a[192:195], v[128:131]
    ds_read_b64_tr_b16 v[56:57], v16 offset:36864
    s_mul_i32 s38, s4, 7168
    v_mfma_f32_16x16x32_bf16 v[144:147], v[60:63], a[196:199], v[144:147]
    ds_read_b64_tr_b16 v[58:59], v16 offset:37376
    s_sub_u32 s38, s30, s38
    v_mfma_f32_16x16x32_bf16 v[160:163], v[60:63], a[200:203], v[160:163]
    s_add_u32 s38, s38, 3584
    v_mov_b32 v29, s38
    v_mfma_f32_16x16x32_bf16 v[176:179], v[60:63], a[204:207], v[176:179]
    buffer_load_dword v2, v29, s[20:23], 0 offen sc1
    s_waitcnt lgkmcnt(6)
TICK_105:
    v_mfma_f32_16x16x32_bf16 v[136:139], v[44:47], a[192:195], v[136:139]
    ds_read_b64_tr_b16 v[60:61], v16 offset:45056
    buffer_load_dwordx4 a[20:23], v26, s[20:23], s64 offen offset:1024 sc1
    v_mfma_f32_16x16x32_bf16 v[152:155], v[44:47], a[196:199], v[152:155]
    ds_read_b64_tr_b16 v[62:63], v16 offset:45568
    v_mfma_f32_16x16x32_bf16 v[168:171], v[44:47], a[200:203], v[168:171]
    buffer_load_dwordx4 a[24:27], v34, s[20:23], s64 offen offset:0 sc1
    v_mfma_f32_16x16x32_bf16 v[184:187], v[44:47], a[204:207], v[184:187]
    s_waitcnt lgkmcnt(6)
TICK_106:
    v_mfma_f32_16x16x32_bf16 v[132:135], v[48:51], a[192:195], v[132:135]
    ds_read_b64_tr_b16 v[44:45], v17 offset:36864
    buffer_load_dwordx4 a[28:31], v34, s[20:23], s64 offen offset:1024 sc1
    v_mfma_f32_16x16x32_bf16 v[148:151], v[48:51], a[196:199], v[148:151]
    ds_read_b64_tr_b16 v[46:47], v17 offset:37376
    v_mfma_f32_16x16x32_bf16 v[164:167], v[48:51], a[200:203], v[164:167]
    v_mfma_f32_16x16x32_bf16 v[180:183], v[48:51], a[204:207], v[180:183]
    s_waitcnt lgkmcnt(6)
TICK_107:
    v_mfma_f32_16x16x32_bf16 v[140:143], v[52:55], a[192:195], v[140:143]
    ds_read_b64_tr_b16 v[48:49], v17 offset:45056
    buffer_load_dwordx4 a[32:35], v26, s[20:23], s65 offen offset:0 sc1
    v_mfma_f32_16x16x32_bf16 v[156:159], v[52:55], a[196:199], v[156:159]
    ds_read_b64_tr_b16 v[50:51], v17 offset:45568
    v_mfma_f32_16x16x32_bf16 v[172:175], v[52:55], a[200:203], v[172:175]
    v_mfma_f32_16x16x32_bf16 v[188:191], v[52:55], a[204:207], v[188:191]
    s_waitcnt vmcnt(8) lgkmcnt(0)
TICK_108:
    v_mfma_f32_16x16x32_bf16 v[128:131], v[56:59], a[208:211], v[128:131]
    s_barrier
    v_add_u32 v16, 98304, v32
    v_lshrrev_b32 v7, 2, v38
    v_mfma_f32_16x16x32_bf16 v[144:147], v[56:59], a[212:215], v[144:147]
    ds_read_b64_tr_b16 a[224:225], v40 offset:32768
    v_and_b32 v6, 3, v0
    v_mfma_f32_16x16x32_bf16 v[160:163], v[56:59], a[216:219], v[160:163]
    ds_read_b64_tr_b16 a[226:227], v40 offset:34816
    s_lshl_b32 s3, s100, 9
    v_mfma_f32_16x16x32_bf16 v[176:179], v[56:59], a[220:223], v[176:179]
    ds_read_b64_tr_b16 a[228:229], v41 offset:32768
TICK_109:
    v_mfma_f32_16x16x32_bf16 v[136:139], v[60:63], a[208:211], v[136:139]
    buffer_load_dwordx4 a[36:39], v26, s[20:23], s65 offen offset:1024 sc1
    s_lshl_b32 s34, s28, 7
    v_mfma_f32_16x16x32_bf16 v[152:155], v[60:63], a[212:215], v[152:155]
    ds_read_b64_tr_b16 a[230:231], v41 offset:34816
    s_add_u32 s3, s3, s34
    v_mfma_f32_16x16x32_bf16 v[168:171], v[60:63], a[216:219], v[168:171]
    ds_read_b64_tr_b16 a[232:233], v42 offset:32768
    s_add_u32 s3, s3, 11010048
    v_mfma_f32_16x16x32_bf16 v[184:187], v[60:63], a[220:223], v[184:187]
    ds_read_b64_tr_b16 a[234:235], v42 offset:34816
TICK_110:
    v_mfma_f32_16x16x32_bf16 v[132:135], v[44:47], a[208:211], v[132:135]
    buffer_load_dwordx4 a[40:43], v34, s[20:23], s65 offen offset:0 sc1
    v_lshl_add_u32 v12, v7, 5, s3
    v_mfma_f32_16x16x32_bf16 v[148:151], v[44:47], a[212:215], v[148:151]
    ds_read_b64_tr_b16 a[236:237], v43 offset:32768
    v_lshlrev_b32 v8, 6, v6
    v_mfma_f32_16x16x32_bf16 v[164:167], v[44:47], a[216:219], v[164:167]
    ds_read_b64_tr_b16 a[238:239], v43 offset:34816
    v_lshl_add_u32 v14, v7, 4, v8
    v_mfma_f32_16x16x32_bf16 v[180:183], v[44:47], a[220:223], v[180:183]
    v_lshlrev_b32 v8, 4, v6
    v_lshl_add_u32 v223, v7, 8, v8
TICK_111:
    v_mfma_f32_16x16x32_bf16 v[140:143], v[48:51], a[208:211], v[140:143]
    buffer_load_dwordx4 a[44:47], v34, s[20:23], s65 offen offset:1024 sc1
    v_mul_u32_u24 v7, 229376, v7
    v_mfma_f32_16x16x32_bf16 v[156:159], v[48:51], a[212:215], v[156:159]
    v_lshl_add_u32 v7, v6, 3, v7
    v_lshl_add_u32 v7, v39, 5, v7
    v_mfma_f32_16x16x32_bf16 v[172:175], v[48:51], a[216:219], v[172:175]
    s_lshl_b32 s3, s100, 1
    s_add_u32 s3, s3, s63
    s_mul_i32 s3, s3, 896
    v_mfma_f32_16x16x32_bf16 v[188:191], v[48:51], a[220:223], v[188:191]
    s_mul_i32 s34, s33, 917504
    s_add_u32 s3, s3, s34
    s_lshl_b32 s34, s32, 7
    s_add_u32 s3, s3, s34
    v_add_u32 v13, s3, v7
    s_lshl_b32 s3, s28, 10
    s_add_u32 s3, s3, 16384
    v_lshl_add_u32 v15, v39, 12, v14
    v_add_u32 v15, s3, v15
    v_lshl_add_u32 v14, v39, 10, v14
    v_add_u32 v14, s62, v14
    v_add_u32 v27, s31, v32
    v_pk_mul_f32 v[4:5], s[60:61], v[128:129]
    v_pk_mul_f32 v[6:7], s[60:61], v[130:131]
    v_pk_mul_f32 v[8:9], s[60:61], v[132:133]
    v_pk_mul_f32 v[10:11], s[60:61], v[134:135]
    buffer_load_dwordx4 a[48:51], v26, s[20:23], s66 offen offset:0 sc1
    v_exp_f32 v4, v4
    v_exp_f32 v5, v5
    v_exp_f32 v6, v6
    v_exp_f32 v7, v7
    v_exp_f32 v8, v8
    v_exp_f32 v9, v9
    v_exp_f32 v10, v10
    v_exp_f32 v11, v11
    v_pk_mul_f32 v[128:129], v[128:129], v[136:137]
    v_pk_mul_f32 v[130:131], v[130:131], v[138:139]
    v_pk_mul_f32 v[132:133], v[132:133], v[140:141]
    v_pk_mul_f32 v[134:135], v[134:135], v[142:143]
    v_pk_add_f32 v[4:5], v[4:5], 1.0 op_sel_hi:[1,0]
    v_pk_add_f32 v[6:7], v[6:7], 1.0 op_sel_hi:[1,0]
    v_pk_add_f32 v[8:9], v[8:9], 1.0 op_sel_hi:[1,0]
    v_pk_add_f32 v[10:11], v[10:11], 1.0 op_sel_hi:[1,0]
    v_rcp_f32 v4, v4
    v_rcp_f32 v5, v5
    v_rcp_f32 v6, v6
    v_rcp_f32 v7, v7
    v_rcp_f32 v8, v8
    v_rcp_f32 v9, v9
    v_rcp_f32 v10, v10
    v_rcp_f32 v11, v11
    v_pk_mul_f32 v[128:129], v[128:129], v[4:5]
    v_pk_mul_f32 v[130:131], v[130:131], v[6:7]
    v_pk_mul_f32 v[132:133], v[132:133], v[8:9]
    v_pk_mul_f32 v[134:135], v[134:135], v[10:11]
    v_cvt_pk_bf16_f32 v224, v128, v129
    v_cvt_pk_bf16_f32 v225, v130, v131
    v_cvt_pk_bf16_f32 v226, v132, v133
    v_cvt_pk_bf16_f32 v227, v134, v135
    buffer_store_dwordx4 v[224:227], v32, s[20:23], s57 offen offset:0 sc1
    v_pk_mul_f32 v[4:5], s[60:61], v[144:145]
    v_pk_mul_f32 v[6:7], s[60:61], v[146:147]
    v_pk_mul_f32 v[8:9], s[60:61], v[148:149]
    v_pk_mul_f32 v[10:11], s[60:61], v[150:151]
    v_exp_f32 v4, v4
    v_exp_f32 v5, v5
    v_exp_f32 v6, v6
    v_exp_f32 v7, v7
    v_exp_f32 v8, v8
    v_exp_f32 v9, v9
    v_exp_f32 v10, v10
    v_exp_f32 v11, v11
    buffer_load_dwordx4 a[52:55], v26, s[20:23], s66 offen offset:1024 sc1
    v_pk_mul_f32 v[144:145], v[144:145], v[152:153]
    v_pk_mul_f32 v[146:147], v[146:147], v[154:155]
    v_pk_mul_f32 v[148:149], v[148:149], v[156:157]
    v_pk_mul_f32 v[150:151], v[150:151], v[158:159]
    v_pk_add_f32 v[4:5], v[4:5], 1.0 op_sel_hi:[1,0]
    v_pk_add_f32 v[6:7], v[6:7], 1.0 op_sel_hi:[1,0]
    v_pk_add_f32 v[8:9], v[8:9], 1.0 op_sel_hi:[1,0]
    v_pk_add_f32 v[10:11], v[10:11], 1.0 op_sel_hi:[1,0]
    v_rcp_f32 v4, v4
    v_rcp_f32 v5, v5
    v_rcp_f32 v6, v6
    v_rcp_f32 v7, v7
    v_rcp_f32 v8, v8
    v_rcp_f32 v9, v9
    v_rcp_f32 v10, v10
    v_rcp_f32 v11, v11
    v_pk_mul_f32 v[144:145], v[144:145], v[4:5]
    v_pk_mul_f32 v[146:147], v[146:147], v[6:7]
    v_pk_mul_f32 v[148:149], v[148:149], v[8:9]
    v_pk_mul_f32 v[150:151], v[150:151], v[10:11]
    v_cvt_pk_bf16_f32 v228, v144, v145
    v_cvt_pk_bf16_f32 v229, v146, v147
    v_cvt_pk_bf16_f32 v230, v148, v149
    v_cvt_pk_bf16_f32 v231, v150, v151
    buffer_store_dwordx4 v[228:231], v32, s[20:23], s57 offen offset:1024 sc1
    v_pk_mul_f32 v[4:5], s[60:61], v[160:161]
    v_pk_mul_f32 v[6:7], s[60:61], v[162:163]
    v_pk_mul_f32 v[8:9], s[60:61], v[164:165]
    v_pk_mul_f32 v[10:11], s[60:61], v[166:167]
    v_exp_f32 v4, v4
    v_exp_f32 v5, v5
    v_exp_f32 v6, v6
    v_exp_f32 v7, v7
    v_exp_f32 v8, v8
    v_exp_f32 v9, v9
    v_exp_f32 v10, v10
    v_exp_f32 v11, v11
    v_pk_mul_f32 v[160:161], v[160:161], v[168:169]
    v_pk_mul_f32 v[162:163], v[162:163], v[170:171]
    v_pk_mul_f32 v[164:165], v[164:165], v[172:173]
    v_pk_mul_f32 v[166:167], v[166:167], v[174:175]
    v_pk_add_f32 v[4:5], v[4:5], 1.0 op_sel_hi:[1,0]
    v_pk_add_f32 v[6:7], v[6:7], 1.0 op_sel_hi:[1,0]
    v_pk_add_f32 v[8:9], v[8:9], 1.0 op_sel_hi:[1,0]
    v_pk_add_f32 v[10:11], v[10:11], 1.0 op_sel_hi:[1,0]
    v_rcp_f32 v4, v4
    v_rcp_f32 v5, v5
    v_rcp_f32 v6, v6
    v_rcp_f32 v7, v7
    v_rcp_f32 v8, v8
    v_rcp_f32 v9, v9
    v_rcp_f32 v10, v10
    v_rcp_f32 v11, v11
    buffer_load_dwordx4 a[56:59], v34, s[20:23], s66 offen offset:0 sc1
    v_pk_mul_f32 v[160:161], v[160:161], v[4:5]
    v_pk_mul_f32 v[162:163], v[162:163], v[6:7]
    v_pk_mul_f32 v[164:165], v[164:165], v[8:9]
    v_pk_mul_f32 v[166:167], v[166:167], v[10:11]
    v_cvt_pk_bf16_f32 v232, v160, v161
    v_cvt_pk_bf16_f32 v233, v162, v163
    v_cvt_pk_bf16_f32 v234, v164, v165
    v_cvt_pk_bf16_f32 v235, v166, v167
    buffer_store_dwordx4 v[232:235], v32, s[20:23], s57 offen offset:2048 sc1
    v_pk_mul_f32 v[4:5], s[60:61], v[176:177]
    v_pk_mul_f32 v[6:7], s[60:61], v[178:179]
    v_pk_mul_f32 v[8:9], s[60:61], v[180:181]
    v_pk_mul_f32 v[10:11], s[60:61], v[182:183]
    v_exp_f32 v4, v4
    v_exp_f32 v5, v5
    v_exp_f32 v6, v6
    v_exp_f32 v7, v7
    v_exp_f32 v8, v8
    v_exp_f32 v9, v9
    v_exp_f32 v10, v10
    v_exp_f32 v11, v11
    v_pk_mul_f32 v[176:177], v[176:177], v[184:185]
    v_pk_mul_f32 v[178:179], v[178:179], v[186:187]
    v_pk_mul_f32 v[180:181], v[180:181], v[188:189]
    v_pk_mul_f32 v[182:183], v[182:183], v[190:191]
    v_pk_add_f32 v[4:5], v[4:5], 1.0 op_sel_hi:[1,0]
    v_pk_add_f32 v[6:7], v[6:7], 1.0 op_sel_hi:[1,0]
    v_pk_add_f32 v[8:9], v[8:9], 1.0 op_sel_hi:[1,0]
    v_pk_add_f32 v[10:11], v[10:11], 1.0 op_sel_hi:[1,0]
    v_rcp_f32 v4, v4
    v_rcp_f32 v5, v5
    v_rcp_f32 v6, v6
    v_rcp_f32 v7, v7
    v_rcp_f32 v8, v8
    v_rcp_f32 v9, v9
    v_rcp_f32 v10, v10
    v_rcp_f32 v11, v11
    v_pk_mul_f32 v[176:177], v[176:177], v[4:5]
    v_pk_mul_f32 v[178:179], v[178:179], v[6:7]
    v_pk_mul_f32 v[180:181], v[180:181], v[8:9]
    v_pk_mul_f32 v[182:183], v[182:183], v[10:11]
    v_cvt_pk_bf16_f32 v236, v176, v177
    v_cvt_pk_bf16_f32 v237, v178, v179
    v_cvt_pk_bf16_f32 v238, v180, v181
    v_cvt_pk_bf16_f32 v239, v182, v183
    buffer_store_dwordx4 v[236:239], v32, s[20:23], s57 offen offset:3072 sc1
    s_waitcnt lgkmcnt(4)
TICK_112:
    v_mfma_f32_16x16x32_bf16 v[128:131], a[224:227], v[240:243], 0
    ds_read_b64_tr_b16 a[240:241], v252 offset:32768
    buffer_load_dwordx4 a[60:63], v34, s[20:23], s66 offen offset:1024 sc1
    v_mfma_f32_16x16x32_bf16 v[144:147], a[224:227], v[244:247], 0
    ds_read_b64_tr_b16 a[242:243], v252 offset:34816
    v_lshrrev_b32 v7, 5, v0
    v_mfma_f32_16x16x32_bf16 v[132:135], a[228:231], v[240:243], 0
    ds_read_b64_tr_b16 a[244:245], v253 offset:32768
    v_lshl_add_u32 v223, v7, 10, v223
    v_mfma_f32_16x16x32_bf16 v[148:151], a[228:231], v[244:247], 0
    ds_read_b64_tr_b16 a[246:247], v253 offset:34816
    s_waitcnt lgkmcnt(4)
TICK_113:
    v_mfma_f32_16x16x32_bf16 v[136:139], a[232:235], v[240:243], 0
    ds_read_b64_tr_b16 a[248:249], v254 offset:32768
    v_and_b32 v7, 1, v39
    v_mfma_f32_16x16x32_bf16 v[152:155], a[232:235], v[244:247], 0
    ds_read_b64_tr_b16 a[250:251], v254 offset:34816
    v_lshl_add_u32 v223, v7, 3, v223
    v_mfma_f32_16x16x32_bf16 v[140:143], a[236:239], v[240:243], 0
    ds_read_b64_tr_b16 a[252:253], v255 offset:32768
    s_xor_b32 s3, s59, 8192
    v_mfma_f32_16x16x32_bf16 v[156:159], a[236:239], v[244:247], 0
    ds_read_b64_tr_b16 a[254:255], v255 offset:34816
    s_waitcnt vmcnt(17) lgkmcnt(4)
TICK_114:
    v_mfma_f32_16x16x32_bf16 v[128:131], a[240:243], a[0:3], v[128:131]
    ds_read_b64_tr_b16 a[224:225], v40 offset:40960
    buffer_load_dwordx4 a[64:67], v26, s[20:23], s67 offen offset:0 sc1
    v_mfma_f32_16x16x32_bf16 v[144:147], a[240:243], a[4:7], v[144:147]
    ds_read_b64_tr_b16 a[226:227], v40 offset:43008
    v_add_u32 v223, s3, v223
    v_mfma_f32_16x16x32_bf16 v[132:135], a[244:247], a[0:3], v[132:135]
    ds_read_b64_tr_b16 a[228:229], v41 offset:40960
    v_lshl_add_u32 v7, v38, 2, v39
    v_mfma_f32_16x16x32_bf16 v[148:151], a[244:247], a[4:7], v[148:151]
    ds_read_b64_tr_b16 a[230:231], v41 offset:43008
    s_waitcnt lgkmcnt(4)
TICK_115:
    v_mfma_f32_16x16x32_bf16 v[136:139], a[248:251], a[0:3], v[136:139]
    ds_read_b64_tr_b16 a[232:233], v42 offset:40960
    buffer_load_dwordx4 a[68:71], v26, s[20:23], s67 offen offset:1024 sc1
    v_mfma_f32_16x16x32_bf16 v[152:155], a[248:251], a[4:7], v[152:155]
    ds_read_b64_tr_b16 a[234:235], v42 offset:43008
    s_and_b32 s3, s59, -8192
    v_mfma_f32_16x16x32_bf16 v[140:143], a[252:255], a[0:3], v[140:143]
    ds_read_b64_tr_b16 a[236:237], v43 offset:40960
    s_lshl_b32 s34, s33, 12
    v_mfma_f32_16x16x32_bf16 v[156:159], a[252:255], a[4:7], v[156:159]
    ds_read_b64_tr_b16 a[238:239], v43 offset:43008
    s_waitcnt vmcnt(16) lgkmcnt(4)
TICK_116:
    v_mfma_f32_16x16x32_bf16 v[128:131], a[224:227], a[16:19], v[128:131]
    ds_read_b64_tr_b16 a[240:241], v252 offset:40960
    v_mfma_f32_16x16x32_bf16 v[144:147], a[224:227], a[20:23], v[144:147]
    ds_read_b64_tr_b16 a[242:243], v252 offset:43008
    v_cmp_ne_u32 vcc, v30, v2
    v_mfma_f32_16x16x32_bf16 v[132:135], a[228:231], a[16:19], v[132:135]
    ds_read_b64_tr_b16 a[244:245], v253 offset:40960
    s_cbranch_vccnz SPIN_pg
BACK_pg:
    v_mfma_f32_16x16x32_bf16 v[148:151], a[228:231], a[20:23], v[148:151]
    ds_read_b64_tr_b16 a[246:247], v253 offset:43008
    s_waitcnt lgkmcnt(4)
TICK_117:
    v_mfma_f32_16x16x32_bf16 v[136:139], a[232:235], a[16:19], v[136:139]
    ds_read_b64_tr_b16 a[248:249], v254 offset:40960
    buffer_load_dwordx4 a[72:75], v34, s[20:23], s67 offen offset:0 sc1
    v_mfma_f32_16x16x32_bf16 v[152:155], a[232:235], a[20:23], v[152:155]
    ds_read_b64_tr_b16 a[250:251], v254 offset:43008
    s_add_u32 s3, s3, s34
    v_mfma_f32_16x16x32_bf16 v[140:143], a[236:239], a[16:19], v[140:143]
    ds_read_b64_tr_b16 a[252:253], v255 offset:40960
    v_lshl_add_u32 v222, v7, 4, s3
    v_mfma_f32_16x16x32_bf16 v[156:159], a[236:239], a[20:23], v[156:159]
    ds_read_b64_tr_b16 a[254:255], v255 offset:43008
    s_waitcnt vmcnt(15) lgkmcnt(4)
TICK_118:
    v_mfma_f32_16x16x32_bf16 v[128:131], a[240:243], a[24:27], v[128:131]
    ds_read_b64_tr_b16 a[224:225], v22 offset:0
    buffer_load_dwordx4 a[76:79], v34, s[20:23], s67 offen offset:1024 sc1
    v_mfma_f32_16x16x32_bf16 v[144:147], a[240:243], a[28:31], v[144:147]
    ds_read_b64_tr_b16 a[226:227], v22 offset:2048
    s_or_b32 s3, s2, s28
    v_mfma_f32_16x16x32_bf16 v[132:135], a[244:247], a[24:27], v[132:135]
    ds_read_b64_tr_b16 a[228:229], v23 offset:0
    s_mov_b32 s34, 2147483392
    v_mfma_f32_16x16x32_bf16 v[148:151], a[244:247], a[28:31], v[148:151]
    ds_read_b64_tr_b16 a[230:231], v23 offset:2048
    s_waitcnt lgkmcnt(4)
TICK_119:
    v_mfma_f32_16x16x32_bf16 v[136:139], a[248:251], a[24:27], v[136:139]
    ds_read_b64_tr_b16 a[232:233], v24 offset:0
    buffer_load_dword v36, v35, s[20:23], 0 offen sc1
    v_mfma_f32_16x16x32_bf16 v[152:155], a[248:251], a[28:31], v[152:155]
    ds_read_b64_tr_b16 a[234:235], v24 offset:2048
    v_mfma_f32_16x16x32_bf16 v[140:143], a[252:255], a[24:27], v[140:143]
    ds_read_b64_tr_b16 a[236:237], v25 offset:0
    buffer_load_dwordx4 a[80:83], v26, s[20:23], s68 offen offset:0 sc1
    v_mfma_f32_16x16x32_bf16 v[156:159], a[252:255], a[28:31], v[156:159]
    ds_read_b64_tr_b16 a[238:239], v25 offset:2048
    s_waitcnt vmcnt(16) lgkmcnt(4)
TICK_120:
    v_mfma_f32_16x16x32_bf16 v[128:131], a[224:227], a[32:35], v[128:131]
    ds_read_b64_tr_b16 a[240:241], v248 offset:0
    v_mfma_f32_16x16x32_bf16 v[144:147], a[224:227], a[36:39], v[144:147]
    ds_read_b64_tr_b16 a[242:243], v248 offset:2048
    v_mfma_f32_16x16x32_bf16 v[132:135], a[228:231], a[32:35], v[132:135]
    ds_read_b64_tr_b16 a[244:245], v249 offset:0
    s_cmp_eq_u32 s3, 0
    s_cselect_b32 s3, 11173888, s34
    v_mfma_f32_16x16x32_bf16 v[148:151], a[228:231], a[36:39], v[148:151]
    ds_read_b64_tr_b16 a[246:247], v249 offset:2048
    s_waitcnt lgkmcnt(4)
TICK_121:
    v_mfma_f32_16x16x32_bf16 v[136:139], a[232:235], a[32:35], v[136:139]
    ds_read_b64_tr_b16 a[248:249], v250 offset:0
    s_waitcnt vmcnt(7)
    v_mfma_f32_16x16x32_bf16 v[152:155], a[232:235], a[36:39], v[152:155]
    ds_read_b64_tr_b16 a[250:251], v250 offset:2048
    buffer_store_dword v30, v28, s[20:23], 0 offen offset:512
    v_mfma_f32_16x16x32_bf16 v[140:143], a[236:239], a[32:35], v[140:143]
    ds_read_b64_tr_b16 a[252:253], v251 offset:0
    v_mov_b32 v17, s3
    v_mfma_f32_16x16x32_bf16 v[156:159], a[236:239], a[36:39], v[156:159]
    ds_read_b64_tr_b16 a[254:255], v251 offset:2048
    s_waitcnt lgkmcnt(4)
TICK_122:
    v_mfma_f32_16x16x32_bf16 v[128:131], a[240:243], a[40:43], v[128:131]
    ds_read_b64_tr_b16 a[224:225], v22 offset:8192
    buffer_load_dwordx4 a[84:87], v26, s[20:23], s68 offen offset:1024 sc1
    v_mfma_f32_16x16x32_bf16 v[144:147], a[240:243], a[44:47], v[144:147]
    ds_read_b64_tr_b16 a[226:227], v22 offset:10240
    v_mov_b32 v37, 0xffff0000
    v_mfma_f32_16x16x32_bf16 v[132:135], a[244:247], a[40:43], v[132:135]
    ds_read_b64_tr_b16 a[228:229], v23 offset:8192
    buffer_load_dwordx4 a[88:91], v34, s[20:23], s68 offen offset:0 sc1
    v_mfma_f32_16x16x32_bf16 v[148:151], a[244:247], a[44:47], v[148:151]
    ds_read_b64_tr_b16 a[230:231], v23 offset:10240
    s_waitcnt lgkmcnt(4)
TICK_123:
    v_mfma_f32_16x16x32_bf16 v[136:139], a[248:251], a[40:43], v[136:139]
    ds_read_b64_tr_b16 a[232:233], v24 offset:8192
    buffer_load_dwordx4 a[92:95], v34, s[20:23], s68 offen offset:1024 sc1
    v_mfma_f32_16x16x32_bf16 v[152:155], a[248:251], a[44:47], v[152:155]
    ds_read_b64_tr_b16 a[234:235], v24 offset:10240
    v_mfma_f32_16x16x32_bf16 v[140:143], a[252:255], a[40:43], v[140:143]
    ds_read_b64_tr_b16 a[236:237], v25 offset:8192
    v_mfma_f32_16x16x32_bf16 v[156:159], a[252:255], a[44:47], v[156:159]
    ds_read_b64_tr_b16 a[238:239], v25 offset:10240
    s_waitcnt lgkmcnt(4)
TICK_124:
    v_mfma_f32_16x16x32_bf16 v[128:131], a[224:227], a[48:51], v[128:131]
    ds_read_b64_tr_b16 a[240:241], v248 offset:8192
    v_mfma_f32_16x16x32_bf16 v[144:147], a[224:227], a[52:55], v[144:147]
    ds_read_b64_tr_b16 a[242:243], v248 offset:10240
    v_mfma_f32_16x16x32_bf16 v[132:135], a[228:231], a[48:51], v[132:135]
    ds_read_b64_tr_b16 a[244:245], v249 offset:8192
    v_mfma_f32_16x16x32_bf16 v[148:151], a[228:231], a[52:55], v[148:151]
    ds_read_b64_tr_b16 a[246:247], v249 offset:10240
    s_waitcnt lgkmcnt(4)
TICK_125:
    v_mfma_f32_16x16x32_bf16 v[136:139], a[232:235], a[48:51], v[136:139]
    ds_read_b64_tr_b16 a[248:249], v250 offset:8192
    buffer_load_dwordx4 a[96:99], v26, s[20:23], s69 offen offset:0 sc1
    v_mfma_f32_16x16x32_bf16 v[152:155], a[232:235], a[52:55], v[152:155]
    ds_read_b64_tr_b16 a[250:251], v250 offset:10240
    v_mfma_f32_16x16x32_bf16 v[140:143], a[236:239], a[48:51], v[140:143]
    ds_read_b64_tr_b16 a[252:253], v251 offset:8192
    v_mfma_f32_16x16x32_bf16 v[156:159], a[236:239], a[52:55], v[156:159]
    ds_read_b64_tr_b16 a[254:255], v251 offset:10240
    s_waitcnt vmcnt(11) lgkmcnt(4)
TICK_126:
    v_mfma_f32_16x16x32_bf16 v[128:131], a[240:243], a[56:59], v[128:131]
    ds_read_b64_tr_b16 a[224:225], v22 offset:16384
    buffer_load_dwordx4 a[100:103], v26, s[20:23], s69 offen offset:1024 sc1
    v_mfma_f32_16x16x32_bf16 v[144:147], a[240:243], a[60:63], v[144:147]
    ds_read_b64_tr_b16 a[226:227], v22 offset:18432
    v_mfma_f32_16x16x32_bf16 v[132:135], a[244:247], a[56:59], v[132:135]
    ds_read_b64_tr_b16 a[228:229], v23 offset:16384
    v_mfma_f32_16x16x32_bf16 v[148:151], a[244:247], a[60:63], v[148:151]
    ds_read_b64_tr_b16 a[230:231], v23 offset:18432
    s_waitcnt lgkmcnt(4)
TICK_127:
    v_mfma_f32_16x16x32_bf16 v[136:139], a[248:251], a[56:59], v[136:139]
    ds_read_b64_tr_b16 a[232:233], v24 offset:16384
    buffer_load_dwordx4 a[104:107], v34, s[20:23], s69 offen offset:0 sc1
    v_mfma_f32_16x16x32_bf16 v[152:155], a[248:251], a[60:63], v[152:155]
    ds_read_b64_tr_b16 a[234:235], v24 offset:18432
    v_mfma_f32_16x16x32_bf16 v[140:143], a[252:255], a[56:59], v[140:143]
    ds_read_b64_tr_b16 a[236:237], v25 offset:16384
    v_mfma_f32_16x16x32_bf16 v[156:159], a[252:255], a[60:63], v[156:159]
    ds_read_b64_tr_b16 a[238:239], v25 offset:18432
    s_waitcnt vmcnt(11) lgkmcnt(4)
TICK_128:
    v_mfma_f32_16x16x32_bf16 v[128:131], a[224:227], a[64:67], v[128:131]
    ds_read_b64_tr_b16 a[240:241], v248 offset:16384
    v_mfma_f32_16x16x32_bf16 v[144:147], a[224:227], a[68:71], v[144:147]
    ds_read_b64_tr_b16 a[242:243], v248 offset:18432
    v_mfma_f32_16x16x32_bf16 v[132:135], a[228:231], a[64:67], v[132:135]
    ds_read_b64_tr_b16 a[244:245], v249 offset:16384
    v_mfma_f32_16x16x32_bf16 v[148:151], a[228:231], a[68:71], v[148:151]
    ds_read_b64_tr_b16 a[246:247], v249 offset:18432
    s_waitcnt lgkmcnt(4)
TICK_129:
    v_mfma_f32_16x16x32_bf16 v[136:139], a[232:235], a[64:67], v[136:139]
    ds_read_b64_tr_b16 a[248:249], v250 offset:16384
    buffer_load_dwordx4 a[108:111], v34, s[20:23], s69 offen offset:1024 sc1
    v_mfma_f32_16x16x32_bf16 v[152:155], a[232:235], a[68:71], v[152:155]
    ds_read_b64_tr_b16 a[250:251], v250 offset:18432
    v_mfma_f32_16x16x32_bf16 v[140:143], a[236:239], a[64:67], v[140:143]
    ds_read_b64_tr_b16 a[252:253], v251 offset:16384
    v_mfma_f32_16x16x32_bf16 v[156:159], a[236:239], a[68:71], v[156:159]
    ds_read_b64_tr_b16 a[254:255], v251 offset:18432
    s_waitcnt vmcnt(10) lgkmcnt(4)
TICK_130:
    v_mfma_f32_16x16x32_bf16 v[128:131], a[240:243], a[72:75], v[128:131]
    ds_read_b64_tr_b16 a[224:225], v22 offset:24576
    s_add_u32 m0, s31, 16384
    v_mfma_f32_16x16x32_bf16 v[144:147], a[240:243], a[76:79], v[144:147]
    ds_read_b64_tr_b16 a[226:227], v22 offset:26624
    s_waitcnt vmcnt(9)
    v_mfma_f32_16x16x32_bf16 v[132:135], a[244:247], a[72:75], v[132:135]
    ds_read_b64_tr_b16 a[228:229], v23 offset:24576
    v_and_b32 v36, 1, v36
    v_mfma_f32_16x16x32_bf16 v[148:151], a[244:247], a[76:79], v[148:151]
    ds_read_b64_tr_b16 a[230:231], v23 offset:26624
    s_waitcnt lgkmcnt(4)
TICK_131:
    v_mfma_f32_16x16x32_bf16 v[136:139], a[248:251], a[72:75], v[136:139]
    ds_read_b64_tr_b16 a[232:233], v24 offset:24576
    v_cmp_eq_u32 vcc, 0, v36
    v_mfma_f32_16x16x32_bf16 v[152:155], a[248:251], a[76:79], v[152:155]
    ds_read_b64_tr_b16 a[234:235], v24 offset:26624
    s_cbranch_vccnz SPIN_upa
BACK_upa:
    v_mfma_f32_16x16x32_bf16 v[140:143], a[252:255], a[72:75], v[140:143]
    ds_read_b64_tr_b16 a[236:237], v25 offset:24576
    s_mov_b32 s5, 0
    v_mfma_f32_16x16x32_bf16 v[156:159], a[252:255], a[76:79], v[156:159]
    ds_read_b64_tr_b16 a[238:239], v25 offset:26624
    s_waitcnt vmcnt(6) lgkmcnt(4)
TICK_132:
    v_mfma_f32_16x16x32_bf16 v[128:131], a[224:227], a[80:83], v[128:131]
    ds_read_b64_tr_b16 a[240:241], v248 offset:24576
    buffer_load_dwordx4 v33, s[20:23], s5 offen sc1 lds
    v_mfma_f32_16x16x32_bf16 v[144:147], a[224:227], a[84:87], v[144:147]
    ds_read_b64_tr_b16 a[242:243], v248 offset:26624
    s_add_u32 m0, s31, 20480
    v_mfma_f32_16x16x32_bf16 v[132:135], a[228:231], a[80:83], v[132:135]
    ds_read_b64_tr_b16 a[244:245], v249 offset:24576
    s_mov_b32 s5, 57344
    v_mfma_f32_16x16x32_bf16 v[148:151], a[228:231], a[84:87], v[148:151]
    ds_read_b64_tr_b16 a[246:247], v249 offset:26624
    s_waitcnt lgkmcnt(4)
TICK_133:
    v_mfma_f32_16x16x32_bf16 v[136:139], a[232:235], a[80:83], v[136:139]
    ds_read_b64_tr_b16 a[248:249], v250 offset:24576
    buffer_load_dwordx4 v33, s[20:23], s5 offen sc1 lds
    v_mfma_f32_16x16x32_bf16 v[152:155], a[232:235], a[84:87], v[152:155]
    ds_read_b64_tr_b16 a[250:251], v250 offset:26624
    s_add_u32 m0, s31, 24576
    v_mfma_f32_16x16x32_bf16 v[140:143], a[236:239], a[80:83], v[140:143]
    ds_read_b64_tr_b16 a[252:253], v251 offset:24576
    s_mov_b32 s5, 8192
    v_mfma_f32_16x16x32_bf16 v[156:159], a[236:239], a[84:87], v[156:159]
    ds_read_b64_tr_b16 a[254:255], v251 offset:26624
    s_waitcnt vmcnt(6) lgkmcnt(4)
TICK_134:
    v_mfma_f32_16x16x32_bf16 v[128:131], a[240:243], a[88:91], v[128:131]
    ds_read_b64_tr_b16 a[224:225], v22 offset:32768
    buffer_load_dwordx4 v33, s[20:23], s5 offen sc1 lds
    v_mfma_f32_16x16x32_bf16 v[144:147], a[240:243], a[92:95], v[144:147]
    ds_read_b64_tr_b16 a[226:227], v22 offset:34816
    s_add_u32 m0, s31, 28672
    v_mfma_f32_16x16x32_bf16 v[132:135], a[244:247], a[88:91], v[132:135]
    ds_read_b64_tr_b16 a[228:229], v23 offset:32768
    s_mov_b32 s5, 65536
    v_mfma_f32_16x16x32_bf16 v[148:151], a[244:247], a[92:95], v[148:151]
    ds_read_b64_tr_b16 a[230:231], v23 offset:34816
    s_waitcnt lgkmcnt(4)
TICK_135:
    v_mfma_f32_16x16x32_bf16 v[136:139], a[248:251], a[88:91], v[136:139]
    ds_read_b64_tr_b16 a[232:233], v24 offset:32768
    buffer_load_dwordx4 v33, s[20:23], s5 offen sc1 lds
    v_mfma_f32_16x16x32_bf16 v[152:155], a[248:251], a[92:95], v[152:155]
    ds_read_b64_tr_b16 a[234:235], v24 offset:34816
    s_buffer_load_dwordx16 s[40:55], s[20:23], s39 offset:512
    v_mfma_f32_16x16x32_bf16 v[140:143], a[252:255], a[88:91], v[140:143]
    ds_read_b64_tr_b16 a[236:237], v25 offset:32768
    s_add_u32 m0, s31, 32768
    v_mfma_f32_16x16x32_bf16 v[156:159], a[252:255], a[92:95], v[156:159]
    ds_read_b64_tr_b16 a[238:239], v25 offset:34816
    s_waitcnt vmcnt(6) lgkmcnt(4)
TICK_136:
    v_mfma_f32_16x16x32_bf16 v[128:131], a[224:227], a[96:99], v[128:131]
    ds_read_b64_tr_b16 a[240:241], v248 offset:32768
    s_mov_b32 s5, 16384
    v_mfma_f32_16x16x32_bf16 v[144:147], a[224:227], a[100:103], v[144:147]
    ds_read_b64_tr_b16 a[242:243], v248 offset:34816
    buffer_load_dwordx4 v33, s[20:23], s5 offen sc1 lds
    v_mfma_f32_16x16x32_bf16 v[132:135], a[228:231], a[96:99], v[132:135]
    ds_read_b64_tr_b16 a[244:245], v249 offset:32768
    v_mfma_f32_16x16x32_bf16 v[148:151], a[228:231], a[100:103], v[148:151]
    ds_read_b64_tr_b16 a[246:247], v249 offset:34816
    s_waitcnt lgkmcnt(4)
TICK_137:
    v_mfma_f32_16x16x32_bf16 v[136:139], a[232:235], a[96:99], v[136:139]
    ds_read_b64_tr_b16 a[248:249], v250 offset:32768
    s_add_u32 m0, s31, 36864
    v_mfma_f32_16x16x32_bf16 v[152:155], a[232:235], a[100:103], v[152:155]
    ds_read_b64_tr_b16 a[250:251], v250 offset:34816
    s_mov_b32 s5, 73728
    v_mfma_f32_16x16x32_bf16 v[140:143], a[236:239], a[96:99], v[140:143]
    ds_read_b64_tr_b16 a[252:253], v251 offset:32768
    buffer_load_dwordx4 v33, s[20:23], s5 offen sc1 lds
    v_mfma_f32_16x16x32_bf16 v[156:159], a[236:239], a[100:103], v[156:159]
    ds_read_b64_tr_b16 a[254:255], v251 offset:34816
    s_waitcnt vmcnt(6) lgkmcnt(4)
TICK_138:
    v_mfma_f32_16x16x32_bf16 v[128:131], a[240:243], a[104:107], v[128:131]
    ds_read_b64_tr_b16 a[224:225], v22 offset:40960
    s_waitcnt lgkmcnt(0)
    v_mfma_f32_16x16x32_bf16 v[144:147], a[240:243], a[108:111], v[144:147]
    ds_read_b64_tr_b16 a[226:227], v22 offset:43008
    s_atomic_swap s71, s[20:21], s30 offset:128
    s_xor_b64 s[40:41], s[40:41], s[70:71]
    s_xor_b64 s[42:43], s[42:43], s[70:71]
    s_xor_b64 s[44:45], s[44:45], s[70:71]
    s_xor_b32 s46, s46, s71
    s_or_b64 s[40:41], s[40:41], s[42:43]
    s_or_b32 s44, s44, s46
    s_or_b64 s[40:41], s[40:41], s[44:45]
    s_xor_b64 s[48:49], s[48:49], s[70:71]
    s_xor_b64 s[50:51], s[50:51], s[70:71]
    s_xor_b64 s[52:53], s[52:53], s[70:71]
    s_xor_b32 s54, s54, s71
    s_or_b64 s[48:49], s[48:49], s[50:51]
    s_or_b32 s52, s52, s54
    s_or_b64 s[48:49], s[48:49], s[52:53]
    s_or_b64 s[40:41], s[40:41], s[48:49]
    s_cbranch_scc1 SPIN_hf1
BACK_hf1:
    v_mfma_f32_16x16x32_bf16 v[132:135], a[244:247], a[104:107], v[132:135]
    ds_read_b64_tr_b16 a[228:229], v23 offset:40960
    v_add_u32 v34, 8192, v34
    v_mfma_f32_16x16x32_bf16 v[148:151], a[244:247], a[108:111], v[148:151]
    ds_read_b64_tr_b16 a[230:231], v23 offset:43008
TICK_139:
    v_mfma_f32_16x16x32_bf16 v[136:139], a[248:251], a[104:107], v[136:139]
    ds_read_b64_tr_b16 a[232:233], v24 offset:40960
    buffer_load_dwordx4 a[8:11], v34, s[20:23], s58 offen offset:0 sc1
    v_mfma_f32_16x16x32_bf16 v[152:155], a[248:251], a[108:111], v[152:155]
    ds_read_b64_tr_b16 a[234:235], v24 offset:43008
    v_mfma_f32_16x16x32_bf16 v[140:143], a[252:255], a[104:107], v[140:143]
    ds_read_b64_tr_b16 a[236:237], v25 offset:40960
    buffer_load_dwordx4 a[12:15], v34, s[20:23], s58 offen offset:1024 sc1
    v_mfma_f32_16x16x32_bf16 v[156:159], a[252:255], a[108:111], v[156:159]
    ds_read_b64_tr_b16 a[238:239], v25 offset:43008
    s_waitcnt lgkmcnt(4)
TICK_140:
    v_mfma_f32_16x16x32_bf16 v[128:131], a[224:227], v[224:227], v[128:131]
    ds_read_b64_tr_b16 a[240:241], v248 offset:40960
    v_add_u32 v26, 8192, v26
    v_mfma_f32_16x16x32_bf16 v[144:147], a[224:227], v[228:231], v[144:147]
    ds_read_b64_tr_b16 a[242:243], v248 offset:43008
    buffer_load_dwordx4 a[112:115], v26, s[20:23], s64 offen offset:0 sc1
    v_mfma_f32_16x16x32_bf16 v[132:135], a[228:231], v[224:227], v[132:135]
    ds_read_b64_tr_b16 a[244:245], v249 offset:40960
    v_mfma_f32_16x16x32_bf16 v[148:151], a[228:231], v[228:231], v[148:151]
    ds_read_b64_tr_b16 a[246:247], v249 offset:43008
    s_waitcnt lgkmcnt(4)
TICK_141:
    v_mfma_f32_16x16x32_bf16 v[136:139], a[232:235], v[224:227], v[136:139]
    ds_read_b64_tr_b16 a[248:249], v250 offset:40960
    buffer_load_dwordx4 a[116:119], v26, s[20:23], s64 offen offset:1024 sc1
    v_mfma_f32_16x16x32_bf16 v[152:155], a[232:235], v[228:231], v[152:155]
    ds_read_b64_tr_b16 a[250:251], v250 offset:43008
    v_mfma_f32_16x16x32_bf16 v[140:143], a[236:239], v[224:227], v[140:143]
    ds_read_b64_tr_b16 a[252:253], v251 offset:40960
    buffer_load_dwordx4 a[120:123], v34, s[20:23], s64 offen offset:0 sc1
    v_mfma_f32_16x16x32_bf16 v[156:159], a[236:239], v[228:231], v[156:159]
    ds_read_b64_tr_b16 a[254:255], v251 offset:43008
    s_waitcnt lgkmcnt(4)
    v_lshlrev_b32 v185, 31, v0
    v_xor_b32 v185, 0xbf800000, v185
    s_mov_b64 s[0:1], 0xffff
    v_cvt_f32_u32 v184, v38
    v_cvt_f32_u32 v186, v39
    v_mul_f32 v184, 0x3d000000, v184
    v_mul_f32 v164, v186, v184
    v_fmamk_f32 v165, v184, 0x40800000, v164
    v_fmamk_f32 v166, v184, 0x41000000, v164
    v_fmamk_f32 v167, v184, 0x41400000, v164
    v_cos_f32 v160, v164
    v_sin_f32 v164, v164
TICK_142:
    buffer_load_dwordx4 a[124:127], v34, s[20:23], s64 offen offset:1024 sc1
    v_cos_f32 v161, v165
    v_sin_f32 v165, v165
    v_cos_f32 v162, v166
    v_sin_f32 v166, v166
    v_cos_f32 v163, v167
    v_sin_f32 v167, v167
    v_cndmask_b32 v164, v164, v185, s[0:1]
TICK_143:
    buffer_load_dwordx4 a[128:131], v26, s[20:23], s65 offen offset:0 sc1
    v_cvt_pk_bf16_f32 v120, v160, -v164
    v_cvt_pk_bf16_f32 v121, v161, -v165
    v_cvt_pk_bf16_f32 v122, v162, -v166
    v_cvt_pk_bf16_f32 v123, v163, -v167
    v_add_f32 v184, 0.5, v184
    v_mul_f32 v164, v186, v184
    v_fmamk_f32 v165, v184, 0x40800000, v164
    v_fmamk_f32 v166, v184, 0x41000000, v164
    v_fmamk_f32 v167, v184, 0x41400000, v164
    v_cos_f32 v160, v164
    v_sin_f32 v164, v164
TICK_144:
    buffer_load_dwordx4 a[132:135], v26, s[20:23], s65 offen offset:1024 sc1
    v_cos_f32 v161, v165
    v_sin_f32 v165, v165
    v_cos_f32 v162, v166
    v_sin_f32 v166, v166
    v_cos_f32 v163, v167
    v_sin_f32 v167, v167
    v_cndmask_b32 v164, v164, v185, s[0:1]
TICK_145:
    buffer_load_dwordx4 a[136:139], v34, s[20:23], s65 offen offset:0 sc1
    v_cvt_pk_bf16_f32 v124, v160, -v164
    v_cvt_pk_bf16_f32 v125, v161, -v165
    v_cvt_pk_bf16_f32 v126, v162, -v166
    v_cvt_pk_bf16_f32 v127, v163, -v167
    s_waitcnt vmcnt(7)
TICK_146:
    v_mfma_f32_16x16x32_bf16 v[128:131], a[240:243], a[8:11], v[128:131]
    ds_read_b64_tr_b16 a[224:225], v22 offset:49152
    buffer_load_dwordx4 a[140:143], v34, s[20:23], s65 offen offset:1024 sc1
    v_mfma_f32_16x16x32_bf16 v[144:147], a[240:243], a[12:15], v[144:147]
    ds_read_b64_tr_b16 a[226:227], v22 offset:51200
    v_mfma_f32_16x16x32_bf16 v[132:135], a[244:247], a[8:11], v[132:135]
    ds_read_b64_tr_b16 a[228:229], v23 offset:49152
    v_mfma_f32_16x16x32_bf16 v[148:151], a[244:247], a[12:15], v[148:151]
    ds_read_b64_tr_b16 a[230:231], v23 offset:51200
    s_waitcnt lgkmcnt(4)
TICK_147:
    v_mfma_f32_16x16x32_bf16 v[136:139], a[248:251], a[8:11], v[136:139]
    ds_read_b64_tr_b16 a[232:233], v24 offset:49152
    buffer_load_dwordx4 a[144:147], v26, s[20:23], s66 offen offset:0 sc1
    v_mfma_f32_16x16x32_bf16 v[152:155], a[248:251], a[12:15], v[152:155]
    ds_read_b64_tr_b16 a[234:235], v24 offset:51200
    v_mfma_f32_16x16x32_bf16 v[140:143], a[252:255], a[8:11], v[140:143]
    ds_read_b64_tr_b16 a[236:237], v25 offset:49152
    v_mfma_f32_16x16x32_bf16 v[156:159], a[252:255], a[12:15], v[156:159]
    ds_read_b64_tr_b16 a[238:239], v25 offset:51200
    s_waitcnt vmcnt(7) lgkmcnt(4)
TICK_148:
    v_mfma_f32_16x16x32_bf16 v[128:131], a[224:227], a[112:115], v[128:131]
    ds_read_b64_tr_b16 a[240:241], v248 offset:49152
    buffer_load_dwordx4 a[148:151], v26, s[20:23], s66 offen offset:1024 sc1
    v_mfma_f32_16x16x32_bf16 v[144:147], a[224:227], a[116:119], v[144:147]
    ds_read_b64_tr_b16 a[242:243], v248 offset:51200
    v_mfma_f32_16x16x32_bf16 v[132:135], a[228:231], a[112:115], v[132:135]
    ds_read_b64_tr_b16 a[244:245], v249 offset:49152
    v_mfma_f32_16x16x32_bf16 v[148:151], a[228:231], a[116:119], v[148:151]
    ds_read_b64_tr_b16 a[246:247], v249 offset:51200
    s_waitcnt lgkmcnt(4)
TICK_149:
    v_mfma_f32_16x16x32_bf16 v[136:139], a[232:235], a[112:115], v[136:139]
    ds_read_b64_tr_b16 a[248:249], v250 offset:49152
    s_mov_b32 s56, 32768
    v_mfma_f32_16x16x32_bf16 v[152:155], a[232:235], a[116:119], v[152:155]
    ds_read_b64_tr_b16 a[250:251], v250 offset:51200
    buffer_load_dword v36, v35, s[20:23], s56 offen sc1
    v_mfma_f32_16x16x32_bf16 v[140:143], a[236:239], a[112:115], v[140:143]
    ds_read_b64_tr_b16 a[252:253], v251 offset:49152
    v_mfma_f32_16x16x32_bf16 v[156:159], a[236:239], a[116:119], v[156:159]
    ds_read_b64_tr_b16 a[254:255], v251 offset:51200
    s_waitcnt vmcnt(7) lgkmcnt(4)
TICK_150:
    v_mfma_f32_16x16x32_bf16 v[128:131], a[240:243], a[120:123], v[128:131]
    ds_read_b64_tr_b16 a[224:225], v22 offset:57344
    buffer_load_dwordx4 a[152:155], v34, s[20:23], s66 offen offset:0 sc1
    v_mfma_f32_16x16x32_bf16 v[144:147], a[240:243], a[124:127], v[144:147]
    ds_read_b64_tr_b16 a[226:227], v22 offset:59392
    v_mfma_f32_16x16x32_bf16 v[132:135], a[244:247], a[120:123], v[132:135]
    ds_read_b64_tr_b16 a[228:229], v23 offset:57344
    buffer_load_dwordx4 a[156:159], v34, s[20:23], s66 offen offset:1024 sc1
    v_mfma_f32_16x16x32_bf16 v[148:151], a[244:247], a[124:127], v[148:151]
    ds_read_b64_tr_b16 a[230:231], v23 offset:59392
    s_waitcnt lgkmcnt(4)
TICK_151:
    v_mfma_f32_16x16x32_bf16 v[136:139], a[248:251], a[120:123], v[136:139]
    ds_read_b64_tr_b16 a[232:233], v24 offset:57344
    buffer_load_dwordx4 a[160:163], v26, s[20:23], s67 offen offset:0 sc1
    v_mfma_f32_16x16x32_bf16 v[152:155], a[248:251], a[124:127], v[152:155]
    ds_read_b64_tr_b16 a[234:235], v24 offset:59392
    v_mfma_f32_16x16x32_bf16 v[140:143], a[252:255], a[120:123], v[140:143]
    ds_read_b64_tr_b16 a[236:237], v25 offset:57344
    buffer_load_dwordx4 a[164:167], v26, s[20:23], s67 offen offset:1024 sc1
    v_mfma_f32_16x16x32_bf16 v[156:159], a[252:255], a[124:127], v[156:159]
    ds_read_b64_tr_b16 a[238:239], v25 offset:59392
    s_waitcnt vmcnt(9) lgkmcnt(4)
TICK_152:
    v_mfma_f32_16x16x32_bf16 v[128:131], a[224:227], a[128:131], v[128:131]
    s_barrier
    ds_read_b64_tr_b16 a[240:241], v248 offset:57344
    v_mfma_f32_16x16x32_bf16 v[144:147], a[224:227], a[132:135], v[144:147]
    ds_read_b64_tr_b16 a[242:243], v248 offset:59392
    buffer_load_dwordx4 a[168:171], v34, s[20:23], s67 offen offset:0 sc1
    v_mfma_f32_16x16x32_bf16 v[132:135], a[228:231], a[128:131], v[132:135]
    ds_read_b64_tr_b16 a[244:245], v249 offset:57344
    v_mfma_f32_16x16x32_bf16 v[148:151], a[228:231], a[132:135], v[148:151]
    ds_read_b64_tr_b16 a[246:247], v249 offset:59392
    s_waitcnt lgkmcnt(4)
TICK_153:
    v_mfma_f32_16x16x32_bf16 v[136:139], a[232:235], a[128:131], v[136:139]
    ds_read_b64_tr_b16 a[248:249], v250 offset:57344
    buffer_load_dwordx4 a[172:175], v34, s[20:23], s67 offen offset:1024 sc1
    v_mfma_f32_16x16x32_bf16 v[152:155], a[232:235], a[132:135], v[152:155]
    ds_read_b64_tr_b16 a[250:251], v250 offset:59392
    v_mfma_f32_16x16x32_bf16 v[140:143], a[236:239], a[128:131], v[140:143]
    ds_read_b64_tr_b16 a[252:253], v251 offset:57344
    v_mfma_f32_16x16x32_bf16 v[156:159], a[236:239], a[132:135], v[156:159]
    ds_read_b64_tr_b16 a[254:255], v251 offset:59392
    s_waitcnt vmcnt(9) lgkmcnt(4)
TICK_154:
    v_mfma_f32_16x16x32_bf16 v[128:131], a[240:243], a[136:139], v[128:131]
    ds_read_b64_tr_b16 a[224:225], v40 offset:0
    buffer_load_dwordx4 a[176:179], v26, s[20:23], s68 offen offset:0 sc1
    v_mfma_f32_16x16x32_bf16 v[144:147], a[240:243], a[140:143], v[144:147]
    ds_read_b64_tr_b16 a[226:227], v40 offset:2048
    v_mfma_f32_16x16x32_bf16 v[132:135], a[244:247], a[136:139], v[132:135]
    ds_read_b64_tr_b16 a[228:229], v41 offset:0
    buffer_load_dwordx4 a[180:183], v26, s[20:23], s68 offen offset:1024 sc1
    v_mfma_f32_16x16x32_bf16 v[148:151], a[244:247], a[140:143], v[148:151]
    ds_read_b64_tr_b16 a[230:231], v41 offset:2048
    s_waitcnt lgkmcnt(4)
TICK_155:
    v_mfma_f32_16x16x32_bf16 v[136:139], a[248:251], a[136:139], v[136:139]
    ds_read_b64_tr_b16 a[232:233], v42 offset:0
    buffer_load_dwordx4 a[184:187], v34, s[20:23], s68 offen offset:0 sc1
    v_mfma_f32_16x16x32_bf16 v[152:155], a[248:251], a[140:143], v[152:155]
    ds_read_b64_tr_b16 a[234:235], v42 offset:2048
    v_mfma_f32_16x16x32_bf16 v[140:143], a[252:255], a[136:139], v[140:143]
    ds_read_b64_tr_b16 a[236:237], v43 offset:0
    v_mfma_f32_16x16x32_bf16 v[156:159], a[252:255], a[140:143], v[156:159]
    ds_read_b64_tr_b16 a[238:239], v43 offset:2048
    s_waitcnt vmcnt(10) lgkmcnt(4)
TICK_156:
    v_mfma_f32_16x16x32_bf16 v[128:131], a[224:227], a[144:147], v[128:131]
    ds_read_b64_tr_b16 a[240:241], v252 offset:0
    buffer_load_dwordx4 a[188:191], v34, s[20:23], s68 offen offset:1024 sc1
    v_mfma_f32_16x16x32_bf16 v[144:147], a[224:227], a[148:151], v[144:147]
    ds_read_b64_tr_b16 a[242:243], v252 offset:2048
    v_mfma_f32_16x16x32_bf16 v[132:135], a[228:231], a[144:147], v[132:135]
    ds_read_b64_tr_b16 a[244:245], v253 offset:0
    v_mfma_f32_16x16x32_bf16 v[148:151], a[228:231], a[148:151], v[148:151]
    ds_read_b64_tr_b16 a[246:247], v253 offset:2048
    s_waitcnt lgkmcnt(4)
TICK_157:
    v_mfma_f32_16x16x32_bf16 v[136:139], a[232:235], a[144:147], v[136:139]
    ds_read_b64_tr_b16 a[248:249], v254 offset:0
    buffer_load_dwordx4 a[192:195], v26, s[20:23], s69 offen offset:0 sc1
    v_mfma_f32_16x16x32_bf16 v[152:155], a[232:235], a[148:151], v[152:155]
    ds_read_b64_tr_b16 a[250:251], v254 offset:2048
    v_mfma_f32_16x16x32_bf16 v[140:143], a[236:239], a[144:147], v[140:143]
    ds_read_b64_tr_b16 a[252:253], v255 offset:0
    v_mfma_f32_16x16x32_bf16 v[156:159], a[236:239], a[148:151], v[156:159]
    ds_read_b64_tr_b16 a[254:255], v255 offset:2048
    s_waitcnt vmcnt(9) lgkmcnt(4)
TICK_158:
    v_mfma_f32_16x16x32_bf16 v[128:131], a[240:243], a[152:155], v[128:131]
    ds_read_b64_tr_b16 a[224:225], v40 offset:8192
    buffer_load_dwordx4 a[196:199], v26, s[20:23], s69 offen offset:1024 sc1
    v_mfma_f32_16x16x32_bf16 v[144:147], a[240:243], a[156:159], v[144:147]
    ds_read_b64_tr_b16 a[226:227], v40 offset:10240
    v_mfma_f32_16x16x32_bf16 v[132:135], a[244:247], a[152:155], v[132:135]
    ds_read_b64_tr_b16 a[228:229], v41 offset:8192
    v_mfma_f32_16x16x32_bf16 v[148:151], a[244:247], a[156:159], v[148:151]
    ds_read_b64_tr_b16 a[230:231], v41 offset:10240
    s_waitcnt lgkmcnt(4)
TICK_159:
    v_mfma_f32_16x16x32_bf16 v[136:139], a[248:251], a[152:155], v[136:139]
    ds_read_b64_tr_b16 a[232:233], v42 offset:8192
    buffer_load_dwordx4 a[200:203], v34, s[20:23], s69 offen offset:0 sc1
    v_mfma_f32_16x16x32_bf16 v[152:155], a[248:251], a[156:159], v[152:155]
    ds_read_b64_tr_b16 a[234:235], v42 offset:10240
    v_mfma_f32_16x16x32_bf16 v[140:143], a[252:255], a[152:155], v[140:143]
    ds_read_b64_tr_b16 a[236:237], v43 offset:8192
    buffer_load_dwordx4 a[204:207], v34, s[20:23], s69 offen offset:1024 sc1
    v_mfma_f32_16x16x32_bf16 v[156:159], a[252:255], a[156:159], v[156:159]
    ds_read_b64_tr_b16 a[238:239], v43 offset:10240
    s_waitcnt vmcnt(10) lgkmcnt(4)
TICK_160:
    v_mfma_f32_16x16x32_bf16 v[128:131], a[224:227], a[160:163], v[128:131]
    ds_read_b64_tr_b16 a[240:241], v252 offset:8192
    s_add_u32 m0, s31, 40960
    v_mfma_f32_16x16x32_bf16 v[144:147], a[224:227], a[164:167], v[144:147]
    ds_read_b64_tr_b16 a[242:243], v252 offset:10240
    v_mfma_f32_16x16x32_bf16 v[132:135], a[228:231], a[160:163], v[132:135]
    ds_read_b64_tr_b16 a[244:245], v253 offset:8192
    v_and_b32 v36, 1, v36
    v_mfma_f32_16x16x32_bf16 v[148:151], a[228:231], a[164:167], v[148:151]
    ds_read_b64_tr_b16 a[246:247], v253 offset:10240
    s_waitcnt lgkmcnt(4)
TICK_161:
    v_mfma_f32_16x16x32_bf16 v[136:139], a[232:235], a[160:163], v[136:139]
    ds_read_b64_tr_b16 a[248:249], v254 offset:8192
    v_cmp_eq_u32 vcc, 0, v36
    v_mfma_f32_16x16x32_bf16 v[152:155], a[232:235], a[164:167], v[152:155]
    ds_read_b64_tr_b16 a[250:251], v254 offset:10240
    s_cbranch_vccnz SPIN_upb
BACK_upb:
    v_mfma_f32_16x16x32_bf16 v[140:143], a[236:239], a[160:163], v[140:143]
    ds_read_b64_tr_b16 a[252:253], v255 offset:8192
    s_mov_b32 s5, 24576
    v_mfma_f32_16x16x32_bf16 v[156:159], a[236:239], a[164:167], v[156:159]
    ds_read_b64_tr_b16 a[254:255], v255 offset:10240
    s_waitcnt vmcnt(8) lgkmcnt(4)
TICK_162:
    v_mfma_f32_16x16x32_bf16 v[128:131], a[240:243], a[168:171], v[128:131]
    ds_read_b64_tr_b16 a[224:225], v40 offset:16384
    buffer_load_dwordx4 v33, s[20:23], s5 offen sc1 lds
    v_mfma_f32_16x16x32_bf16 v[144:147], a[240:243], a[172:175], v[144:147]
    ds_read_b64_tr_b16 a[226:227], v40 offset:18432
    s_add_u32 m0, s31, 45056
    v_mfma_f32_16x16x32_bf16 v[132:135], a[244:247], a[168:171], v[132:135]
    ds_read_b64_tr_b16 a[228:229], v41 offset:16384
    s_mov_b32 s5, 81920
    v_mfma_f32_16x16x32_bf16 v[148:151], a[244:247], a[172:175], v[148:151]
    ds_read_b64_tr_b16 a[230:231], v41 offset:18432
    s_waitcnt lgkmcnt(4)
TICK_163:
    v_mfma_f32_16x16x32_bf16 v[136:139], a[248:251], a[168:171], v[136:139]
    ds_read_b64_tr_b16 a[232:233], v42 offset:16384
    buffer_load_dwordx4 v33, s[20:23], s5 offen sc1 lds
    v_mfma_f32_16x16x32_bf16 v[152:155], a[248:251], a[172:175], v[152:155]
    ds_read_b64_tr_b16 a[234:235], v42 offset:18432
    s_add_u32 m0, s31, 49152
    v_mfma_f32_16x16x32_bf16 v[140:143], a[252:255], a[168:171], v[140:143]
    ds_read_b64_tr_b16 a[236:237], v43 offset:16384
    s_mov_b32 s5, 32768
    v_mfma_f32_16x16x32_bf16 v[156:159], a[252:255], a[172:175], v[156:159]
    ds_read_b64_tr_b16 a[238:239], v43 offset:18432
    s_waitcnt vmcnt(8) lgkmcnt(4)
TICK_164:
    v_mfma_f32_16x16x32_bf16 v[128:131], a[224:227], a[176:179], v[128:131]
    ds_read_b64_tr_b16 a[240:241], v252 offset:16384
    buffer_load_dwordx4 v33, s[20:23], s5 offen sc1 lds
    v_mfma_f32_16x16x32_bf16 v[144:147], a[224:227], a[180:183], v[144:147]
    ds_read_b64_tr_b16 a[242:243], v252 offset:18432
    s_add_u32 m0, s31, 53248
    v_mfma_f32_16x16x32_bf16 v[132:135], a[228:231], a[176:179], v[132:135]
    ds_read_b64_tr_b16 a[244:245], v253 offset:16384
    s_mov_b32 s5, 90112
    v_mfma_f32_16x16x32_bf16 v[148:151], a[228:231], a[180:183], v[148:151]
    ds_read_b64_tr_b16 a[246:247], v253 offset:18432
    s_waitcnt lgkmcnt(4)
TICK_165:
    v_mfma_f32_16x16x32_bf16 v[136:139], a[232:235], a[176:179], v[136:139]
    ds_read_b64_tr_b16 a[248:249], v254 offset:16384
    buffer_load_dwordx4 v33, s[20:23], s5 offen sc1 lds
    v_mfma_f32_16x16x32_bf16 v[152:155], a[232:235], a[180:183], v[152:155]
    ds_read_b64_tr_b16 a[250:251], v254 offset:18432
    s_add_u32 m0, s31, 57344
    v_mfma_f32_16x16x32_bf16 v[140:143], a[236:239], a[176:179], v[140:143]
    ds_read_b64_tr_b16 a[252:253], v255 offset:16384
    s_mov_b32 s5, 40960
    v_mfma_f32_16x16x32_bf16 v[156:159], a[236:239], a[180:183], v[156:159]
    ds_read_b64_tr_b16 a[254:255], v255 offset:18432
    s_waitcnt vmcnt(8) lgkmcnt(4)
TICK_166:
    v_mfma_f32_16x16x32_bf16 v[128:131], a[240:243], a[184:187], v[128:131]
    ds_read_b64_tr_b16 a[224:225], v40 offset:24576
    buffer_load_dwordx4 v33, s[20:23], s5 offen sc1 lds
    v_mfma_f32_16x16x32_bf16 v[144:147], a[240:243], a[188:191], v[144:147]
    ds_read_b64_tr_b16 a[226:227], v40 offset:26624
    v_mfma_f32_16x16x32_bf16 v[132:135], a[244:247], a[184:187], v[132:135]
    ds_read_b64_tr_b16 a[228:229], v41 offset:24576
    buffer_load_dwordx4 v[208:211], v12, s[20:23], 0 offen offset:0 sc1
    v_mfma_f32_16x16x32_bf16 v[148:151], a[244:247], a[188:191], v[148:151]
    ds_read_b64_tr_b16 a[230:231], v41 offset:26624
    s_waitcnt lgkmcnt(4)
TICK_167:
    v_mfma_f32_16x16x32_bf16 v[136:139], a[248:251], a[184:187], v[136:139]
    ds_read_b64_tr_b16 a[232:233], v42 offset:24576
    buffer_load_dwordx4 v[212:215], v12, s[20:23], 0 offen offset:16 sc1
    v_mfma_f32_16x16x32_bf16 v[152:155], a[248:251], a[188:191], v[152:155]
    ds_read_b64_tr_b16 a[234:235], v42 offset:26624
    s_add_u32 m0, s31, 61440
    v_mfma_f32_16x16x32_bf16 v[140:143], a[252:255], a[184:187], v[140:143]
    ds_read_b64_tr_b16 a[236:237], v43 offset:24576
    s_mov_b32 s5, 98304
    v_mfma_f32_16x16x32_bf16 v[156:159], a[252:255], a[188:191], v[156:159]
    ds_read_b64_tr_b16 a[238:239], v43 offset:26624
    s_waitcnt vmcnt(9) lgkmcnt(4)
TICK_168:
    v_mfma_f32_16x16x32_bf16 v[128:131], a[224:227], a[192:195], v[128:131]
    ds_read_b64_tr_b16 a[240:241], v252 offset:24576
    buffer_load_dwordx4 v33, s[20:23], s5 offen sc1 lds
    v_mfma_f32_16x16x32_bf16 v[144:147], a[224:227], a[196:199], v[144:147]
    ds_read_b64_tr_b16 a[242:243], v252 offset:26624
    s_add_u32 m0, s31, 0
    v_mfma_f32_16x16x32_bf16 v[132:135], a[228:231], a[192:195], v[132:135]
    ds_read_b64_tr_b16 a[244:245], v253 offset:24576
    s_mov_b32 s5, 49152
    v_mfma_f32_16x16x32_bf16 v[148:151], a[228:231], a[196:199], v[148:151]
    ds_read_b64_tr_b16 a[246:247], v253 offset:26624
    s_waitcnt lgkmcnt(4)
TICK_169:
    v_mfma_f32_16x16x32_bf16 v[136:139], a[232:235], a[192:195], v[136:139]
    ds_read_b64_tr_b16 a[248:249], v254 offset:24576
    buffer_load_dwordx4 v33, s[20:23], s5 offen sc1 lds
    v_mfma_f32_16x16x32_bf16 v[152:155], a[232:235], a[196:199], v[152:155]
    ds_read_b64_tr_b16 a[250:251], v254 offset:26624
    s_add_u32 m0, s31, 4096
    v_mfma_f32_16x16x32_bf16 v[140:143], a[236:239], a[192:195], v[140:143]
    ds_read_b64_tr_b16 a[252:253], v255 offset:24576
    s_mov_b32 s5, 106496
    v_mfma_f32_16x16x32_bf16 v[156:159], a[236:239], a[196:199], v[156:159]
    ds_read_b64_tr_b16 a[254:255], v255 offset:26624
    s_waitcnt vmcnt(9) lgkmcnt(4)
TICK_170:
    v_mfma_f32_16x16x32_bf16 v[128:131], a[240:243], a[200:203], v[128:131]
    ds_read_b128 v[160:163], v16 offset:16384
    buffer_load_dwordx4 v33, s[20:23], s5 offen sc1 lds
    v_mfma_f32_16x16x32_bf16 v[144:147], a[240:243], a[204:207], v[144:147]
    ds_read_b128 v[164:167], v16 offset:17408
    v_mfma_f32_16x16x32_bf16 v[132:135], a[244:247], a[200:203], v[132:135]
    ds_read_b128 v[168:171], v16 offset:18432
    v_mfma_f32_16x16x32_bf16 v[148:151], a[244:247], a[204:207], v[148:151]
    ds_read_b128 v[172:175], v16 offset:19456
    s_waitcnt lgkmcnt(4)
TICK_171:
    v_mfma_f32_16x16x32_bf16 v[136:139], a[248:251], a[200:203], v[136:139]
    ds_read_b128 v[176:179], v16 offset:20480
    v_mfma_f32_16x16x32_bf16 v[152:155], a[248:251], a[204:207], v[152:155]
    ds_read_b128 v[180:183], v16 offset:21504
    v_mfma_f32_16x16x32_bf16 v[140:143], a[252:255], a[200:203], v[140:143]
    ds_read_b128 v[184:187], v16 offset:22528
    v_mfma_f32_16x16x32_bf16 v[156:159], a[252:255], a[204:207], v[156:159]
    ds_read_b128 v[188:191], v16 offset:23552
    s_lshl_b32 m0, s33, 13
    s_cmp_eq_u32 s63, s4
    s_cbranch_scc1 L_keep
    v_cvt_pk_bf16_f32 v224, v128, v129
    v_cvt_pk_bf16_f32 v225, v130, v131
    v_cvt_pk_bf16_f32 v226, v132, v133
    v_cvt_pk_bf16_f32 v227, v134, v135
    v_min_u32 v224, -2, v224
    v_min_u32 v226, -2, v226
    buffer_store_dwordx4 v[224:227], v222, s[20:23], 0 offen offset:0 sc1
    v_cvt_pk_bf16_f32 v232, v144, v145
    v_cvt_pk_bf16_f32 v233, v146, v147
    v_cvt_pk_bf16_f32 v234, v148, v149
    v_cvt_pk_bf16_f32 v235, v150, v151
    v_min_u32 v232, -2, v232
    v_min_u32 v234, -2, v234
    buffer_store_dwordx4 v[232:235], v222, s[20:23], 0 offen offset:2048 sc1
    v_cvt_pk_bf16_f32 v228, v136, v137
    v_cvt_pk_bf16_f32 v229, v138, v139
    v_cvt_pk_bf16_f32 v230, v140, v141
    v_cvt_pk_bf16_f32 v231, v142, v143
    v_min_u32 v228, -2, v228
    v_min_u32 v230, -2, v230
    buffer_store_dwordx4 v[228:231], v222, s[20:23], 0 offen offset:1024 sc1
    v_cvt_pk_bf16_f32 v236, v152, v153
    v_cvt_pk_bf16_f32 v237, v154, v155
    v_cvt_pk_bf16_f32 v238, v156, v157
    v_cvt_pk_bf16_f32 v239, v158, v159
    v_min_u32 v236, -2, v236
    v_min_u32 v238, -2, v238
    buffer_store_dwordx4 v[236:239], v222, s[20:23], 0 offen offset:3072 sc1
    s_branch L_kept
L_keep:
    s_nop 4
    v_mov_b32 v1, 2147483392
    ds_write_addtid_b32 v128 offset:0
    ds_write_addtid_b32 v129 offset:256
    ds_write_addtid_b32 v130 offset:512
    ds_write_addtid_b32 v131 offset:768
    ds_write_addtid_b32 v144 offset:4096
    ds_write_addtid_b32 v145 offset:4352
    ds_write_addtid_b32 v146 offset:4608
    ds_write_addtid_b32 v147 offset:4864
    ds_write_addtid_b32 v132 offset:1024
    ds_write_addtid_b32 v133 offset:1280
    ds_write_addtid_b32 v134 offset:1536
    ds_write_addtid_b32 v135 offset:1792
    ds_write_addtid_b32 v148 offset:5120
    ds_write_addtid_b32 v149 offset:5376
    ds_write_addtid_b32 v150 offset:5632
    ds_write_addtid_b32 v151 offset:5888
    ds_write_addtid_b32 v136 offset:2048
    ds_write_addtid_b32 v137 offset:2304
    ds_write_addtid_b32 v138 offset:2560
    ds_write_addtid_b32 v139 offset:2816
    ds_write_addtid_b32 v152 offset:6144
    ds_write_addtid_b32 v153 offset:6400
    ds_write_addtid_b32 v154 offset:6656
    ds_write_addtid_b32 v155 offset:6912
    ds_write_addtid_b32 v140 offset:3072
    ds_write_addtid_b32 v141 offset:3328
    ds_write_addtid_b32 v142 offset:3584
    ds_write_addtid_b32 v143 offset:3840
    ds_write_addtid_b32 v156 offset:7168
    ds_write_addtid_b32 v157 offset:7424
    ds_write_addtid_b32 v158 offset:7680
    ds_write_addtid_b32 v159 offset:7936
    buffer_store_dword v1, v1, s[20:23], 0 offen
    buffer_store_dword v1, v1, s[20:23], 0 offen
    buffer_store_dword v1, v1, s[20:23], 0 offen
    buffer_store_dword v1, v1, s[20:23], 0 offen
L_kept:
    v_mov_b32 v28, 1
    s_add_u32 m0, s62, 16384
    s_mov_b32 s40, 57344
    s_mov_b32 s41, 114688
    s_mov_b32 s42, 172032
    s_waitcnt lgkmcnt(4)
TICK_172:
    v_mfma_f32_16x16x32_bf16 v[44:47], v[160:163], v[64:67], 0
    ds_read_b128 v[192:195], v16 offset:24576
    v_bitop3_b32 v28, v28, v160, v164 bitop3:0x80
    v_mfma_f32_16x16x32_bf16 v[48:51], v[164:167], v[64:67], 0
    ds_read_b128 v[196:199], v16 offset:25600
    v_bitop3_b32 v28, v28, v168, v172 bitop3:0x80
    v_mfma_f32_16x16x32_bf16 v[52:55], v[168:171], v[64:67], 0
    ds_read_b128 v[200:203], v16 offset:26624
    v_mfma_f32_16x16x32_bf16 v[56:59], v[172:175], v[64:67], 0
    ds_read_b128 v[204:207], v16 offset:27648
    s_waitcnt lgkmcnt(4)
TICK_173:
    v_mfma_f32_16x16x32_bf16 v[44:47], v[176:179], v[92:95], v[44:47]
    ds_read_b128 v[160:163], v16 offset:28672
    v_bitop3_b32 v28, v28, v176, v180 bitop3:0x80
    v_mfma_f32_16x16x32_bf16 v[48:51], v[180:183], v[92:95], v[48:51]
    ds_read_b128 v[164:167], v16 offset:29696
    v_bitop3_b32 v28, v28, v184, v188 bitop3:0x80
    v_mfma_f32_16x16x32_bf16 v[52:55], v[184:187], v[92:95], v[52:55]
    ds_read_b128 v[168:171], v16 offset:30720
    v_mfma_f32_16x16x32_bf16 v[56:59], v[188:191], v[92:95], v[56:59]
    ds_read_b128 v[172:175], v16 offset:31744
    s_waitcnt lgkmcnt(4)
TICK_174:
    v_mfma_f32_16x16x32_bf16 v[44:47], v[192:195], v[68:71], v[44:47]
    ds_read_b128 v[176:179], v16 offset:32768
    v_bitop3_b32 v28, v28, v192, v196 bitop3:0x80
    v_mfma_f32_16x16x32_bf16 v[48:51], v[196:199], v[68:71], v[48:51]
    ds_read_b128 v[180:183], v16 offset:33792
    v_bitop3_b32 v28, v28, v200, v204 bitop3:0x80
    v_mfma_f32_16x16x32_bf16 v[52:55], v[200:203], v[68:71], v[52:55]
    ds_read_b128 v[184:187], v16 offset:34816
    v_mfma_f32_16x16x32_bf16 v[56:59], v[204:207], v[68:71], v[56:59]
    ds_read_b128 v[188:191], v16 offset:35840
    s_waitcnt lgkmcnt(4)
TICK_175:
    v_mfma_f32_16x16x32_bf16 v[44:47], v[160:163], v[96:99], v[44:47]
    ds_read_b128 v[192:195], v16 offset:36864
    v_bitop3_b32 v28, v28, v160, v164 bitop3:0x80
    v_mfma_f32_16x16x32_bf16 v[48:51], v[164:167], v[96:99], v[48:51]
    ds_read_b128 v[196:199], v16 offset:37888
    v_bitop3_b32 v28, v28, v168, v172 bitop3:0x80
    v_mfma_f32_16x16x32_bf16 v[52:55], v[168:171], v[96:99], v[52:55]
    ds_read_b128 v[200:203], v16 offset:38912
    v_mfma_f32_16x16x32_bf16 v[56:59], v[172:175], v[96:99], v[56:59]
    ds_read_b128 v[204:207], v16 offset:39936
    s_waitcnt lgkmcnt(4)
    s_waitcnt vmcnt(4)
TICK_176:
    v_mfma_f32_16x16x32_bf16 v[44:47], v[176:179], v[72:75], v[44:47]
    s_barrier
    ds_read_b128 v[160:163], v16 offset:40960
    v_mfma_f32_16x16x32_bf16 v[48:51], v[180:183], v[72:75], v[48:51]
    ds_read_b128 v[164:167], v16 offset:41984
    v_bitop3_b32 v28, v28, v176, v180 bitop3:0x80
    v_mfma_f32_16x16x32_bf16 v[52:55], v[184:187], v[72:75], v[52:55]
    ds_read_b128 v[168:171], v16 offset:43008
    v_bitop3_b32 v28, v28, v184, v188 bitop3:0x80
    v_mfma_f32_16x16x32_bf16 v[56:59], v[188:191], v[72:75], v[56:59]
    ds_read_b128 v[172:175], v16 offset:44032
    s_waitcnt lgkmcnt(4)
TICK_177:
    v_mfma_f32_16x16x32_bf16 v[44:47], v[192:195], v[100:103], v[44:47]
    ds_read_b128 v[176:179], v16 offset:45056
    v_bitop3_b32 v28, v28, v192, v196 bitop3:0x80
    v_mfma_f32_16x16x32_bf16 v[48:51], v[196:199], v[100:103], v[48:51]
    ds_read_b128 v[180:183], v16 offset:46080
    v_bitop3_b32 v28, v28, v200, v204 bitop3:0x80
    v_mfma_f32_16x16x32_bf16 v[52:55], v[200:203], v[100:103], v[52:55]
    ds_read_b128 v[184:187], v16 offset:47104
    v_mfma_f32_16x16x32_bf16 v[56:59], v[204:207], v[100:103], v[56:59]
    ds_read_b128 v[188:191], v16 offset:48128
    s_waitcnt lgkmcnt(4)
TICK_178:
    v_mfma_f32_16x16x32_bf16 v[44:47], v[160:163], v[76:79], v[44:47]
    ds_read_b128 v[192:195], v16 offset:49152
    v_bitop3_b32 v28, v28, v160, v164 bitop3:0x80
    v_mfma_f32_16x16x32_bf16 v[48:51], v[164:167], v[76:79], v[48:51]
    ds_read_b128 v[196:199], v16 offset:50176
    v_bitop3_b32 v28, v28, v168, v172 bitop3:0x80
    v_mfma_f32_16x16x32_bf16 v[52:55], v[168:171], v[76:79], v[52:55]
    ds_read_b128 v[200:203], v16 offset:51200
    v_bitop3_b32 v1, v209, v211, v30 bitop3:0x7e
    v_mfma_f32_16x16x32_bf16 v[56:59], v[172:175], v[76:79], v[56:59]
    ds_read_b128 v[204:207], v16 offset:52224
    s_waitcnt lgkmcnt(4)
TICK_179:
    v_mfma_f32_16x16x32_bf16 v[44:47], v[176:179], v[104:107], v[44:47]
    ds_read_b128 v[160:163], v16 offset:53248
    v_bitop3_b32 v28, v28, v176, v180 bitop3:0x80
    v_mfma_f32_16x16x32_bf16 v[48:51], v[180:183], v[104:107], v[48:51]
    ds_read_b128 v[164:167], v16 offset:54272
    v_bitop3_b32 v28, v28, v184, v188 bitop3:0x80
    v_mfma_f32_16x16x32_bf16 v[52:55], v[184:187], v[104:107], v[52:55]
    ds_read_b128 v[168:171], v16 offset:55296
    v_bitop3_b32 v2, v213, v215, v30 bitop3:0x7e
    v_mfma_f32_16x16x32_bf16 v[56:59], v[188:191], v[104:107], v[56:59]
    ds_read_b128 v[172:175], v16 offset:56320
    s_waitcnt lgkmcnt(4)
TICK_180:
    v_mfma_f32_16x16x32_bf16 v[44:47], v[192:195], v[80:83], v[44:47]
    ds_read_b128 v[176:179], v16 offset:57344
    v_bitop3_b32 v28, v28, v192, v196 bitop3:0x80
    v_mfma_f32_16x16x32_bf16 v[48:51], v[196:199], v[80:83], v[48:51]
    ds_read_b128 v[180:183], v16 offset:58368
    v_bitop3_b32 v28, v28, v200, v204 bitop3:0x80
    v_mfma_f32_16x16x32_bf16 v[52:55], v[200:203], v[80:83], v[52:55]
    ds_read_b128 v[184:187], v16 offset:59392
    v_or_b32 v1, v1, v2
    v_mfma_f32_16x16x32_bf16 v[56:59], v[204:207], v[80:83], v[56:59]
    ds_read_b128 v[188:191], v16 offset:60416
    s_waitcnt lgkmcnt(4)
TICK_181:
    v_mfma_f32_16x16x32_bf16 v[44:47], v[160:163], v[108:111], v[44:47]
    ds_read_b128 v[192:195], v16 offset:61440
    v_bitop3_b32 v28, v28, v160, v164 bitop3:0x80
    v_mfma_f32_16x16x32_bf16 v[48:51], v[164:167], v[108:111], v[48:51]
    ds_read_b128 v[196:199], v16 offset:62464
    v_bitop3_b32 v28, v28, v168, v172 bitop3:0x80
    v_mfma_f32_16x16x32_bf16 v[52:55], v[168:171], v[108:111], v[52:55]
    ds_read_b128 v[200:203], v16 offset:63488
    v_cmp_ne_u32 vcc, 0, v1
    v_mfma_f32_16x16x32_bf16 v[56:59], v[172:175], v[108:111], v[56:59]
    ds_read_b128 v[204:207], v16 offset:64512
    s_waitcnt lgkmcnt(4)
TICK_182:
    v_mfma_f32_16x16x32_bf16 v[44:47], v[176:179], v[84:87], v[44:47]
    ds_read_b128 v[160:163], v16 offset:0
    buffer_load_dwordx2 v[240:241], v223, s[20:23], 0 offen offset:0 sc1
    v_mfma_f32_16x16x32_bf16 v[48:51], v[180:183], v[84:87], v[48:51]
    ds_read_b128 v[164:167], v16 offset:1024
    v_bitop3_b32 v28, v28, v176, v180 bitop3:0x80
    v_mfma_f32_16x16x32_bf16 v[52:55], v[184:187], v[84:87], v[52:55]
    ds_read_b128 v[168:171], v16 offset:2048
    buffer_load_dwordx2 v[242:243], v223, s[20:23], 0 offen offset:64 sc1
    v_mfma_f32_16x16x32_bf16 v[56:59], v[188:191], v[84:87], v[56:59]
    ds_read_b128 v[172:175], v16 offset:3072
    s_waitcnt lgkmcnt(4)
    v_bitop3_b32 v28, v28, v184, v188 bitop3:0x80
TICK_183:
    v_mfma_f32_16x16x32_bf16 v[44:47], v[192:195], v[112:115], v[44:47]
    ds_read_b128 v[176:179], v16 offset:4096
    buffer_load_dwordx2 v[244:245], v223, s[20:23], 0 offen offset:128 sc1
    v_mfma_f32_16x16x32_bf16 v[48:51], v[196:199], v[112:115], v[48:51]
    ds_read_b128 v[180:183], v16 offset:5120
    v_bitop3_b32 v28, v28, v192, v196 bitop3:0x80
    v_mfma_f32_16x16x32_bf16 v[52:55], v[200:203], v[112:115], v[52:55]
    ds_read_b128 v[184:187], v16 offset:6144
    buffer_load_dwordx2 v[246:247], v223, s[20:23], 0 offen offset:192 sc1
    v_mfma_f32_16x16x32_bf16 v[56:59], v[204:207], v[112:115], v[56:59]
    ds_read_b128 v[188:191], v16 offset:7168
    s_waitcnt lgkmcnt(4)
    v_bitop3_b32 v28, v28, v200, v204 bitop3:0x80
TICK_184:
    v_mfma_f32_16x16x32_bf16 v[44:47], v[160:163], v[88:91], v[44:47]
    ds_read_b128 v[128:131], v14 offset:0
    v_bitop3_b32 v28, v28, v160, v164 bitop3:0x80
    v_mfma_f32_16x16x32_bf16 v[48:51], v[164:167], v[88:91], v[48:51]
    ds_read_b128 v[132:135], v14 offset:256
    v_bitop3_b32 v28, v28, v168, v172 bitop3:0x80
    v_mfma_f32_16x16x32_bf16 v[52:55], v[168:171], v[88:91], v[52:55]
    ds_read_b128 v[136:139], v14 offset:512
    s_cbranch_vccnz SPIN_gz
BACK_gz:
    v_mfma_f32_16x16x32_bf16 v[56:59], v[172:175], v[88:91], v[56:59]
    ds_read_b128 v[140:143], v14 offset:768
    s_waitcnt lgkmcnt(4)
TICK_185:
    v_mfma_f32_16x16x32_bf16 v[44:47], v[176:179], v[116:119], v[44:47]
    v_bitop3_b32 v28, v28, v176, v180 bitop3:0x80
    v_bitop3_b32 v28, v28, v184, v188 bitop3:0x80
    v_mfma_f32_16x16x32_bf16 v[48:51], v[180:183], v[116:119], v[48:51]
    v_mov_b32 v3, 0x36124925
    v_mov_b32 v8, v208
    v_mfma_f32_16x16x32_bf16 v[52:55], v[184:187], v[116:119], v[52:55]
    v_fma_f32 v4, -v208, v3, v3
    v_mov_b32 v9, v210
    v_mfma_f32_16x16x32_bf16 v[56:59], v[188:191], v[116:119], v[56:59]
    v_fma_f32 v5, -v210, v3, v3
    v_mov_b32 v10, v212
    v_fma_f32 v6, -v212, v3, v3
    v_mov_b32 v11, v214
    v_fma_f32 v7, -v214, v3, v3
    v_cmp_eq_u32 vcc, 0, v28
    s_waitcnt lgkmcnt(0)
    s_cbranch_vccnz SPIN_u2
BACK_u2:
    v_cvt_pk_bf16_f32 v160, v44, v45
    v_cvt_pk_bf16_f32 v164, v46, v47
    v_cvt_pk_bf16_f32 v161, v48, v49
    v_cvt_pk_bf16_f32 v165, v50, v51
    v_cvt_pk_bf16_f32 v162, v52, v53
    v_cvt_pk_bf16_f32 v166, v54, v55
    v_cvt_pk_bf16_f32 v163, v56, v57
    v_cvt_pk_bf16_f32 v167, v58, v59
    s_nop 0
    v_mfma_f32_16x16x32_bf16 v[192:195], v[160:163], v[120:123], 0
    v_mfma_f32_16x16x32_bf16 v[200:203], v[164:167], v[120:123], 0
    v_mfma_f32_16x16x32_bf16 v[196:199], v[160:163], v[124:127], 0
    v_mfma_f32_16x16x32_bf16 v[204:207], v[164:167], v[124:127], 0
    v_pk_mul_f32 v[128:129], v[128:129], v[8:9]
    v_pk_mul_f32 v[130:131], v[130:131], v[10:11]
    v_pk_mul_f32 v[132:133], v[132:133], v[8:9]
    v_pk_mul_f32 v[134:135], v[134:135], v[10:11]
    v_pk_mul_f32 v[136:137], v[136:137], v[8:9]
    v_pk_mul_f32 v[138:139], v[138:139], v[10:11]
    v_pk_mul_f32 v[140:141], v[140:141], v[8:9]
    v_pk_mul_f32 v[142:143], v[142:143], v[10:11]
    ds_write_addtid_b32 v192 offset:0
    ds_write_addtid_b32 v193 offset:256
    ds_write_addtid_b32 v194 offset:512
    ds_write_addtid_b32 v195 offset:768
    ds_write_addtid_b32 v196 offset:1024
    ds_write_addtid_b32 v197 offset:1280
    ds_write_addtid_b32 v198 offset:1536
    ds_write_addtid_b32 v199 offset:1792
    ds_write_addtid_b32 v200 offset:2048
    ds_write_addtid_b32 v201 offset:2304
    ds_write_addtid_b32 v202 offset:2560
    ds_write_addtid_b32 v203 offset:2816
    ds_write_addtid_b32 v204 offset:3072
    ds_write_addtid_b32 v205 offset:3328
    ds_write_addtid_b32 v206 offset:3584
    ds_write_addtid_b32 v207 offset:3840
    s_waitcnt lgkmcnt(0)
    s_barrier
    ds_read_b128 v[144:147], v15 offset:0
    ds_read_b128 v[148:151], v15 offset:256
    ds_read_b128 v[152:155], v15 offset:512
    ds_read_b128 v[156:159], v15 offset:768
    s_waitcnt lgkmcnt(3)
    v_pk_fma_f32 v[128:129], v[144:145], v[4:5], v[128:129]
    v_pk_fma_f32 v[130:131], v[146:147], v[6:7], v[130:131]
    s_waitcnt lgkmcnt(2)
    v_pk_fma_f32 v[132:133], v[148:149], v[4:5], v[132:133]
    v_pk_fma_f32 v[134:135], v[150:151], v[6:7], v[134:135]
    s_waitcnt lgkmcnt(1)
    v_pk_fma_f32 v[136:137], v[152:153], v[4:5], v[136:137]
    v_pk_fma_f32 v[138:139], v[154:155], v[6:7], v[138:139]
    s_waitcnt lgkmcnt(0)
    v_pk_fma_f32 v[140:141], v[156:157], v[4:5], v[140:141]
    v_pk_fma_f32 v[142:143], v[158:159], v[6:7], v[142:143]
    s_waitcnt vmcnt(0)
    v_max3_u32 v1, v240, v242, v244
    v_max_u32 v1, v1, v246
    v_cmp_eq_u32 vcc, -1, v1
    s_nop 0
    s_cbranch_vccnz SPIN_px
BACK_px:
    v_lshlrev_b32 v224, 16, v240
    v_lshlrev_b32 v225, 16, v242
    v_lshlrev_b32 v226, 16, v244
    v_lshlrev_b32 v227, 16, v246
    v_pk_fma_f32 v[128:129], v[224:225], v[8:9], v[128:129]
    v_pk_fma_f32 v[130:131], v[226:227], v[10:11], v[130:131]
    v_and_b32 v228, v37, v240
    v_and_b32 v229, v37, v242
    v_and_b32 v230, v37, v244
    v_and_b32 v231, v37, v246
    v_pk_fma_f32 v[132:133], v[228:229], v[8:9], v[132:133]
    v_pk_fma_f32 v[134:135], v[230:231], v[10:11], v[134:135]
    v_cvt_pk_bf16_f32 v18, v128, v132
    v_cvt_pk_bf16_f32 v20, v129, v133
    v_cvt_pk_bf16_f32 v22, v130, v134
    v_cvt_pk_bf16_f32 v24, v131, v135
    v_lshlrev_b32 v232, 16, v241
    v_lshlrev_b32 v233, 16, v243
    v_lshlrev_b32 v234, 16, v245
    v_lshlrev_b32 v235, 16, v247
    v_pk_fma_f32 v[136:137], v[232:233], v[8:9], v[136:137]
    v_pk_fma_f32 v[138:139], v[234:235], v[10:11], v[138:139]
    v_and_b32 v236, v37, v241
    v_and_b32 v237, v37, v243
    v_and_b32 v238, v37, v245
    v_and_b32 v239, v37, v247
    v_pk_fma_f32 v[140:141], v[236:237], v[8:9], v[140:141]
    v_pk_fma_f32 v[142:143], v[238:239], v[10:11], v[142:143]
    v_cvt_pk_bf16_f32 v19, v136, v140
    buffer_store_dwordx2 v[18:19], v13, s[24:27], 0 offen
    v_cvt_pk_bf16_f32 v21, v137, v141
    buffer_store_dwordx2 v[20:21], v13, s[24:27], s40 offen
    v_cvt_pk_bf16_f32 v23, v138, v142
    buffer_store_dwordx2 v[22:23], v13, s[24:27], s41 offen
    v_cvt_pk_bf16_f32 v25, v139, v143
    buffer_store_dwordx2 v[24:25], v13, s[24:27], s42 offen
    buffer_store_dword v30, v17, s[20:23], 0 offen sc1
    s_endpgm
L_spare:
    s_lshl_b32 s29, s33, 2
    s_add_u32 s29, s29, s34
    s_sub_u32 s29, s29, 28
    s_lshr_b32 s30, s29, 1
    s_and_b32 s39, s29, 1
    v_and_b32 v1, 15, v0
    v_lshrrev_b32 v2, 4, v0
    s_cmp_eq_u32 s30, 0
    s_cselect_b32 s42, 4294966288, s30
    s_mov_b32 s41, s30
    s_cmp_ge_u32 s28, 2
    s_cselect_b32 s40, s42, s41
    s_lshl_b32 s3, s28, 9
    s_add_u32 s3, s3, s40
    v_lshl_add_u32 v3, v2, 7, s3
    s_mul_i32 s7, s39, 224
    v_mad_u32_u24 v12, v1, 14, s7
    v_xor_b32 v28, s30, v1
    v_and_b32 v28, 1, v28
    v_lshlrev_b32 v13, 1, v28
    v_sub_u32 v12, v12, v13
    v_lshlrev_b32 v28, 4, v28
    v_add_u32 v13, 0, v3
    v_sub_u32 v14, 2048, v13
    v_cmp_eq_u32 s[44:45], 0, v13
    v_mov_b32 v15, 1024
    s_nop 0
    v_cndmask_b32 v14, v14, v15, s[44:45]
    v_mul_u32_u24 v16, 450, v13
    v_mul_u32_u24 v20, 450, v14
    v_add_u32 v4, v16, v12
    v_add_u32 v8, v20, v12
    v_add_u32 v13, 32, v3
    v_sub_u32 v14, 2048, v13
    v_mul_u32_u24 v17, 450, v13
    v_mul_u32_u24 v21, 450, v14
    v_add_u32 v5, v17, v12
    v_add_u32 v9, v21, v12
    v_add_u32 v13, 64, v3
    v_sub_u32 v14, 2048, v13
    v_mul_u32_u24 v18, 450, v13
    v_mul_u32_u24 v22, 450, v14
    v_add_u32 v6, v18, v12
    v_add_u32 v10, v22, v12
    v_add_u32 v13, 96, v3
    v_sub_u32 v14, 2048, v13
    v_mul_u32_u24 v19, 450, v13
    v_mul_u32_u24 v23, 450, v14
    v_add_u32 v7, v19, v12
    v_add_u32 v11, v23, v12
    s_and_b32 s3, s28, 1
    s_lshl_b32 s3, s3, 4
    v_lshrrev_b32 v13, 3, v0
    v_add_u32 v13, s3, v13
    v_mul_u32_u24 v13, 57344, v13
    v_and_b32 v14, 7, v0
    v_xor_b32 v14, v14, v2
    v_lshlrev_b32 v254, 4, v14
    s_lshr_b32 s3, s28, 1
    s_lshl_b32 s7, s29, 1
    s_add_u32 s3, s3, s7
    s_mul_i32 s3, s3, 896
    v_add3_u32 v29, v13, v254, s3
    v_xor_b32 v254, 64, v29
    v_add_u32 v254, 457728, v254
    s_lshl_b32 s43, s28, 14
    s_add_u32 s43, s43, 98304
    s_mul_i32 s55, s39, 2147483392
    v_mov_b32 v15, 11173888
    s_waitcnt lgkmcnt(0)
    s_mov_b32 s12, s66
    s_and_b32 s13, s67, 0xffff
    s_mov_b32 s14, 921600
    s_mov_b32 s15, 0x20000
    s_mov_b32 s16, s68
    s_and_b32 s17, s69, 0xffff
    s_mov_b32 s18, 921600
    s_mov_b32 s19, 0x20000
    buffer_load_dwordx4 v[160:163], v4, s[12:15], 0 offen
    buffer_load_dwordx4 v[164:167], v4, s[16:19], 0 offen
    s_mov_b32 s8, s64
    s_and_b32 s9, s65, 0xffff
    s_mov_b32 s10, 1835008
    s_mov_b32 s11, 0x20000
    s_mov_b32 s20, s82
    s_and_b32 s21, s83, 0xffff
    s_mov_b32 s22, 13631488
    s_mov_b32 s23, 0x20000
    s_mov_b32 s24, s78
    s_and_b32 s25, s79, 0xffff
    s_mov_b32 s26, 896
    s_mov_b32 s27, 0x20000
    buffer_load_dwordx4 v[168:171], v8, s[12:15], 0 offen
    buffer_load_dwordx4 v[172:175], v8, s[16:19], 0 offen
    s_lshl_b32 s3, s28, 9
    s_add_u32 s3, s3, s40
    v_lshl_add_u32 v3, v1, 5, s3
    v_cmp_eq_u32 s[46:47], 0, v3
    v_cvt_f32_u32 v3, v3
    v_mul_f32 v33, 0x3a000000, v3
    v_lshlrev_b32 v3, 2, v2
    v_cvt_f32_u32 v35, v3
    v_mul_f32 v34, v35, v33
    s_cmp_eq_u32 s30, 0
    s_cselect_b32 s48, 0xffff, -1
    s_cselect_b32 s49, 16, 0
    s_cmp_ge_u32 s28, 2
    s_cselect_b32 s49, s49, 0
    v_mov_b32 v36, 0x3f80
    v_mov_b32 v37, 0xbf80
    buffer_load_dwordx4 v[176:179], v5, s[12:15], 0 offen
    v_fmamk_f32 v40, v33, 0x00000000, v34
    v_fmamk_f32 v41, v33, 0x3f800000, v34
    v_fmamk_f32 v42, v33, 0x40000000, v34
    v_fmamk_f32 v43, v33, 0x40400000, v34
    v_cos_f32 v44, v40
    v_sin_f32 v40, v40
    v_cos_f32 v45, v41
    v_sin_f32 v41, v41
    v_cos_f32 v46, v42
    v_sin_f32 v42, v42
    v_cos_f32 v47, v43
    v_sin_f32 v43, v43
    buffer_load_dwordx4 v[180:183], v5, s[16:19], 0 offen
    v_cvt_pk_bf16_f32 v48, v44, v40
    v_cvt_pk_bf16_f32 v52, -v40, v44
    v_cvt_pk_bf16_f32 v49, v45, v41
    v_cvt_pk_bf16_f32 v53, -v41, v45
    v_cvt_pk_bf16_f32 v50, v46, v42
    v_cvt_pk_bf16_f32 v54, -v42, v46
    v_cvt_pk_bf16_f32 v51, v47, v43
    v_cvt_pk_bf16_f32 v55, -v43, v47
    v_and_b32 v48, s48, v48
    v_and_b32 v49, s48, v49
    v_and_b32 v50, s48, v50
    v_and_b32 v51, s48, v51
    v_and_b32 v52, s48, v52
    v_and_b32 v53, s48, v53
    v_and_b32 v54, s48, v54
    v_and_b32 v55, s48, v55
    v_lshlrev_b32 v48, s49, v48
    v_lshlrev_b32 v49, s49, v49
    v_lshlrev_b32 v50, s49, v50
    v_lshlrev_b32 v51, s49, v51
    v_lshlrev_b32 v52, s49, v52
    v_lshlrev_b32 v53, s49, v53
    v_lshlrev_b32 v54, s49, v54
    v_lshlrev_b32 v55, s49, v55
    v_cndmask_b32 v52, v52, v36, s[46:47]
    v_cndmask_b32 v53, v53, v37, s[46:47]
    v_cndmask_b32 v54, v54, v36, s[46:47]
    v_cndmask_b32 v55, v55, v37, s[46:47]
    v_accvgpr_write_b32 a0, v48
    v_accvgpr_write_b32 a16, v52
    v_accvgpr_write_b32 a1, v49
    v_accvgpr_write_b32 a17, v53
    v_accvgpr_write_b32 a2, v50
    v_accvgpr_write_b32 a18, v54
    v_accvgpr_write_b32 a3, v51
    v_accvgpr_write_b32 a19, v55
    v_fmamk_f32 v40, v33, 0x41800000, v34
    v_fmamk_f32 v41, v33, 0x41880000, v34
    v_fmamk_f32 v42, v33, 0x41900000, v34
    v_fmamk_f32 v43, v33, 0x41980000, v34
    v_cos_f32 v44, v40
    v_sin_f32 v40, v40
    v_cos_f32 v45, v41
    v_sin_f32 v41, v41
    v_cos_f32 v46, v42
    v_sin_f32 v42, v42
    v_cos_f32 v47, v43
    v_sin_f32 v43, v43
    v_cvt_pk_bf16_f32 v48, v44, v40
    v_cvt_pk_bf16_f32 v52, -v40, v44
    v_cvt_pk_bf16_f32 v49, v45, v41
    v_cvt_pk_bf16_f32 v53, -v41, v45
    v_cvt_pk_bf16_f32 v50, v46, v42
    v_cvt_pk_bf16_f32 v54, -v42, v46
    v_cvt_pk_bf16_f32 v51, v47, v43
    v_cvt_pk_bf16_f32 v55, -v43, v47
    v_and_b32 v48, s48, v48
    v_and_b32 v49, s48, v49
    v_and_b32 v50, s48, v50
    v_and_b32 v51, s48, v51
    v_and_b32 v52, s48, v52
    v_and_b32 v53, s48, v53
    v_and_b32 v54, s48, v54
    v_and_b32 v55, s48, v55
    v_lshlrev_b32 v48, s49, v48
    v_lshlrev_b32 v49, s49, v49
    v_lshlrev_b32 v50, s49, v50
    v_lshlrev_b32 v51, s49, v51
    v_lshlrev_b32 v52, s49, v52
    v_lshlrev_b32 v53, s49, v53
    v_lshlrev_b32 v54, s49, v54
    v_lshlrev_b32 v55, s49, v55
    v_cndmask_b32 v52, v52, v36, s[46:47]
    v_cndmask_b32 v53, v53, v37, s[46:47]
    v_cndmask_b32 v54, v54, v36, s[46:47]
    v_cndmask_b32 v55, v55, v37, s[46:47]
    v_accvgpr_write_b32 a4, v48
    v_accvgpr_write_b32 a20, v52
    v_accvgpr_write_b32 a5, v49
    v_accvgpr_write_b32 a21, v53
    v_accvgpr_write_b32 a6, v50
    v_accvgpr_write_b32 a22, v54
    v_accvgpr_write_b32 a7, v51
    v_accvgpr_write_b32 a23, v55
    v_fmamk_f32 v40, v33, 0x42000000, v34
    v_fmamk_f32 v41, v33, 0x42040000, v34
    v_fmamk_f32 v42, v33, 0x42080000, v34
    v_fmamk_f32 v43, v33, 0x420c0000, v34
    v_cos_f32 v44, v40
    v_sin_f32 v40, v40
    v_cos_f32 v45, v41
    v_sin_f32 v41, v41
    v_cos_f32 v46, v42
    v_sin_f32 v42, v42
    v_cos_f32 v47, v43
    v_sin_f32 v43, v43
    v_cvt_pk_bf16_f32 v48, v44, v40
    v_cvt_pk_bf16_f32 v52, -v40, v44
    v_cvt_pk_bf16_f32 v49, v45, v41
    v_cvt_pk_bf16_f32 v53, -v41, v45
    v_cvt_pk_bf16_f32 v50, v46, v42
    v_cvt_pk_bf16_f32 v54, -v42, v46
    v_cvt_pk_bf16_f32 v51, v47, v43
    v_cvt_pk_bf16_f32 v55, -v43, v47
    v_and_b32 v48, s48, v48
    v_and_b32 v49, s48, v49
    v_and_b32 v50, s48, v50
    v_and_b32 v51, s48, v51
    v_and_b32 v52, s48, v52
    v_and_b32 v53, s48, v53
    v_and_b32 v54, s48, v54
    v_and_b32 v55, s48, v55
    v_lshlrev_b32 v48, s49, v48
    v_lshlrev_b32 v49, s49, v49
    v_lshlrev_b32 v50, s49, v50
    v_lshlrev_b32 v51, s49, v51
    v_lshlrev_b32 v52, s49, v52
    v_lshlrev_b32 v53, s49, v53
    v_lshlrev_b32 v54, s49, v54
    v_lshlrev_b32 v55, s49, v55
    v_cndmask_b32 v52, v52, v36, s[46:47]
    v_cndmask_b32 v53, v53, v37, s[46:47]
    v_cndmask_b32 v54, v54, v36, s[46:47]
    v_cndmask_b32 v55, v55, v37, s[46:47]
    v_accvgpr_write_b32 a8, v48
    v_accvgpr_write_b32 a24, v52
    v_accvgpr_write_b32 a9, v49
    v_accvgpr_write_b32 a25, v53
    v_accvgpr_write_b32 a10, v50
    v_accvgpr_write_b32 a26, v54
    v_accvgpr_write_b32 a11, v51
    v_accvgpr_write_b32 a27, v55
    v_fmamk_f32 v40, v33, 0x42400000, v34
    v_fmamk_f32 v41, v33, 0x42440000, v34
    v_fmamk_f32 v42, v33, 0x42480000, v34
    v_fmamk_f32 v43, v33, 0x424c0000, v34
    v_cos_f32 v44, v40
    v_sin_f32 v40, v40
    v_cos_f32 v45, v41
    v_sin_f32 v41, v41
    v_cos_f32 v46, v42
    v_sin_f32 v42, v42
    v_cos_f32 v47, v43
    v_sin_f32 v43, v43
    v_cvt_pk_bf16_f32 v48, v44, v40
    v_cvt_pk_bf16_f32 v52, -v40, v44
    v_cvt_pk_bf16_f32 v49, v45, v41
    v_cvt_pk_bf16_f32 v53, -v41, v45
    v_cvt_pk_bf16_f32 v50, v46, v42
    v_cvt_pk_bf16_f32 v54, -v42, v46
    v_cvt_pk_bf16_f32 v51, v47, v43
    v_cvt_pk_bf16_f32 v55, -v43, v47
    v_and_b32 v48, s48, v48
    v_and_b32 v49, s48, v49
    v_and_b32 v50, s48, v50
    v_and_b32 v51, s48, v51
    v_and_b32 v52, s48, v52
    v_and_b32 v53, s48, v53
    v_and_b32 v54, s48, v54
    v_and_b32 v55, s48, v55
    v_lshlrev_b32 v48, s49, v48
    v_lshlrev_b32 v49, s49, v49
    v_lshlrev_b32 v50, s49, v50
    v_lshlrev_b32 v51, s49, v51
    v_lshlrev_b32 v52, s49, v52
    v_lshlrev_b32 v53, s49, v53
    v_lshlrev_b32 v54, s49, v54
    v_lshlrev_b32 v55, s49, v55
    v_cndmask_b32 v52, v52, v36, s[46:47]
    v_cndmask_b32 v53, v53, v37, s[46:47]
    v_cndmask_b32 v54, v54, v36, s[46:47]
    v_cndmask_b32 v55, v55, v37, s[46:47]
    v_accvgpr_write_b32 a12, v48
    v_accvgpr_write_b32 a28, v52
    v_accvgpr_write_b32 a13, v49
    v_accvgpr_write_b32 a29, v53
    v_accvgpr_write_b32 a14, v50
    v_accvgpr_write_b32 a30, v54
    v_accvgpr_write_b32 a15, v51
    v_accvgpr_write_b32 a31, v55
    v_lshl_add_u32 v3, v2, 7, s41
    v_cvt_f32_i32 v34, v3
    v_and_b32 v38, 1, v0
    v_or_b32 v3, v3, v38
    v_cmp_eq_u32 s[46:47], 0, v3
    v_lshl_add_u32 v3, v2, 7, s42
    v_cvt_f32_i32 v35, v3
    v_cvt_f32_u32 v38, v38
    v_lshlrev_b32 v3, 30, v0
    v_and_b32 v3, 0x80000000, v3
    v_xor_b32 v36, 0x3f803f80, v3
    s_cmp_eq_u32 s30, 0
    s_cselect_b32 s50, 0xaaaaaaaa, 0
    s_cselect_b32 s52, 0x55555555, 0
    s_cselect_b32 s3, 0, 0xbe800000
    s_mov_b32 s51, s50
    s_mov_b32 s53, s52
    v_mul_f32 v38, s3, v38
    v_lshrrev_b32 v3, 1, v1
    s_lshl_b32 s3, s28, 4
    v_add_u32 v3, s3, v3
    v_cvt_f32_u32 v3, v3
    v_mul_f32 v33, 0x3a000000, v3
    v_fma_f32 v37, v34, v33, v38
    v_fmamk_f32 v40, v33, 0x00000000, v37
    v_fmamk_f32 v41, v33, 0x42000000, v37
    v_fmamk_f32 v42, v33, 0x42800000, v37
    v_fmamk_f32 v43, v33, 0x42c00000, v37
    v_cos_f32 v44, v40
    v_sin_f32 v40, v40
    v_cos_f32 v45, v41
    v_sin_f32 v41, v41
    v_cos_f32 v46, v42
    v_sin_f32 v42, v42
    v_cos_f32 v47, v43
    v_sin_f32 v43, v43
    v_cvt_pk_bf16_f32 v48, v44, -v40
    v_cvt_pk_bf16_f32 v49, v45, -v41
    v_cvt_pk_bf16_f32 v50, v46, -v42
    v_cvt_pk_bf16_f32 v51, v47, -v43
    v_cndmask_b32 v48, v48, v36, s[46:47]
    v_cndmask_b32 v48, v48, 0, s[50:51]
    v_cndmask_b32 v49, v49, 0, s[50:51]
    v_cndmask_b32 v50, v50, 0, s[50:51]
    v_cndmask_b32 v51, v51, 0, s[50:51]
    v_accvgpr_write_b32 a32, v48
    v_accvgpr_write_b32 a33, v49
    v_accvgpr_write_b32 a34, v50
    v_accvgpr_write_b32 a35, v51
    v_fmamk_f32 v40, v33, 0x44000000, v37
    v_fmamk_f32 v41, v33, 0x44080000, v37
    v_fmamk_f32 v42, v33, 0x44100000, v37
    v_fmamk_f32 v43, v33, 0x44180000, v37
    v_cos_f32 v44, v40
    v_sin_f32 v40, v40
    v_cos_f32 v45, v41
    v_sin_f32 v41, v41
    v_cos_f32 v46, v42
    v_sin_f32 v42, v42
    v_cos_f32 v47, v43
    v_sin_f32 v43, v43
    v_cvt_pk_bf16_f32 v48, v44, -v40
    v_cvt_pk_bf16_f32 v49, v45, -v41
    v_cvt_pk_bf16_f32 v50, v46, -v42
    v_cvt_pk_bf16_f32 v51, v47, -v43
    v_cndmask_b32 v48, v48, 0, s[50:51]
    v_cndmask_b32 v49, v49, 0, s[50:51]
    v_cndmask_b32 v50, v50, 0, s[50:51]
    v_cndmask_b32 v51, v51, 0, s[50:51]
    v_accvgpr_write_b32 a36, v48
    v_accvgpr_write_b32 a37, v49
    v_accvgpr_write_b32 a38, v50
    v_accvgpr_write_b32 a39, v51
    v_fma_f32 v37, v35, v33, v38
    v_fmamk_f32 v40, v33, 0x44800000, v37
    v_fmamk_f32 v41, v33, 0x44840000, v37
    v_fmamk_f32 v42, v33, 0x44880000, v37
    v_fmamk_f32 v43, v33, 0x448c0000, v37
    v_cos_f32 v44, v40
    v_sin_f32 v40, v40
    v_cos_f32 v45, v41
    v_sin_f32 v41, v41
    v_cos_f32 v46, v42
    v_sin_f32 v42, v42
    v_cos_f32 v47, v43
    v_sin_f32 v43, v43
    v_cvt_pk_bf16_f32 v48, v44, -v40
    v_cvt_pk_bf16_f32 v49, v45, -v41
    v_cvt_pk_bf16_f32 v50, v46, -v42
    v_cvt_pk_bf16_f32 v51, v47, -v43
    v_cndmask_b32 v48, v48, 0, s[52:53]
    v_cndmask_b32 v49, v49, 0, s[52:53]
    v_cndmask_b32 v50, v50, 0, s[52:53]
    v_cndmask_b32 v51, v51, 0, s[52:53]
    v_accvgpr_write_b32 a40, v48
    v_accvgpr_write_b32 a41, v49
    v_accvgpr_write_b32 a42, v50
    v_accvgpr_write_b32 a43, v51
    v_fmamk_f32 v40, v33, 0x44c00000, v37
    v_fmamk_f32 v41, v33, 0x44c40000, v37
    v_fmamk_f32 v42, v33, 0x44c80000, v37
    v_fmamk_f32 v43, v33, 0x44cc0000, v37
    v_cos_f32 v44, v40
    v_sin_f32 v40, v40
    v_cos_f32 v45, v41
    v_sin_f32 v41, v41
    v_cos_f32 v46, v42
    v_sin_f32 v42, v42
    v_cos_f32 v47, v43
    v_sin_f32 v43, v43
    v_cvt_pk_bf16_f32 v48, v44, -v40
    v_cvt_pk_bf16_f32 v49, v45, -v41
    v_cvt_pk_bf16_f32 v50, v46, -v42
    v_cvt_pk_bf16_f32 v51, v47, -v43
    v_cndmask_b32 v48, v48, 0, s[52:53]
    v_cndmask_b32 v49, v49, 0, s[52:53]
    v_cndmask_b32 v50, v50, 0, s[52:53]
    v_cndmask_b32 v51, v51, 0, s[52:53]
    v_accvgpr_write_b32 a44, v48
    v_accvgpr_write_b32 a45, v49
    v_accvgpr_write_b32 a46, v50
    v_accvgpr_write_b32 a47, v51
    v_add_f32 v33, 0x3b800000, v33
    v_fma_f32 v37, v34, v33, v38
    v_fmamk_f32 v40, v33, 0x00000000, v37
    v_fmamk_f32 v41, v33, 0x42000000, v37
    v_fmamk_f32 v42, v33, 0x42800000, v37
    v_fmamk_f32 v43, v33, 0x42c00000, v37
    v_cos_f32 v44, v40
    v_sin_f32 v40, v40
    v_cos_f32 v45, v41
    v_sin_f32 v41, v41
    v_cos_f32 v46, v42
    v_sin_f32 v42, v42
    v_cos_f32 v47, v43
    v_sin_f32 v43, v43
    v_cvt_pk_bf16_f32 v48, v44, -v40
    v_cvt_pk_bf16_f32 v49, v45, -v41
    v_cvt_pk_bf16_f32 v50, v46, -v42
    v_cvt_pk_bf16_f32 v51, v47, -v43
    v_cndmask_b32 v48, v48, v36, s[46:47]
    v_cndmask_b32 v48, v48, 0, s[50:51]
    v_cndmask_b32 v49, v49, 0, s[50:51]
    v_cndmask_b32 v50, v50, 0, s[50:51]
    v_cndmask_b32 v51, v51, 0, s[50:51]
    v_accvgpr_write_b32 a48, v48
    v_accvgpr_write_b32 a49, v49
    v_accvgpr_write_b32 a50, v50
    v_accvgpr_write_b32 a51, v51
    v_fmamk_f32 v40, v33, 0x44000000, v37
    v_fmamk_f32 v41, v33, 0x44080000, v37
    v_fmamk_f32 v42, v33, 0x44100000, v37
    v_fmamk_f32 v43, v33, 0x44180000, v37
    v_cos_f32 v44, v40
    v_sin_f32 v40, v40
    v_cos_f32 v45, v41
    v_sin_f32 v41, v41
    v_cos_f32 v46, v42
    v_sin_f32 v42, v42
    v_cos_f32 v47, v43
    v_sin_f32 v43, v43
    v_cvt_pk_bf16_f32 v48, v44, -v40
    v_cvt_pk_bf16_f32 v49, v45, -v41
    v_cvt_pk_bf16_f32 v50, v46, -v42
    v_cvt_pk_bf16_f32 v51, v47, -v43
    v_cndmask_b32 v48, v48, 0, s[50:51]
    v_cndmask_b32 v49, v49, 0, s[50:51]
    v_cndmask_b32 v50, v50, 0, s[50:51]
    v_cndmask_b32 v51, v51, 0, s[50:51]
    v_accvgpr_write_b32 a52, v48
    v_accvgpr_write_b32 a53, v49
    v_accvgpr_write_b32 a54, v50
    v_accvgpr_write_b32 a55, v51
    v_fma_f32 v37, v35, v33, v38
    v_fmamk_f32 v40, v33, 0x44800000, v37
    v_fmamk_f32 v41, v33, 0x44840000, v37
    v_fmamk_f32 v42, v33, 0x44880000, v37
    v_fmamk_f32 v43, v33, 0x448c0000, v37
    v_cos_f32 v44, v40
    v_sin_f32 v40, v40
    v_cos_f32 v45, v41
    v_sin_f32 v41, v41
    v_cos_f32 v46, v42
    v_sin_f32 v42, v42
    v_cos_f32 v47, v43
    v_sin_f32 v43, v43
    v_cvt_pk_bf16_f32 v48, v44, -v40
    v_cvt_pk_bf16_f32 v49, v45, -v41
    v_cvt_pk_bf16_f32 v50, v46, -v42
    v_cvt_pk_bf16_f32 v51, v47, -v43
    v_cndmask_b32 v48, v48, 0, s[52:53]
    v_cndmask_b32 v49, v49, 0, s[52:53]
    v_cndmask_b32 v50, v50, 0, s[52:53]
    v_cndmask_b32 v51, v51, 0, s[52:53]
    v_accvgpr_write_b32 a56, v48
    v_accvgpr_write_b32 a57, v49
    v_accvgpr_write_b32 a58, v50
    v_accvgpr_write_b32 a59, v51
    v_fmamk_f32 v40, v33, 0x44c00000, v37
    v_fmamk_f32 v41, v33, 0x44c40000, v37
    v_fmamk_f32 v42, v33, 0x44c80000, v37
    v_fmamk_f32 v43, v33, 0x44cc0000, v37
    v_cos_f32 v44, v40
    v_sin_f32 v40, v40
    v_cos_f32 v45, v41
    v_sin_f32 v41, v41
    v_cos_f32 v46, v42
    v_sin_f32 v42, v42
    v_cos_f32 v47, v43
    v_sin_f32 v43, v43
    v_cvt_pk_bf16_f32 v48, v44, -v40
    v_cvt_pk_bf16_f32 v49, v45, -v41
    v_cvt_pk_bf16_f32 v50, v46, -v42
    v_cvt_pk_bf16_f32 v51, v47, -v43
    v_cndmask_b32 v48, v48, 0, s[52:53]
    v_cndmask_b32 v49, v49, 0, s[52:53]
    v_cndmask_b32 v50, v50, 0, s[52:53]
    v_cndmask_b32 v51, v51, 0, s[52:53]
    v_accvgpr_write_b32 a60, v48
    v_accvgpr_write_b32 a61, v49
    v_accvgpr_write_b32 a62, v50
    v_accvgpr_write_b32 a63, v51
    v_add_u32 v34, s55, v16
    v_add_u32 v35, s55, v17
    v_add_u32 v36, s55, v18
    v_add_u32 v37, s55, v19
    v_add_u32 v38, s55, v20
    v_add_u32 v39, s55, v21
    v_add_u32 v40, s55, v22
    v_add_u32 v41, s55, v23
    buffer_load_dwordx4 v[184:187], v9, s[12:15], 0 offen
    buffer_load_dwordx4 v[188:191], v9, s[16:19], 0 offen
    buffer_load_dwordx4 v[192:195], v6, s[12:15], 0 offen
    buffer_load_dwordx4 v[196:199], v6, s[16:19], 0 offen
    buffer_load_dwordx4 v[200:203], v10, s[12:15], 0 offen
    buffer_load_dwordx4 v[204:207], v10, s[16:19], 0 offen
    buffer_load_dwordx4 v[208:211], v7, s[12:15], 0 offen
    buffer_load_dwordx4 v[212:215], v7, s[16:19], 0 offen
    buffer_load_dwordx4 v[216:219], v11, s[12:15], 0 offen
    buffer_load_dwordx4 v[220:223], v11, s[16:19], 0 offen
    buffer_load_dword v30, v15, s[20:23], 0 offen sc1
    v_mov_b32 v3, 0xffff0000
    s_waitcnt vmcnt(9)
    v_alignbit_b32 v160, v161, v160, v28
    v_alignbit_b32 v161, v162, v161, v28
    v_alignbit_b32 v162, v163, v162, v28
    v_lshrrev_b32 v163, v28, v163
    v_alignbit_b32 v164, v165, v164, v28
    v_alignbit_b32 v165, v166, v165, v28
    v_alignbit_b32 v166, v167, v166, v28
    v_lshrrev_b32 v167, v28, v167
    v_alignbit_b32 v168, v169, v168, v28
    v_alignbit_b32 v169, v170, v169, v28
    v_alignbit_b32 v170, v171, v170, v28
    v_lshrrev_b32 v171, v28, v171
    v_alignbit_b32 v172, v173, v172, v28
    v_alignbit_b32 v173, v174, v173, v28
    v_alignbit_b32 v174, v175, v174, v28
    v_lshrrev_b32 v175, v28, v175
    v_alignbit_b32 v176, v177, v176, v28
    v_alignbit_b32 v177, v178, v177, v28
    v_alignbit_b32 v178, v179, v178, v28
    v_lshrrev_b32 v179, v28, v179
    v_alignbit_b32 v180, v181, v180, v28
    v_alignbit_b32 v181, v182, v181, v28
    v_alignbit_b32 v182, v183, v182, v28
    v_lshrrev_b32 v183, v28, v183
    v_alignbit_b32 v184, v185, v184, v28
    v_alignbit_b32 v185, v186, v185, v28
    v_alignbit_b32 v186, v187, v186, v28
    v_lshrrev_b32 v187, v28, v187
    v_alignbit_b32 v188, v189, v188, v28
    v_alignbit_b32 v189, v190, v189, v28
    v_alignbit_b32 v190, v191, v190, v28
    v_lshrrev_b32 v191, v28, v191
    v_lshlrev_b32 v240, 16, v160
    v_lshlrev_b32 v241, 16, v176
    v_lshlrev_b32 v242, 16, v164
    v_lshlrev_b32 v243, 16, v180
    v_lshlrev_b32 v244, 16, v168
    v_lshlrev_b32 v245, 16, v184
    v_lshlrev_b32 v246, 16, v172
    v_lshlrev_b32 v247, 16, v188
    v_pk_add_f32 v[48:49], v[240:241], v[244:245]
    v_pk_add_f32 v[52:53], v[242:243], v[246:247] neg_lo:[0,1] neg_hi:[0,1]
    v_pk_add_f32 v[56:57], v[240:241], v[244:245] neg_lo:[0,1] neg_hi:[0,1]
    v_pk_add_f32 v[60:61], v[242:243], v[246:247]
    v_cndmask_b32 v4, v48, v244, s[44:45]
    v_cndmask_b32 v6, v60, v246, s[44:45]
    v_cndmask_b32 v48, v48, v240, s[44:45]
    v_cndmask_b32 v60, v60, v242, s[44:45]
    v_cndmask_b32 v52, v52, 0, s[44:45]
    v_cndmask_b32 v56, v56, 0, s[44:45]
    v_mov_b32 v5, v49
    v_mov_b32 v7, v61
    v_and_b32 v240, v3, v160
    v_and_b32 v241, v3, v176
    v_and_b32 v242, v3, v164
    v_and_b32 v243, v3, v180
    v_and_b32 v244, v3, v168
    v_and_b32 v245, v3, v184
    v_and_b32 v246, v3, v172
    v_and_b32 v247, v3, v188
    v_pk_add_f32 v[64:65], v[240:241], v[244:245]
    v_pk_add_f32 v[68:69], v[242:243], v[246:247] neg_lo:[0,1] neg_hi:[0,1]
    v_pk_add_f32 v[72:73], v[240:241], v[244:245] neg_lo:[0,1] neg_hi:[0,1]
    v_pk_add_f32 v[76:77], v[242:243], v[246:247]
    v_cndmask_b32 v8, v64, v244, s[44:45]
    v_cndmask_b32 v10, v76, v246, s[44:45]
    v_cndmask_b32 v64, v64, v240, s[44:45]
    v_cndmask_b32 v76, v76, v242, s[44:45]
    v_cndmask_b32 v68, v68, 0, s[44:45]
    v_cndmask_b32 v72, v72, 0, s[44:45]
    v_mov_b32 v9, v65
    v_mov_b32 v11, v77
    v_lshlrev_b32 v240, 16, v161
    v_lshlrev_b32 v241, 16, v177
    v_lshlrev_b32 v242, 16, v165
    v_lshlrev_b32 v243, 16, v181
    v_lshlrev_b32 v244, 16, v169
    v_lshlrev_b32 v245, 16, v185
    v_lshlrev_b32 v246, 16, v173
    v_lshlrev_b32 v247, 16, v189
    v_pk_add_f32 v[80:81], v[240:241], v[244:245]
    v_pk_add_f32 v[84:85], v[242:243], v[246:247] neg_lo:[0,1] neg_hi:[0,1]
    v_pk_add_f32 v[88:89], v[240:241], v[244:245] neg_lo:[0,1] neg_hi:[0,1]
    v_pk_add_f32 v[92:93], v[242:243], v[246:247]
    v_cndmask_b32 v12, v80, v244, s[44:45]
    v_cndmask_b32 v14, v92, v246, s[44:45]
    v_cndmask_b32 v80, v80, v240, s[44:45]
    v_cndmask_b32 v92, v92, v242, s[44:45]
    v_cndmask_b32 v84, v84, 0, s[44:45]
    v_cndmask_b32 v88, v88, 0, s[44:45]
    v_mov_b32 v13, v81
    v_mov_b32 v15, v93
    v_and_b32 v240, v3, v161
    v_and_b32 v241, v3, v177
    v_and_b32 v242, v3, v165
    v_and_b32 v243, v3, v181
    v_and_b32 v244, v3, v169
    v_and_b32 v245, v3, v185
    v_and_b32 v246, v3, v173
    v_and_b32 v247, v3, v189
    v_pk_add_f32 v[96:97], v[240:241], v[244:245]
    v_pk_add_f32 v[100:101], v[242:243], v[246:247] neg_lo:[0,1] neg_hi:[0,1]
    v_pk_add_f32 v[104:105], v[240:241], v[244:245] neg_lo:[0,1] neg_hi:[0,1]
    v_pk_add_f32 v[108:109], v[242:243], v[246:247]
    v_cndmask_b32 v16, v96, v244, s[44:45]
    v_cndmask_b32 v18, v108, v246, s[44:45]
    v_cndmask_b32 v96, v96, v240, s[44:45]
    v_cndmask_b32 v108, v108, v242, s[44:45]
    v_cndmask_b32 v100, v100, 0, s[44:45]
    v_cndmask_b32 v104, v104, 0, s[44:45]
    v_mov_b32 v17, v97
    v_mov_b32 v19, v109
    v_lshlrev_b32 v240, 16, v162
    v_lshlrev_b32 v241, 16, v178
    v_lshlrev_b32 v242, 16, v166
    v_lshlrev_b32 v243, 16, v182
    v_lshlrev_b32 v244, 16, v170
    v_lshlrev_b32 v245, 16, v186
    v_lshlrev_b32 v246, 16, v174
    v_lshlrev_b32 v247, 16, v190
    v_pk_add_f32 v[112:113], v[240:241], v[244:245]
    v_pk_add_f32 v[116:117], v[242:243], v[246:247] neg_lo:[0,1] neg_hi:[0,1]
    v_pk_add_f32 v[120:121], v[240:241], v[244:245] neg_lo:[0,1] neg_hi:[0,1]
    v_pk_add_f32 v[124:125], v[242:243], v[246:247]
    v_cndmask_b32 v20, v112, v244, s[44:45]
    v_cndmask_b32 v22, v124, v246, s[44:45]
    v_cndmask_b32 v112, v112, v240, s[44:45]
    v_cndmask_b32 v124, v124, v242, s[44:45]
    v_cndmask_b32 v116, v116, 0, s[44:45]
    v_cndmask_b32 v120, v120, 0, s[44:45]
    v_mov_b32 v21, v113
    v_mov_b32 v23, v125
    v_and_b32 v240, v3, v162
    v_and_b32 v241, v3, v178
    v_and_b32 v242, v3, v166
    v_and_b32 v243, v3, v182
    v_and_b32 v244, v3, v170
    v_and_b32 v245, v3, v186
    v_and_b32 v246, v3, v174
    v_and_b32 v247, v3, v190
    v_pk_add_f32 v[128:129], v[240:241], v[244:245]
    v_pk_add_f32 v[132:133], v[242:243], v[246:247] neg_lo:[0,1] neg_hi:[0,1]
    v_pk_add_f32 v[136:137], v[240:241], v[244:245] neg_lo:[0,1] neg_hi:[0,1]
    v_pk_add_f32 v[140:141], v[242:243], v[246:247]
    v_cndmask_b32 v24, v128, v244, s[44:45]
    v_cndmask_b32 v26, v140, v246, s[44:45]
    v_cndmask_b32 v128, v128, v240, s[44:45]
    v_cndmask_b32 v140, v140, v242, s[44:45]
    v_cndmask_b32 v132, v132, 0, s[44:45]
    v_cndmask_b32 v136, v136, 0, s[44:45]
    v_mov_b32 v25, v129
    v_mov_b32 v27, v141
    v_lshlrev_b32 v240, 16, v163
    v_lshlrev_b32 v241, 16, v179
    v_lshlrev_b32 v242, 16, v167
    v_lshlrev_b32 v243, 16, v183
    v_lshlrev_b32 v244, 16, v171
    v_lshlrev_b32 v245, 16, v187
    v_lshlrev_b32 v246, 16, v175
    v_lshlrev_b32 v247, 16, v191
    v_pk_add_f32 v[144:145], v[240:241], v[244:245]
    v_pk_add_f32 v[148:149], v[242:243], v[246:247] neg_lo:[0,1] neg_hi:[0,1]
    v_pk_add_f32 v[152:153], v[240:241], v[244:245] neg_lo:[0,1] neg_hi:[0,1]
    v_pk_add_f32 v[156:157], v[242:243], v[246:247]
    v_cndmask_b32 v44, v144, v244, s[44:45]
    v_cndmask_b32 v46, v156, v246, s[44:45]
    v_cndmask_b32 v144, v144, v240, s[44:45]
    v_cndmask_b32 v156, v156, v242, s[44:45]
    v_cndmask_b32 v148, v148, 0, s[44:45]
    v_cndmask_b32 v152, v152, 0, s[44:45]
    v_mov_b32 v45, v145
    v_mov_b32 v47, v157
    s_mov_b32 exec_lo, 0x10001
    s_mov_b32 exec_hi, 0x10001
    buffer_load_short_d16_hi v224, v34, s[12:15], 0 offen offset:448
    buffer_load_short_d16_hi v225, v34, s[16:19], 0 offen offset:448
    buffer_load_short_d16_hi v226, v38, s[12:15], 0 offen offset:448
    buffer_load_short_d16_hi v227, v38, s[16:19], 0 offen offset:448
    buffer_load_short_d16_hi v228, v35, s[12:15], 0 offen offset:448
    buffer_load_short_d16_hi v229, v35, s[16:19], 0 offen offset:448
    buffer_load_short_d16_hi v230, v39, s[12:15], 0 offen offset:448
    buffer_load_short_d16_hi v231, v39, s[16:19], 0 offen offset:448
    buffer_load_short_d16_hi v232, v36, s[12:15], 0 offen offset:448
    buffer_load_short_d16_hi v233, v36, s[16:19], 0 offen offset:448
    buffer_load_short_d16_hi v234, v40, s[12:15], 0 offen offset:448
    buffer_load_short_d16_hi v235, v40, s[16:19], 0 offen offset:448
    buffer_load_short_d16_hi v236, v37, s[12:15], 0 offen offset:448
    buffer_load_short_d16_hi v237, v37, s[16:19], 0 offen offset:448
    buffer_load_short_d16_hi v238, v41, s[12:15], 0 offen offset:448
    buffer_load_short_d16_hi v239, v41, s[16:19], 0 offen offset:448
    s_mov_b64 exec, -1
    s_and_b32 s3, s33, 6
    s_lshl_b32 s3, s3, 4
    s_and_b32 s7, s33, 1
    s_add_u32 s3, s3, s7
    s_lshl_b32 s3, s3, 8
    s_add_u32 s3, s3, 11075584
    v_lshl_add_u32 v252, v1, 2, v2
    v_lshl_add_u32 v252, v252, 7, s3
    s_mov_b32 exec_hi, 0
    buffer_load_dword v253, v252, s[20:23], 0 offen sc1
    s_mov_b64 exec, -1
    s_waitcnt vmcnt(17)
    v_alignbit_b32 v192, v193, v192, v28
    v_alignbit_b32 v193, v194, v193, v28
    v_alignbit_b32 v194, v195, v194, v28
    v_lshrrev_b32 v195, v28, v195
    v_alignbit_b32 v196, v197, v196, v28
    v_alignbit_b32 v197, v198, v197, v28
    v_alignbit_b32 v198, v199, v198, v28
    v_lshrrev_b32 v199, v28, v199
    v_alignbit_b32 v200, v201, v200, v28
    v_alignbit_b32 v201, v202, v201, v28
    v_alignbit_b32 v202, v203, v202, v28
    v_lshrrev_b32 v203, v28, v203
    v_alignbit_b32 v204, v205, v204, v28
    v_alignbit_b32 v205, v206, v205, v28
    v_alignbit_b32 v206, v207, v206, v28
    v_lshrrev_b32 v207, v28, v207
    v_alignbit_b32 v208, v209, v208, v28
    v_alignbit_b32 v209, v210, v209, v28
    v_alignbit_b32 v210, v211, v210, v28
    v_lshrrev_b32 v211, v28, v211
    v_alignbit_b32 v212, v213, v212, v28
    v_alignbit_b32 v213, v214, v213, v28
    v_alignbit_b32 v214, v215, v214, v28
    v_lshrrev_b32 v215, v28, v215
    v_alignbit_b32 v216, v217, v216, v28
    v_alignbit_b32 v217, v218, v217, v28
    v_alignbit_b32 v218, v219, v218, v28
    v_lshrrev_b32 v219, v28, v219
    v_alignbit_b32 v220, v221, v220, v28
    v_alignbit_b32 v221, v222, v221, v28
    v_alignbit_b32 v222, v223, v222, v28
    v_lshrrev_b32 v223, v28, v223
    v_lshlrev_b32 v240, 16, v192
    v_lshlrev_b32 v241, 16, v208
    v_lshlrev_b32 v242, 16, v196
    v_lshlrev_b32 v243, 16, v212
    v_lshlrev_b32 v244, 16, v200
    v_lshlrev_b32 v245, 16, v216
    v_lshlrev_b32 v246, 16, v204
    v_lshlrev_b32 v247, 16, v220
    v_pk_add_f32 v[50:51], v[240:241], v[244:245]
    v_pk_add_f32 v[54:55], v[242:243], v[246:247] neg_lo:[0,1] neg_hi:[0,1]
    v_pk_add_f32 v[58:59], v[240:241], v[244:245] neg_lo:[0,1] neg_hi:[0,1]
    v_pk_add_f32 v[62:63], v[242:243], v[246:247]
    v_and_b32 v240, v3, v192
    v_and_b32 v241, v3, v208
    v_and_b32 v242, v3, v196
    v_and_b32 v243, v3, v212
    v_and_b32 v244, v3, v200
    v_and_b32 v245, v3, v216
    v_and_b32 v246, v3, v204
    v_and_b32 v247, v3, v220
    v_pk_add_f32 v[66:67], v[240:241], v[244:245]
    v_pk_add_f32 v[70:71], v[242:243], v[246:247] neg_lo:[0,1] neg_hi:[0,1]
    v_pk_add_f32 v[74:75], v[240:241], v[244:245] neg_lo:[0,1] neg_hi:[0,1]
    v_pk_add_f32 v[78:79], v[242:243], v[246:247]
    v_lshlrev_b32 v240, 16, v193
    v_lshlrev_b32 v241, 16, v209
    v_lshlrev_b32 v242, 16, v197
    v_lshlrev_b32 v243, 16, v213
    v_lshlrev_b32 v244, 16, v201
    v_lshlrev_b32 v245, 16, v217
    v_lshlrev_b32 v246, 16, v205
    v_lshlrev_b32 v247, 16, v221
    v_pk_add_f32 v[82:83], v[240:241], v[244:245]
    v_pk_add_f32 v[86:87], v[242:243], v[246:247] neg_lo:[0,1] neg_hi:[0,1]
    v_pk_add_f32 v[90:91], v[240:241], v[244:245] neg_lo:[0,1] neg_hi:[0,1]
    v_pk_add_f32 v[94:95], v[242:243], v[246:247]
    v_and_b32 v240, v3, v193
    v_and_b32 v241, v3, v209
    v_and_b32 v242, v3, v197
    v_and_b32 v243, v3, v213
    v_and_b32 v244, v3, v201
    v_and_b32 v245, v3, v217
    v_and_b32 v246, v3, v205
    v_and_b32 v247, v3, v221
    v_pk_add_f32 v[98:99], v[240:241], v[244:245]
    v_pk_add_f32 v[102:103], v[242:243], v[246:247] neg_lo:[0,1] neg_hi:[0,1]
    v_pk_add_f32 v[106:107], v[240:241], v[244:245] neg_lo:[0,1] neg_hi:[0,1]
    v_pk_add_f32 v[110:111], v[242:243], v[246:247]
    v_lshlrev_b32 v240, 16, v194
    v_lshlrev_b32 v241, 16, v210
    v_lshlrev_b32 v242, 16, v198
    v_lshlrev_b32 v243, 16, v214
    v_lshlrev_b32 v244, 16, v202
    v_lshlrev_b32 v245, 16, v218
    v_lshlrev_b32 v246, 16, v206
    v_lshlrev_b32 v247, 16, v222
    v_pk_add_f32 v[114:115], v[240:241], v[244:245]
    v_pk_add_f32 v[118:119], v[242:243], v[246:247] neg_lo:[0,1] neg_hi:[0,1]
    v_pk_add_f32 v[122:123], v[240:241], v[244:245] neg_lo:[0,1] neg_hi:[0,1]
    v_pk_add_f32 v[126:127], v[242:243], v[246:247]
    v_and_b32 v240, v3, v194
    v_and_b32 v241, v3, v210
    v_and_b32 v242, v3, v198
    v_and_b32 v243, v3, v214
    v_and_b32 v244, v3, v202
    v_and_b32 v245, v3, v218
    v_and_b32 v246, v3, v206
    v_and_b32 v247, v3, v222
    v_pk_add_f32 v[130:131], v[240:241], v[244:245]
    v_pk_add_f32 v[134:135], v[242:243], v[246:247] neg_lo:[0,1] neg_hi:[0,1]
    v_pk_add_f32 v[138:139], v[240:241], v[244:245] neg_lo:[0,1] neg_hi:[0,1]
    v_pk_add_f32 v[142:143], v[242:243], v[246:247]
    v_lshlrev_b32 v240, 16, v195
    v_lshlrev_b32 v241, 16, v211
    v_lshlrev_b32 v242, 16, v199
    v_lshlrev_b32 v243, 16, v215
    v_lshlrev_b32 v244, 16, v203
    v_lshlrev_b32 v245, 16, v219
    v_lshlrev_b32 v246, 16, v207
    v_lshlrev_b32 v247, 16, v223
    v_pk_add_f32 v[146:147], v[240:241], v[244:245]
    v_pk_add_f32 v[150:151], v[242:243], v[246:247] neg_lo:[0,1] neg_hi:[0,1]
    v_pk_add_f32 v[154:155], v[240:241], v[244:245] neg_lo:[0,1] neg_hi:[0,1]
    v_pk_add_f32 v[158:159], v[242:243], v[246:247]
    s_mov_b32 s35, 0x9E3779B1
    v_mul_lo_u32 v30, v30, s35
    v_add_u32 v30, 0x7F4A7C15, v30
    v_mov_b32 v31, v30
    s_waitcnt vmcnt(0)
    v_mov_b32 v184, v224
    v_mov_b32 v185, v228
    v_mov_b32 v186, v225
    v_mov_b32 v187, v229
    v_mov_b32 v188, v226
    v_mov_b32 v189, v230
    v_mov_b32 v190, v227
    v_mov_b32 v191, v231
    v_pk_add_f32 v[160:161], v[184:185], v[188:189]
    v_pk_add_f32 v[164:165], v[186:187], v[190:191] neg_lo:[0,1] neg_hi:[0,1]
    v_pk_add_f32 v[168:169], v[184:185], v[188:189] neg_lo:[0,1] neg_hi:[0,1]
    v_pk_add_f32 v[172:173], v[186:187], v[190:191]
    v_cndmask_b32 v176, v160, v188, s[44:45]
    v_cndmask_b32 v178, v172, v190, s[44:45]
    v_cndmask_b32 v160, v160, v184, s[44:45]
    v_cndmask_b32 v172, v172, v186, s[44:45]
    v_cndmask_b32 v164, v164, 0, s[44:45]
    v_cndmask_b32 v168, v168, 0, s[44:45]
    v_mov_b32 v177, v161
    v_mov_b32 v179, v173
    v_mov_b32 v184, v232
    v_mov_b32 v185, v236
    v_mov_b32 v186, v233
    v_mov_b32 v187, v237
    v_mov_b32 v188, v234
    v_mov_b32 v189, v238
    v_mov_b32 v190, v235
    v_mov_b32 v191, v239
    v_pk_add_f32 v[162:163], v[184:185], v[188:189]
    v_pk_add_f32 v[166:167], v[186:187], v[190:191] neg_lo:[0,1] neg_hi:[0,1]
    v_pk_add_f32 v[170:171], v[184:185], v[188:189] neg_lo:[0,1] neg_hi:[0,1]
    v_pk_add_f32 v[174:175], v[186:187], v[190:191]
    v_lshl_add_u32 v192, v1, 1, s39
    v_cmp_eq_u32 s[46:47], 0, v192
    v_mov_b32 v184, 1.0
    s_nop 0
    v_cndmask_b32 v185, v184, 0.5, s[46:47]
    v_cndmask_b32 v34, v48, v160, s[46:47]
    v_cndmask_b32 v35, v49, v161, s[46:47]
    v_cndmask_b32 v36, v50, v162, s[46:47]
    v_cndmask_b32 v37, v51, v163, s[46:47]
    v_cndmask_b32 v38, v52, v164, s[46:47]
    v_cndmask_b32 v39, v53, v165, s[46:47]
    v_cndmask_b32 v40, v54, v166, s[46:47]
    v_cndmask_b32 v41, v55, v167, s[46:47]
    v_cndmask_b32 v42, v4, v176, s[46:47]
    v_cndmask_b32 v43, v5, v177, s[46:47]
    v_mul_f32 v34, v34, v185
    v_mul_f32 v35, v35, v185
    v_mul_f32 v36, v36, v185
    v_mul_f32 v37, v37, v185
    v_mul_f32 v38, v38, v185
    v_mul_f32 v39, v39, v185
    v_mul_f32 v40, v40, v185
    v_mul_f32 v41, v41, v185
    v_mul_f32 v42, v42, v185
    v_mul_f32 v43, v43, v185
    v_mul_f32 v48, v48, v185
    v_mul_f32 v49, v49, v185
    v_mul_f32 v50, v50, v185
    v_mul_f32 v51, v51, v185
    v_mul_f32 v52, v52, v185
    v_mul_f32 v53, v53, v185
    v_mul_f32 v54, v54, v185
    v_mul_f32 v55, v55, v185
    v_mul_f32 v4, v4, v185
    v_mul_f32 v5, v5, v185
    v_cndmask_b32 v56, v56, 0, s[46:47]
    v_cndmask_b32 v57, v57, 0, s[46:47]
    v_cndmask_b32 v58, v58, 0, s[46:47]
    v_cndmask_b32 v59, v59, 0, s[46:47]
    v_cndmask_b32 v60, v60, 0, s[46:47]
    v_cndmask_b32 v61, v61, 0, s[46:47]
    v_cndmask_b32 v62, v62, 0, s[46:47]
    v_cndmask_b32 v63, v63, 0, s[46:47]
    v_cndmask_b32 v6, v6, 0, s[46:47]
    v_cndmask_b32 v7, v7, 0, s[46:47]
    v_bfe_u32 v3, v0, 3, 2
    v_mul_u32_u24 v3, 1792, v3
    v_and_b32 v244, 7, v0
    v_min_u32 v244, 6, v244
    v_lshl_add_u32 v3, v244, 7, v3
    s_mul_i32 s3, s39, 896
    s_mul_i32 s7, s28, 7168
    s_add_u32 s3, s3, s7
    s_add_u32 s3, s3, 11108352
    v_add_u32 v244, s3, v3
    s_mul_i32 s3, s30, 14
    s_mul_i32 s7, s39, 7
    s_add_u32 s3, s3, s7
    s_lshl_b32 s3, s3, 13
    s_lshl_b32 s4, s28, 11
    s_add_u32 s3, s3, s4
    s_add_u32 s5, s3, 7340032
    v_add_u32 v246, s5, v32
    v_lshlrev_b32 v3, 4, v1
    v_lshl_add_u32 v3, v2, 9, v3
    v_and_b32 v248, 1, v2
    v_lshl_add_u32 v248, v248, 3, v3
    v_xor_b32 v249, 8, v248
    v_add_u32 v33, 65536, v32
    v_add_u32 v250, s4, v33
    v_lshrrev_b32 v3, 2, v1
    v_lshl_add_u32 v3, v3, 2, v2
    v_and_b32 v251, 3, v0
    v_lshl_add_u32 v3, v3, 2, v251
    v_lshl_add_u32 v251, v3, 4, s5
    s_lshl_b32 s3, s29, 9
    s_lshl_b32 s7, s28, 7
    s_add_u32 s3, s3, s7
    s_add_u32 s3, s3, 11010048
    v_lshl_add_u32 v3, v0, 3, s3
    v_lshrrev_b32 v240, 1, v1
    v_xor_b32 v240, v240, v2
    v_lshlrev_b32 v241, 7, v1
    v_lshl_add_u32 v240, v240, 4, v241
    v_add_u32 v240, s43, v240
    v_xor_b32 v241, 64, v240
    v_lshl_add_u32 v242, v2, 4, s43
    s_getpc_b64 s[6:7]
L_pc2:
    s_add_u32 s6, s6, L_end-L_pc2-4
    s_addc_u32 s7, s7, 0
    s_lshl_b32 s3, s28, 13
    v_lshl_add_u32 v222, v0, 7, s3
    v_min_u32 v222, L_end-L_begin-4, v222
    v_sub_u32 v222, 0, v222
    v_ashrrev_i32 v223, 31, v222
    v_lshl_add_u64 v[222:223], v[222:223], 0, s[6:7]
    global_load_dword v255, v[222:223], off
    s_mov_b32 s38, 0
    s_mov_b32 exec_hi, 0
L_u1poll:
    buffer_load_dword v168, v244, s[20:23], 0 offen sc1
    s_add_u32 s38, s38, 1
    s_waitcnt vmcnt(0)
    v_cmp_ne_u32 vcc, v30, v168
    s_nop 0
    s_cbranch_vccz L_u1ok
    s_cmp_lt_u32 s38, 200000
    s_cbranch_scc1 L_u1poll
L_u1ok:
    s_mov_b32 exec_hi, -1
    s_waitcnt vmcnt(0)
    s_add_u32 m0, s4, 0
    s_mov_b32 s7, 0
    buffer_load_dwordx4 v246, s[20:23], s7 offen offset:0 sc1 lds
    buffer_load_dwordx4 v246, s[20:23], s7 offen offset:1024 sc1 lds
    s_add_u32 m0, s4, 8192
    s_mov_b32 s7, 8192
    buffer_load_dwordx4 v246, s[20:23], s7 offen offset:0 sc1 lds
    buffer_load_dwordx4 v246, s[20:23], s7 offen offset:1024 sc1 lds
    s_add_u32 m0, s4, 16384
    s_mov_b32 s7, 16384
    buffer_load_dwordx4 v246, s[20:23], s7 offen offset:0 sc1 lds
    buffer_load_dwordx4 v246, s[20:23], s7 offen offset:1024 sc1 lds
    s_add_u32 m0, s4, 24576
    s_mov_b32 s7, 24576
    buffer_load_dwordx4 v246, s[20:23], s7 offen offset:0 sc1 lds
    buffer_load_dwordx4 v246, s[20:23], s7 offen offset:1024 sc1 lds
    s_add_u32 m0, s4, 32768
    s_mov_b32 s7, 32768
    buffer_load_dwordx4 v246, s[20:23], s7 offen offset:0 sc1 lds
    buffer_load_dwordx4 v246, s[20:23], s7 offen offset:1024 sc1 lds
    s_add_u32 m0, s4, 40960
    s_mov_b32 s7, 40960
    buffer_load_dwordx4 v246, s[20:23], s7 offen offset:0 sc1 lds
    buffer_load_dwordx4 v246, s[20:23], s7 offen offset:1024 sc1 lds
    s_add_u32 m0, s4, 49152
    s_mov_b32 s7, 49152
    buffer_load_dwordx4 v246, s[20:23], s7 offen offset:0 sc1 lds
    buffer_load_dwordx4 v246, s[20:23], s7 offen offset:1024 sc1 lds
    s_mov_b32 s56, 0
    s_mov_b32 s57, 8192
    s_mov_b32 s58, 16384
    s_mov_b32 s59, 24576
    s_mov_b32 s60, 32768
    s_mov_b32 s61, 40960
    s_mov_b32 s62, 49152
    s_waitcnt vmcnt(10)
    s_barrier
    ds_read_b64_tr_b16 a[64:65], v248 offset:0
    ds_read_b64_tr_b16 a[66:67], v248 offset:256
    ds_read_b64_tr_b16 a[68:69], v249 offset:0
    ds_read_b64_tr_b16 a[70:71], v249 offset:256
    ds_read_b64_tr_b16 a[72:73], v248 offset:2048
    ds_read_b64_tr_b16 a[74:75], v248 offset:2304
    ds_read_b64_tr_b16 a[76:77], v249 offset:2048
    ds_read_b64_tr_b16 a[78:79], v249 offset:2304
    ds_read_b64_tr_b16 a[80:81], v248 offset:4096
    ds_read_b64_tr_b16 a[82:83], v248 offset:4352
    ds_read_b64_tr_b16 a[84:85], v249 offset:4096
    ds_read_b64_tr_b16 a[86:87], v249 offset:4352
    ds_read_b64_tr_b16 a[88:89], v248 offset:6144
    ds_read_b64_tr_b16 a[90:91], v248 offset:6400
    ds_read_b64_tr_b16 a[92:93], v249 offset:6144
    ds_read_b64_tr_b16 a[94:95], v249 offset:6400
    s_waitcnt lgkmcnt(12)
    v_mfma_f32_16x16x32_bf16 v[160:163], a[0:3], a[64:67], 0
    ds_read_b64_tr_b16 a[96:97], v248 offset:8192
    ds_read_b64_tr_b16 a[98:99], v248 offset:8448
    v_mfma_f32_16x16x32_bf16 v[164:167], a[16:19], a[64:67], 0
    ds_read_b64_tr_b16 a[100:101], v249 offset:8192
    ds_read_b64_tr_b16 a[102:103], v249 offset:8448
    v_mfma_f32_16x16x32_bf16 v[168:171], a[0:3], a[68:71], 0
    ds_read_b64_tr_b16 a[104:105], v248 offset:10240
    ds_read_b64_tr_b16 a[106:107], v248 offset:10496
    v_mfma_f32_16x16x32_bf16 v[172:175], a[16:19], a[68:71], 0
    ds_read_b64_tr_b16 a[108:109], v249 offset:10240
    ds_read_b64_tr_b16 a[110:111], v249 offset:10496
    s_waitcnt lgkmcnt(14)
    v_mfma_f32_16x16x32_bf16 v[160:163], a[4:7], a[72:75], v[160:163]
    ds_read_b64_tr_b16 a[112:113], v248 offset:12288
    ds_read_b64_tr_b16 a[114:115], v248 offset:12544
    v_mfma_f32_16x16x32_bf16 v[164:167], a[20:23], a[72:75], v[164:167]
    ds_read_b64_tr_b16 a[116:117], v249 offset:12288
    ds_read_b64_tr_b16 a[118:119], v249 offset:12544
    v_mfma_f32_16x16x32_bf16 v[168:171], a[4:7], a[76:79], v[168:171]
    ds_read_b64_tr_b16 a[120:121], v248 offset:14336
    ds_read_b64_tr_b16 a[122:123], v248 offset:14592
    v_mfma_f32_16x16x32_bf16 v[172:175], a[20:23], a[76:79], v[172:175]
    ds_read_b64_tr_b16 a[124:125], v249 offset:14336
    ds_read_b64_tr_b16 a[126:127], v249 offset:14592
    s_waitcnt lgkmcnt(14)
    v_mfma_f32_16x16x32_bf16 v[160:163], a[8:11], a[80:83], v[160:163]
    v_mfma_f32_16x16x32_bf16 v[164:167], a[24:27], a[80:83], v[164:167]
    v_mfma_f32_16x16x32_bf16 v[168:171], a[8:11], a[84:87], v[168:171]
    v_mfma_f32_16x16x32_bf16 v[172:175], a[24:27], a[84:87], v[172:175]
    v_mfma_f32_16x16x32_bf16 v[160:163], a[12:15], a[88:91], v[160:163]
    v_mfma_f32_16x16x32_bf16 v[164:167], a[28:31], a[88:91], v[164:167]
    v_mfma_f32_16x16x32_bf16 v[168:171], a[12:15], a[92:95], v[168:171]
    v_mfma_f32_16x16x32_bf16 v[172:175], a[28:31], a[92:95], v[172:175]
    s_nop 4
    v_pk_mul_f32 v[176:177], v[48:49], v[160:161]
    v_pk_mul_f32 v[180:181], v[52:53], v[160:161]
    v_pk_mul_f32 v[184:185], v[34:35], v[168:169]
    v_pk_mul_f32 v[188:189], v[38:39], v[168:169]
    v_pk_fma_f32 v[176:177], v[52:53], v[164:165], v[176:177] neg_lo:[1,0,0] neg_hi:[1,0,0]
    v_pk_fma_f32 v[180:181], v[4:5], v[164:165], v[180:181]
    v_pk_fma_f32 v[184:185], v[38:39], v[172:173], v[184:185] neg_lo:[1,0,0] neg_hi:[1,0,0]
    v_pk_fma_f32 v[188:189], v[42:43], v[172:173], v[188:189]
    v_pk_fma_f32 v[176:177], v[60:61], v[168:169], v[176:177] neg_lo:[1,0,0] neg_hi:[1,0,0]
    v_pk_fma_f32 v[180:181], v[56:57], v[168:169], v[180:181]
    v_pk_fma_f32 v[184:185], v[60:61], v[160:161], v[184:185]
    v_pk_fma_f32 v[188:189], v[56:57], v[160:161], v[188:189] neg_lo:[1,0,0] neg_hi:[1,0,0]
    v_pk_fma_f32 v[176:177], v[56:57], v[172:173], v[176:177] neg_lo:[1,0,0] neg_hi:[1,0,0]
    v_pk_fma_f32 v[180:181], v[6:7], v[172:173], v[180:181] neg_lo:[1,0,0] neg_hi:[1,0,0]
    v_pk_fma_f32 v[184:185], v[56:57], v[164:165], v[184:185]
    v_pk_fma_f32 v[188:189], v[6:7], v[164:165], v[188:189]
    v_pk_mul_f32 v[178:179], v[50:51], v[162:163]
    v_pk_mul_f32 v[182:183], v[54:55], v[162:163]
    v_pk_mul_f32 v[186:187], v[36:37], v[170:171]
    v_pk_mul_f32 v[190:191], v[40:41], v[170:171]
    v_pk_fma_f32 v[178:179], v[54:55], v[166:167], v[178:179] neg_lo:[1,0,0] neg_hi:[1,0,0]
    v_pk_fma_f32 v[182:183], v[50:51], v[166:167], v[182:183]
    v_pk_fma_f32 v[186:187], v[40:41], v[174:175], v[186:187] neg_lo:[1,0,0] neg_hi:[1,0,0]
    v_pk_fma_f32 v[190:191], v[36:37], v[174:175], v[190:191]
    v_pk_fma_f32 v[178:179], v[62:63], v[170:171], v[178:179] neg_lo:[1,0,0] neg_hi:[1,0,0]
    v_pk_fma_f32 v[182:183], v[58:59], v[170:171], v[182:183]
    v_pk_fma_f32 v[186:187], v[62:63], v[162:163], v[186:187]
    v_pk_fma_f32 v[190:191], v[58:59], v[162:163], v[190:191] neg_lo:[1,0,0] neg_hi:[1,0,0]
    v_pk_fma_f32 v[178:179], v[58:59], v[174:175], v[178:179] neg_lo:[1,0,0] neg_hi:[1,0,0]
    v_pk_fma_f32 v[182:183], v[62:63], v[174:175], v[182:183] neg_lo:[1,0,0] neg_hi:[1,0,0]
    v_pk_fma_f32 v[186:187], v[58:59], v[166:167], v[186:187]
    v_pk_fma_f32 v[190:191], v[62:63], v[166:167], v[190:191]
    s_waitcnt lgkmcnt(0)
    v_mfma_f32_16x16x32_bf16 v[160:163], a[0:3], a[96:99], 0
    s_waitcnt vmcnt(6) lgkmcnt(0)
    s_barrier
    v_mfma_f32_16x16x32_bf16 v[164:167], a[16:19], a[96:99], 0
    ds_read_b64_tr_b16 a[64:65], v248 offset:16384
    v_cvt_pk_bf16_f32 v192, v176, v180
    v_mfma_f32_16x16x32_bf16 v[168:171], a[0:3], a[100:103], 0
    ds_read_b64_tr_b16 a[66:67], v248 offset:16640
    v_cvt_pk_bf16_f32 v193, v177, v181
    v_mfma_f32_16x16x32_bf16 v[172:175], a[16:19], a[100:103], 0
    ds_read_b64_tr_b16 a[68:69], v249 offset:16384
    v_cvt_pk_bf16_f32 v194, v178, v182
    v_mfma_f32_16x16x32_bf16 v[160:163], a[4:7], a[104:107], v[160:163]
    ds_read_b64_tr_b16 a[70:71], v249 offset:16640
    v_cvt_pk_bf16_f32 v195, v179, v183
    v_mfma_f32_16x16x32_bf16 v[164:167], a[20:23], a[104:107], v[164:167]
    ds_read_b64_tr_b16 a[72:73], v248 offset:18432
    v_cvt_pk_bf16_f32 v196, v184, v188
    v_mfma_f32_16x16x32_bf16 v[168:171], a[4:7], a[108:111], v[168:171]
    ds_read_b64_tr_b16 a[74:75], v248 offset:18688
    v_cvt_pk_bf16_f32 v197, v185, v189
    v_mfma_f32_16x16x32_bf16 v[172:175], a[20:23], a[108:111], v[172:175]
    ds_read_b64_tr_b16 a[76:77], v249 offset:18432
    v_cvt_pk_bf16_f32 v198, v186, v190
    v_mfma_f32_16x16x32_bf16 v[160:163], a[8:11], a[112:115], v[160:163]
    ds_read_b64_tr_b16 a[78:79], v249 offset:18688
    v_cvt_pk_bf16_f32 v199, v187, v191
    v_mfma_f32_16x16x32_bf16 v[164:167], a[24:27], a[112:115], v[164:167]
    ds_write_b128 v250, v[192:195] offset:0
    v_mfma_f32_16x16x32_bf16 v[168:171], a[8:11], a[116:119], v[168:171]
    ds_read_b64_tr_b16 a[80:81], v248 offset:20480
    ds_read_b64_tr_b16 a[82:83], v248 offset:20736
    v_mfma_f32_16x16x32_bf16 v[172:175], a[24:27], a[116:119], v[172:175]
    ds_write_b128 v250, v[196:199] offset:1024
    v_mfma_f32_16x16x32_bf16 v[160:163], a[12:15], a[120:123], v[160:163]
    ds_read_b64_tr_b16 a[84:85], v249 offset:20480
    ds_read_b64_tr_b16 a[86:87], v249 offset:20736
    v_mfma_f32_16x16x32_bf16 v[164:167], a[28:31], a[120:123], v[164:167]
    ds_read_b64_tr_b16 a[88:89], v248 offset:22528
    ds_read_b64_tr_b16 a[90:91], v248 offset:22784
    v_mfma_f32_16x16x32_bf16 v[168:171], a[12:15], a[124:127], v[168:171]
    ds_read_b64_tr_b16 a[92:93], v249 offset:22528
    ds_read_b64_tr_b16 a[94:95], v249 offset:22784
    v_mfma_f32_16x16x32_bf16 v[172:175], a[28:31], a[124:127], v[172:175]
    v_pk_mul_f32 v[176:177], v[64:65], v[160:161]
    v_pk_mul_f32 v[180:181], v[68:69], v[160:161]
    s_nop 2
    v_pk_mul_f32 v[184:185], v[64:65], v[168:169]
    v_pk_mul_f32 v[188:189], v[68:69], v[168:169]
    v_pk_fma_f32 v[176:177], v[68:69], v[164:165], v[176:177] neg_lo:[1,0,0] neg_hi:[1,0,0]
    v_pk_fma_f32 v[180:181], v[8:9], v[164:165], v[180:181]
    v_pk_fma_f32 v[184:185], v[68:69], v[172:173], v[184:185] neg_lo:[1,0,0] neg_hi:[1,0,0]
    v_pk_fma_f32 v[188:189], v[8:9], v[172:173], v[188:189]
    v_pk_fma_f32 v[176:177], v[76:77], v[168:169], v[176:177] neg_lo:[1,0,0] neg_hi:[1,0,0]
    v_pk_fma_f32 v[180:181], v[72:73], v[168:169], v[180:181]
    v_pk_fma_f32 v[184:185], v[76:77], v[160:161], v[184:185]
    v_pk_fma_f32 v[188:189], v[72:73], v[160:161], v[188:189] neg_lo:[1,0,0] neg_hi:[1,0,0]
    v_pk_fma_f32 v[176:177], v[72:73], v[172:173], v[176:177] neg_lo:[1,0,0] neg_hi:[1,0,0]
    v_pk_fma_f32 v[180:181], v[10:11], v[172:173], v[180:181] neg_lo:[1,0,0] neg_hi:[1,0,0]
    v_pk_fma_f32 v[184:185], v[72:73], v[164:165], v[184:185]
    v_pk_fma_f32 v[188:189], v[10:11], v[164:165], v[188:189]
    v_pk_mul_f32 v[178:179], v[66:67], v[162:163]
    v_pk_mul_f32 v[182:183], v[70:71], v[162:163]
    v_pk_mul_f32 v[186:187], v[66:67], v[170:171]
    v_pk_mul_f32 v[190:191], v[70:71], v[170:171]
    v_pk_fma_f32 v[178:179], v[70:71], v[166:167], v[178:179] neg_lo:[1,0,0] neg_hi:[1,0,0]
    v_pk_fma_f32 v[182:183], v[66:67], v[166:167], v[182:183]
    v_pk_fma_f32 v[186:187], v[70:71], v[174:175], v[186:187] neg_lo:[1,0,0] neg_hi:[1,0,0]
    v_pk_fma_f32 v[190:191], v[66:67], v[174:175], v[190:191]
    v_pk_fma_f32 v[178:179], v[78:79], v[170:171], v[178:179] neg_lo:[1,0,0] neg_hi:[1,0,0]
    v_pk_fma_f32 v[182:183], v[74:75], v[170:171], v[182:183]
    v_pk_fma_f32 v[186:187], v[78:79], v[162:163], v[186:187]
    v_pk_fma_f32 v[190:191], v[74:75], v[162:163], v[190:191] neg_lo:[1,0,0] neg_hi:[1,0,0]
    v_pk_fma_f32 v[178:179], v[74:75], v[174:175], v[178:179] neg_lo:[1,0,0] neg_hi:[1,0,0]
    v_pk_fma_f32 v[182:183], v[78:79], v[174:175], v[182:183] neg_lo:[1,0,0] neg_hi:[1,0,0]
    v_pk_fma_f32 v[186:187], v[74:75], v[166:167], v[186:187]
    v_pk_fma_f32 v[190:191], v[78:79], v[166:167], v[190:191]
    s_waitcnt lgkmcnt(0)
    v_mfma_f32_16x16x32_bf16 v[160:163], a[0:3], a[64:67], 0
    s_waitcnt vmcnt(2) lgkmcnt(0)
    s_barrier
    v_mfma_f32_16x16x32_bf16 v[164:167], a[16:19], a[64:67], 0
    ds_read_b128 a[128:131], v33 offset:0
    v_cvt_pk_bf16_f32 v192, v176, v180
    v_mfma_f32_16x16x32_bf16 v[168:171], a[0:3], a[68:71], 0
    ds_read_b128 a[132:135], v33 offset:1024
    v_cvt_pk_bf16_f32 v193, v177, v181
    v_mfma_f32_16x16x32_bf16 v[172:175], a[16:19], a[68:71], 0
    ds_read_b128 a[136:139], v33 offset:2048
    v_cvt_pk_bf16_f32 v194, v178, v182
    v_mfma_f32_16x16x32_bf16 v[160:163], a[4:7], a[72:75], v[160:163]
    ds_read_b128 a[140:143], v33 offset:3072
    v_cvt_pk_bf16_f32 v195, v179, v183
    v_mfma_f32_16x16x32_bf16 v[164:167], a[20:23], a[72:75], v[164:167]
    ds_read_b128 a[144:147], v33 offset:4096
    v_cvt_pk_bf16_f32 v196, v184, v188
    v_mfma_f32_16x16x32_bf16 v[168:171], a[4:7], a[76:79], v[168:171]
    ds_read_b128 a[148:151], v33 offset:5120
    v_cvt_pk_bf16_f32 v197, v185, v189
    v_mfma_f32_16x16x32_bf16 v[172:175], a[20:23], a[76:79], v[172:175]
    ds_read_b128 a[152:155], v33 offset:6144
    v_cvt_pk_bf16_f32 v198, v186, v190
    v_mfma_f32_16x16x32_bf16 v[160:163], a[8:11], a[80:83], v[160:163]
    ds_read_b128 a[156:159], v33 offset:7168
    v_cvt_pk_bf16_f32 v199, v187, v191
    v_mfma_f32_16x16x32_bf16 v[164:167], a[24:27], a[80:83], v[164:167]
    ds_read_b64_tr_b16 a[96:97], v248 offset:24576
    v_mfma_f32_16x16x32_bf16 v[168:171], a[8:11], a[84:87], v[168:171]
    ds_read_b64_tr_b16 a[98:99], v248 offset:24832
    v_mfma_f32_16x16x32_bf16 v[172:175], a[24:27], a[84:87], v[172:175]
    ds_read_b64_tr_b16 a[100:101], v249 offset:24576
    v_mfma_f32_16x16x32_bf16 v[160:163], a[12:15], a[88:91], v[160:163]
    ds_read_b64_tr_b16 a[102:103], v249 offset:24832
    v_mfma_f32_16x16x32_bf16 v[164:167], a[28:31], a[88:91], v[164:167]
    ds_read_b64_tr_b16 a[104:105], v248 offset:26624
    v_mfma_f32_16x16x32_bf16 v[168:171], a[12:15], a[92:95], v[168:171]
    ds_read_b64_tr_b16 a[106:107], v248 offset:26880
    v_mfma_f32_16x16x32_bf16 v[172:175], a[28:31], a[92:95], v[172:175]
    ds_read_b64_tr_b16 a[108:109], v249 offset:26624
    s_waitcnt lgkmcnt(7)
    v_mfma_f32_16x16x32_bf16 v[200:203], a[128:131], a[32:35], 0
    v_mul_f32 v176, v80, v160
    v_mul_f32 v180, v84, v160
    v_mfma_f32_16x16x32_bf16 v[208:211], a[128:131], a[48:51], 0
    ds_write_b128 v250, v[192:195] offset:8192
    v_mfma_f32_16x16x32_bf16 v[204:207], a[132:135], a[32:35], 0
    v_mul_f32 v184, v80, v168
    v_mul_f32 v188, v84, v168
    v_mfma_f32_16x16x32_bf16 v[212:215], a[132:135], a[48:51], 0
    ds_write_b128 v250, v[196:199] offset:9216
    v_mfma_f32_16x16x32_bf16 v[200:203], a[136:139], a[36:39], v[200:203]
    v_mul_f32 v177, v81, v161
    v_mul_f32 v181, v85, v161
    v_mfma_f32_16x16x32_bf16 v[208:211], a[136:139], a[52:55], v[208:211]
    ds_read_b64_tr_b16 a[110:111], v249 offset:26880
    v_mul_f32 v185, v81, v169
    v_mfma_f32_16x16x32_bf16 v[204:207], a[140:143], a[36:39], v[204:207]
    ds_read_b64_tr_b16 a[112:113], v248 offset:28672
    v_mul_f32 v189, v85, v169
    v_mfma_f32_16x16x32_bf16 v[212:215], a[140:143], a[52:55], v[212:215]
    ds_read_b64_tr_b16 a[114:115], v248 offset:28928
    v_mul_f32 v178, v82, v162
    v_mfma_f32_16x16x32_bf16 v[200:203], a[144:147], a[40:43], v[200:203]
    ds_read_b64_tr_b16 a[116:117], v249 offset:28672
    v_mul_f32 v182, v86, v162
    v_mfma_f32_16x16x32_bf16 v[208:211], a[144:147], a[56:59], v[208:211]
    ds_read_b64_tr_b16 a[118:119], v249 offset:28928
    v_mul_f32 v186, v82, v170
    v_mfma_f32_16x16x32_bf16 v[204:207], a[148:151], a[40:43], v[204:207]
    ds_read_b64_tr_b16 a[120:121], v248 offset:30720
    v_mul_f32 v190, v86, v170
    v_mfma_f32_16x16x32_bf16 v[212:215], a[148:151], a[56:59], v[212:215]
    ds_read_b64_tr_b16 a[122:123], v248 offset:30976
    v_mul_f32 v179, v83, v163
    v_mfma_f32_16x16x32_bf16 v[200:203], a[152:155], a[44:47], v[200:203]
    ds_read_b64_tr_b16 a[124:125], v249 offset:30720
    v_mul_f32 v183, v87, v163
    v_mfma_f32_16x16x32_bf16 v[208:211], a[152:155], a[60:63], v[208:211]
    ds_read_b64_tr_b16 a[126:127], v249 offset:30976
    v_mul_f32 v187, v83, v171
    v_mfma_f32_16x16x32_bf16 v[204:207], a[156:159], a[44:47], v[204:207]
    v_mul_f32 v191, v87, v171
    v_mfma_f32_16x16x32_bf16 v[212:215], a[156:159], a[60:63], v[212:215]
    v_pk_fma_f32 v[176:177], v[84:85], v[164:165], v[176:177] neg_lo:[1,0,0] neg_hi:[1,0,0]
    v_pk_fma_f32 v[180:181], v[12:13], v[164:165], v[180:181]
    v_pk_fma_f32 v[184:185], v[84:85], v[172:173], v[184:185] neg_lo:[1,0,0] neg_hi:[1,0,0]
    v_pk_fma_f32 v[188:189], v[12:13], v[172:173], v[188:189]
    v_pk_fma_f32 v[176:177], v[92:93], v[168:169], v[176:177] neg_lo:[1,0,0] neg_hi:[1,0,0]
    v_pk_fma_f32 v[180:181], v[88:89], v[168:169], v[180:181]
    v_pk_fma_f32 v[184:185], v[92:93], v[160:161], v[184:185]
    v_pk_fma_f32 v[188:189], v[88:89], v[160:161], v[188:189] neg_lo:[1,0,0] neg_hi:[1,0,0]
    v_pk_fma_f32 v[176:177], v[88:89], v[172:173], v[176:177] neg_lo:[1,0,0] neg_hi:[1,0,0]
    v_pk_fma_f32 v[180:181], v[14:15], v[172:173], v[180:181] neg_lo:[1,0,0] neg_hi:[1,0,0]
    v_pk_fma_f32 v[184:185], v[88:89], v[164:165], v[184:185]
    v_pk_fma_f32 v[188:189], v[14:15], v[164:165], v[188:189]
    v_pk_fma_f32 v[178:179], v[86:87], v[166:167], v[178:179] neg_lo:[1,0,0] neg_hi:[1,0,0]
    v_pk_fma_f32 v[182:183], v[82:83], v[166:167], v[182:183]
    v_pk_fma_f32 v[186:187], v[86:87], v[174:175], v[186:187] neg_lo:[1,0,0] neg_hi:[1,0,0]
    v_pk_fma_f32 v[190:191], v[82:83], v[174:175], v[190:191]
    v_pk_fma_f32 v[178:179], v[94:95], v[170:171], v[178:179] neg_lo:[1,0,0] neg_hi:[1,0,0]
    v_pk_fma_f32 v[182:183], v[90:91], v[170:171], v[182:183]
    v_pk_fma_f32 v[186:187], v[94:95], v[162:163], v[186:187]
    v_pk_fma_f32 v[190:191], v[90:91], v[162:163], v[190:191] neg_lo:[1,0,0] neg_hi:[1,0,0]
    v_pk_fma_f32 v[178:179], v[90:91], v[174:175], v[178:179] neg_lo:[1,0,0] neg_hi:[1,0,0]
    v_pk_fma_f32 v[182:183], v[94:95], v[174:175], v[182:183] neg_lo:[1,0,0] neg_hi:[1,0,0]
    v_pk_fma_f32 v[186:187], v[90:91], v[166:167], v[186:187]
    v_pk_fma_f32 v[190:191], v[94:95], v[166:167], v[190:191]
    s_waitcnt lgkmcnt(0)
    v_mfma_f32_16x16x32_bf16 v[160:163], a[0:3], a[96:99], 0
    s_waitcnt vmcnt(0) lgkmcnt(0)
    s_barrier
    v_mfma_f32_16x16x32_bf16 v[164:167], a[16:19], a[96:99], 0
    ds_read_b128 a[128:131], v33 offset:8192
    v_cvt_pk_bf16_f32 v232, v200, v201
    v_mfma_f32_16x16x32_bf16 v[168:171], a[0:3], a[100:103], 0
    ds_read_b128 a[132:135], v33 offset:9216
    v_cvt_pk_bf16_f32 v233, v202, v203
    v_mfma_f32_16x16x32_bf16 v[172:175], a[16:19], a[100:103], 0
    ds_read_b128 a[136:139], v33 offset:10240
    v_cvt_pk_bf16_f32 v234, v204, v205
    v_mfma_f32_16x16x32_bf16 v[160:163], a[4:7], a[104:107], v[160:163]
    ds_read_b128 a[140:143], v33 offset:11264
    v_cvt_pk_bf16_f32 v235, v206, v207
    v_mfma_f32_16x16x32_bf16 v[164:167], a[20:23], a[104:107], v[164:167]
    ds_read_b128 a[144:147], v33 offset:12288
    v_or_b32 v232, 1, v232
    v_mfma_f32_16x16x32_bf16 v[168:171], a[4:7], a[108:111], v[168:171]
    ds_read_b128 a[148:151], v33 offset:13312
    v_cvt_pk_bf16_f32 v236, v208, v209
    v_mfma_f32_16x16x32_bf16 v[172:175], a[20:23], a[108:111], v[172:175]
    ds_read_b128 a[152:155], v33 offset:14336
    v_cvt_pk_bf16_f32 v237, v210, v211
    v_mfma_f32_16x16x32_bf16 v[160:163], a[8:11], a[112:115], v[160:163]
    ds_read_b128 a[156:159], v33 offset:15360
    v_cvt_pk_bf16_f32 v238, v212, v213
    v_mfma_f32_16x16x32_bf16 v[164:167], a[24:27], a[112:115], v[164:167]
    ds_read_b64_tr_b16 a[64:65], v248 offset:32768
    v_cvt_pk_bf16_f32 v239, v214, v215
    v_mfma_f32_16x16x32_bf16 v[168:171], a[8:11], a[116:119], v[168:171]
    ds_read_b64_tr_b16 a[66:67], v248 offset:33024
    v_or_b32 v236, 1, v236
    v_mfma_f32_16x16x32_bf16 v[172:175], a[24:27], a[116:119], v[172:175]
    ds_read_b64_tr_b16 a[68:69], v249 offset:32768
    v_cvt_pk_bf16_f32 v192, v176, v180
    v_mfma_f32_16x16x32_bf16 v[160:163], a[12:15], a[120:123], v[160:163]
    ds_read_b64_tr_b16 a[70:71], v249 offset:33024
    v_cvt_pk_bf16_f32 v193, v177, v181
    v_mfma_f32_16x16x32_bf16 v[164:167], a[28:31], a[120:123], v[164:167]
    ds_read_b64_tr_b16 a[72:73], v248 offset:34816
    v_cvt_pk_bf16_f32 v194, v178, v182
    v_mfma_f32_16x16x32_bf16 v[168:171], a[12:15], a[124:127], v[168:171]
    ds_read_b64_tr_b16 a[74:75], v248 offset:35072
    v_cvt_pk_bf16_f32 v195, v179, v183
    v_mfma_f32_16x16x32_bf16 v[172:175], a[28:31], a[124:127], v[172:175]
    ds_read_b64_tr_b16 a[76:77], v249 offset:34816
    v_cvt_pk_bf16_f32 v196, v184, v188
    s_waitcnt lgkmcnt(7)
    v_mfma_f32_16x16x32_bf16 v[200:203], a[128:131], a[32:35], 0
    buffer_store_dwordx4 v[232:235], v251, s[20:23], s56 offen offset:0 sc1
    v_cvt_pk_bf16_f32 v197, v185, v189
    v_mfma_f32_16x16x32_bf16 v[208:211], a[128:131], a[48:51], 0
    buffer_store_dwordx4 v[236:239], v251, s[20:23], s56 offen offset:1024 sc1
    v_cvt_pk_bf16_f32 v198, v186, v190
    v_mfma_f32_16x16x32_bf16 v[204:207], a[132:135], a[32:35], 0
    v_cvt_pk_bf16_f32 v199, v187, v191
    v_mfma_f32_16x16x32_bf16 v[212:215], a[132:135], a[48:51], 0
    ds_write_b128 v250, v[192:195] offset:0
    v_mfma_f32_16x16x32_bf16 v[200:203], a[136:139], a[36:39], v[200:203]
    v_mul_f32 v176, v96, v160
    v_mul_f32 v180, v100, v160
    v_mfma_f32_16x16x32_bf16 v[208:211], a[136:139], a[52:55], v[208:211]
    ds_write_b128 v250, v[196:199] offset:1024
    v_mfma_f32_16x16x32_bf16 v[204:207], a[140:143], a[36:39], v[204:207]
    ds_read_b64_tr_b16 a[78:79], v249 offset:35072
    v_mul_f32 v184, v96, v168
    v_mfma_f32_16x16x32_bf16 v[212:215], a[140:143], a[52:55], v[212:215]
    ds_read_b64_tr_b16 a[80:81], v248 offset:36864
    v_mul_f32 v188, v100, v168
    v_mfma_f32_16x16x32_bf16 v[200:203], a[144:147], a[40:43], v[200:203]
    ds_read_b64_tr_b16 a[82:83], v248 offset:37120
    v_mul_f32 v177, v97, v161
    v_mfma_f32_16x16x32_bf16 v[208:211], a[144:147], a[56:59], v[208:211]
    ds_read_b64_tr_b16 a[84:85], v249 offset:36864
    v_mul_f32 v181, v101, v161
    v_mfma_f32_16x16x32_bf16 v[204:207], a[148:151], a[40:43], v[204:207]
    ds_read_b64_tr_b16 a[86:87], v249 offset:37120
    v_mul_f32 v185, v97, v169
    v_mfma_f32_16x16x32_bf16 v[212:215], a[148:151], a[56:59], v[212:215]
    ds_read_b64_tr_b16 a[88:89], v248 offset:38912
    v_mul_f32 v189, v101, v169
    v_mfma_f32_16x16x32_bf16 v[200:203], a[152:155], a[44:47], v[200:203]
    ds_read_b64_tr_b16 a[90:91], v248 offset:39168
    v_mul_f32 v178, v98, v162
    v_mfma_f32_16x16x32_bf16 v[208:211], a[152:155], a[60:63], v[208:211]
    ds_read_b64_tr_b16 a[92:93], v249 offset:38912
    v_mul_f32 v182, v102, v162
    v_mfma_f32_16x16x32_bf16 v[204:207], a[156:159], a[44:47], v[204:207]
    ds_read_b64_tr_b16 a[94:95], v249 offset:39168
    v_mul_f32 v186, v98, v170
    v_mfma_f32_16x16x32_bf16 v[212:215], a[156:159], a[60:63], v[212:215]
    v_mul_f32 v190, v102, v170
    v_mul_f32 v179, v99, v163
    global_load_dword v255, v[222:223], off
    v_mul_f32 v183, v103, v163
    v_mul_f32 v187, v99, v171
    v_mul_f32 v191, v103, v171
    v_pk_fma_f32 v[176:177], v[100:101], v[164:165], v[176:177] neg_lo:[1,0,0] neg_hi:[1,0,0]
    v_pk_fma_f32 v[180:181], v[16:17], v[164:165], v[180:181]
    v_pk_fma_f32 v[184:185], v[100:101], v[172:173], v[184:185] neg_lo:[1,0,0] neg_hi:[1,0,0]
    v_pk_fma_f32 v[188:189], v[16:17], v[172:173], v[188:189]
    v_pk_fma_f32 v[176:177], v[108:109], v[168:169], v[176:177] neg_lo:[1,0,0] neg_hi:[1,0,0]
    v_pk_fma_f32 v[180:181], v[104:105], v[168:169], v[180:181]
    v_pk_fma_f32 v[184:185], v[108:109], v[160:161], v[184:185]
    v_pk_fma_f32 v[188:189], v[104:105], v[160:161], v[188:189] neg_lo:[1,0,0] neg_hi:[1,0,0]
    v_pk_fma_f32 v[176:177], v[104:105], v[172:173], v[176:177] neg_lo:[1,0,0] neg_hi:[1,0,0]
    v_pk_fma_f32 v[180:181], v[18:19], v[172:173], v[180:181] neg_lo:[1,0,0] neg_hi:[1,0,0]
    v_pk_fma_f32 v[184:185], v[104:105], v[164:165], v[184:185]
    v_pk_fma_f32 v[188:189], v[18:19], v[164:165], v[188:189]
    v_pk_fma_f32 v[178:179], v[102:103], v[166:167], v[178:179] neg_lo:[1,0,0] neg_hi:[1,0,0]
    v_pk_fma_f32 v[182:183], v[98:99], v[166:167], v[182:183]
    v_pk_fma_f32 v[186:187], v[102:103], v[174:175], v[186:187] neg_lo:[1,0,0] neg_hi:[1,0,0]
    v_pk_fma_f32 v[190:191], v[98:99], v[174:175], v[190:191]
    v_pk_fma_f32 v[178:179], v[110:111], v[170:171], v[178:179] neg_lo:[1,0,0] neg_hi:[1,0,0]
    v_pk_fma_f32 v[182:183], v[106:107], v[170:171], v[182:183]
    v_pk_fma_f32 v[186:187], v[110:111], v[162:163], v[186:187]
    v_pk_fma_f32 v[190:191], v[106:107], v[162:163], v[190:191] neg_lo:[1,0,0] neg_hi:[1,0,0]
    v_pk_fma_f32 v[178:179], v[106:107], v[174:175], v[178:179] neg_lo:[1,0,0] neg_hi:[1,0,0]
    v_pk_fma_f32 v[182:183], v[110:111], v[174:175], v[182:183] neg_lo:[1,0,0] neg_hi:[1,0,0]
    v_pk_fma_f32 v[186:187], v[106:107], v[166:167], v[186:187]
    v_pk_fma_f32 v[190:191], v[110:111], v[166:167], v[190:191]
    s_waitcnt lgkmcnt(0)
    v_mfma_f32_16x16x32_bf16 v[160:163], a[0:3], a[64:67], 0
    s_waitcnt lgkmcnt(0)
    s_barrier
    v_mfma_f32_16x16x32_bf16 v[164:167], a[16:19], a[64:67], 0
    ds_read_b128 a[128:131], v33 offset:0
    v_cvt_pk_bf16_f32 v232, v200, v201
    v_mfma_f32_16x16x32_bf16 v[168:171], a[0:3], a[68:71], 0
    ds_read_b128 a[132:135], v33 offset:1024
    v_cvt_pk_bf16_f32 v233, v202, v203
    v_mfma_f32_16x16x32_bf16 v[172:175], a[16:19], a[68:71], 0
    ds_read_b128 a[136:139], v33 offset:2048
    v_cvt_pk_bf16_f32 v234, v204, v205
    v_mfma_f32_16x16x32_bf16 v[160:163], a[4:7], a[72:75], v[160:163]
    ds_read_b128 a[140:143], v33 offset:3072
    v_cvt_pk_bf16_f32 v235, v206, v207
    v_mfma_f32_16x16x32_bf16 v[164:167], a[20:23], a[72:75], v[164:167]
    ds_read_b128 a[144:147], v33 offset:4096
    v_or_b32 v232, 1, v232
    v_mfma_f32_16x16x32_bf16 v[168:171], a[4:7], a[76:79], v[168:171]
    ds_read_b128 a[148:151], v33 offset:5120
    v_cvt_pk_bf16_f32 v236, v208, v209
    v_mfma_f32_16x16x32_bf16 v[172:175], a[20:23], a[76:79], v[172:175]
    ds_read_b128 a[152:155], v33 offset:6144
    v_cvt_pk_bf16_f32 v237, v210, v211
    v_mfma_f32_16x16x32_bf16 v[160:163], a[8:11], a[80:83], v[160:163]
    ds_read_b128 a[156:159], v33 offset:7168
    v_cvt_pk_bf16_f32 v238, v212, v213
    v_mfma_f32_16x16x32_bf16 v[164:167], a[24:27], a[80:83], v[164:167]
    ds_read_b64_tr_b16 a[96:97], v248 offset:40960
    v_cvt_pk_bf16_f32 v239, v214, v215
    v_mfma_f32_16x16x32_bf16 v[168:171], a[8:11], a[84:87], v[168:171]
    ds_read_b64_tr_b16 a[98:99], v248 offset:41216
    v_or_b32 v236, 1, v236
    v_mfma_f32_16x16x32_bf16 v[172:175], a[24:27], a[84:87], v[172:175]
    ds_read_b64_tr_b16 a[100:101], v249 offset:40960
    v_cvt_pk_bf16_f32 v192, v176, v180
    v_mfma_f32_16x16x32_bf16 v[160:163], a[12:15], a[88:91], v[160:163]
    ds_read_b64_tr_b16 a[102:103], v249 offset:41216
    v_cvt_pk_bf16_f32 v193, v177, v181
    v_mfma_f32_16x16x32_bf16 v[164:167], a[28:31], a[88:91], v[164:167]
    ds_read_b64_tr_b16 a[104:105], v248 offset:43008
    v_cvt_pk_bf16_f32 v194, v178, v182
    v_mfma_f32_16x16x32_bf16 v[168:171], a[12:15], a[92:95], v[168:171]
    ds_read_b64_tr_b16 a[106:107], v248 offset:43264
    v_cvt_pk_bf16_f32 v195, v179, v183
    v_mfma_f32_16x16x32_bf16 v[172:175], a[28:31], a[92:95], v[172:175]
    ds_read_b64_tr_b16 a[108:109], v249 offset:43008
    v_cvt_pk_bf16_f32 v196, v184, v188
    s_waitcnt lgkmcnt(7)
    v_mfma_f32_16x16x32_bf16 v[200:203], a[128:131], a[32:35], 0
    buffer_store_dwordx4 v[232:235], v251, s[20:23], s57 offen offset:0 sc1
    v_cvt_pk_bf16_f32 v197, v185, v189
    v_mfma_f32_16x16x32_bf16 v[208:211], a[128:131], a[48:51], 0
    buffer_store_dwordx4 v[236:239], v251, s[20:23], s57 offen offset:1024 sc1
    v_cvt_pk_bf16_f32 v198, v186, v190
    v_mfma_f32_16x16x32_bf16 v[204:207], a[132:135], a[32:35], 0
    v_cvt_pk_bf16_f32 v199, v187, v191
    v_mfma_f32_16x16x32_bf16 v[212:215], a[132:135], a[48:51], 0
    ds_write_b128 v250, v[192:195] offset:8192
    v_mfma_f32_16x16x32_bf16 v[200:203], a[136:139], a[36:39], v[200:203]
    v_mul_f32 v176, v112, v160
    v_mul_f32 v180, v116, v160
    v_mfma_f32_16x16x32_bf16 v[208:211], a[136:139], a[52:55], v[208:211]
    ds_write_b128 v250, v[196:199] offset:9216
    v_mfma_f32_16x16x32_bf16 v[204:207], a[140:143], a[36:39], v[204:207]
    ds_read_b64_tr_b16 a[110:111], v249 offset:43264
    v_mul_f32 v184, v112, v168
    v_mfma_f32_16x16x32_bf16 v[212:215], a[140:143], a[52:55], v[212:215]
    ds_read_b64_tr_b16 a[112:113], v248 offset:45056
    v_mul_f32 v188, v116, v168
    v_mfma_f32_16x16x32_bf16 v[200:203], a[144:147], a[40:43], v[200:203]
    ds_read_b64_tr_b16 a[114:115], v248 offset:45312
    v_mul_f32 v177, v113, v161
    v_mfma_f32_16x16x32_bf16 v[208:211], a[144:147], a[56:59], v[208:211]
    ds_read_b64_tr_b16 a[116:117], v249 offset:45056
    v_mul_f32 v181, v117, v161
    v_mfma_f32_16x16x32_bf16 v[204:207], a[148:151], a[40:43], v[204:207]
    ds_read_b64_tr_b16 a[118:119], v249 offset:45312
    v_mul_f32 v185, v113, v169
    v_mfma_f32_16x16x32_bf16 v[212:215], a[148:151], a[56:59], v[212:215]
    ds_read_b64_tr_b16 a[120:121], v248 offset:47104
    v_mul_f32 v189, v117, v169
    v_mfma_f32_16x16x32_bf16 v[200:203], a[152:155], a[44:47], v[200:203]
    ds_read_b64_tr_b16 a[122:123], v248 offset:47360
    v_mul_f32 v178, v114, v162
    v_mfma_f32_16x16x32_bf16 v[208:211], a[152:155], a[60:63], v[208:211]
    ds_read_b64_tr_b16 a[124:125], v249 offset:47104
    v_mul_f32 v182, v118, v162
    v_mfma_f32_16x16x32_bf16 v[204:207], a[156:159], a[44:47], v[204:207]
    ds_read_b64_tr_b16 a[126:127], v249 offset:47360
    v_mul_f32 v186, v114, v170
    v_mfma_f32_16x16x32_bf16 v[212:215], a[156:159], a[60:63], v[212:215]
    v_mul_f32 v190, v118, v170
    v_mul_f32 v179, v115, v163
    v_mul_f32 v183, v119, v163
    v_mul_f32 v187, v115, v171
    v_mul_f32 v191, v119, v171
    v_pk_fma_f32 v[176:177], v[116:117], v[164:165], v[176:177] neg_lo:[1,0,0] neg_hi:[1,0,0]
    v_pk_fma_f32 v[180:181], v[20:21], v[164:165], v[180:181]
    v_pk_fma_f32 v[184:185], v[116:117], v[172:173], v[184:185] neg_lo:[1,0,0] neg_hi:[1,0,0]
    v_pk_fma_f32 v[188:189], v[20:21], v[172:173], v[188:189]
    v_pk_fma_f32 v[176:177], v[124:125], v[168:169], v[176:177] neg_lo:[1,0,0] neg_hi:[1,0,0]
    v_pk_fma_f32 v[180:181], v[120:121], v[168:169], v[180:181]
    v_pk_fma_f32 v[184:185], v[124:125], v[160:161], v[184:185]
    v_pk_fma_f32 v[188:189], v[120:121], v[160:161], v[188:189] neg_lo:[1,0,0] neg_hi:[1,0,0]
    v_pk_fma_f32 v[176:177], v[120:121], v[172:173], v[176:177] neg_lo:[1,0,0] neg_hi:[1,0,0]
    v_pk_fma_f32 v[180:181], v[22:23], v[172:173], v[180:181] neg_lo:[1,0,0] neg_hi:[1,0,0]
    v_pk_fma_f32 v[184:185], v[120:121], v[164:165], v[184:185]
    v_pk_fma_f32 v[188:189], v[22:23], v[164:165], v[188:189]
    v_pk_fma_f32 v[178:179], v[118:119], v[166:167], v[178:179] neg_lo:[1,0,0] neg_hi:[1,0,0]
    v_pk_fma_f32 v[182:183], v[114:115], v[166:167], v[182:183]
    v_pk_fma_f32 v[186:187], v[118:119], v[174:175], v[186:187] neg_lo:[1,0,0] neg_hi:[1,0,0]
    v_pk_fma_f32 v[190:191], v[114:115], v[174:175], v[190:191]
    v_pk_fma_f32 v[178:179], v[126:127], v[170:171], v[178:179] neg_lo:[1,0,0] neg_hi:[1,0,0]
    v_pk_fma_f32 v[182:183], v[122:123], v[170:171], v[182:183]
    v_pk_fma_f32 v[186:187], v[126:127], v[162:163], v[186:187]
    v_pk_fma_f32 v[190:191], v[122:123], v[162:163], v[190:191] neg_lo:[1,0,0] neg_hi:[1,0,0]
    v_pk_fma_f32 v[178:179], v[122:123], v[174:175], v[178:179] neg_lo:[1,0,0] neg_hi:[1,0,0]
    v_pk_fma_f32 v[182:183], v[126:127], v[174:175], v[182:183] neg_lo:[1,0,0] neg_hi:[1,0,0]
    v_pk_fma_f32 v[186:187], v[122:123], v[166:167], v[186:187]
    v_pk_fma_f32 v[190:191], v[126:127], v[166:167], v[190:191]
    s_waitcnt lgkmcnt(0)
    v_mfma_f32_16x16x32_bf16 v[160:163], a[0:3], a[96:99], 0
    s_waitcnt lgkmcnt(0)
    s_barrier
    v_mfma_f32_16x16x32_bf16 v[164:167], a[16:19], a[96:99], 0
    ds_read_b128 a[128:131], v33 offset:8192
    v_cvt_pk_bf16_f32 v232, v200, v201
    v_mfma_f32_16x16x32_bf16 v[168:171], a[0:3], a[100:103], 0
    ds_read_b128 a[132:135], v33 offset:9216
    v_cvt_pk_bf16_f32 v233, v202, v203
    v_mfma_f32_16x16x32_bf16 v[172:175], a[16:19], a[100:103], 0
    ds_read_b128 a[136:139], v33 offset:10240
    v_cvt_pk_bf16_f32 v234, v204, v205
    v_mfma_f32_16x16x32_bf16 v[160:163], a[4:7], a[104:107], v[160:163]
    ds_read_b128 a[140:143], v33 offset:11264
    v_cvt_pk_bf16_f32 v235, v206, v207
    v_mfma_f32_16x16x32_bf16 v[164:167], a[20:23], a[104:107], v[164:167]
    ds_read_b128 a[144:147], v33 offset:12288
    v_or_b32 v232, 1, v232
    v_mfma_f32_16x16x32_bf16 v[168:171], a[4:7], a[108:111], v[168:171]
    ds_read_b128 a[148:151], v33 offset:13312
    v_cvt_pk_bf16_f32 v236, v208, v209
    v_mfma_f32_16x16x32_bf16 v[172:175], a[20:23], a[108:111], v[172:175]
    ds_read_b128 a[152:155], v33 offset:14336
    v_cvt_pk_bf16_f32 v237, v210, v211
    v_mfma_f32_16x16x32_bf16 v[160:163], a[8:11], a[112:115], v[160:163]
    ds_read_b128 a[156:159], v33 offset:15360
    v_cvt_pk_bf16_f32 v238, v212, v213
    v_mfma_f32_16x16x32_bf16 v[164:167], a[24:27], a[112:115], v[164:167]
    ds_read_b64_tr_b16 a[64:65], v248 offset:49152
    v_cvt_pk_bf16_f32 v239, v214, v215
    v_mfma_f32_16x16x32_bf16 v[168:171], a[8:11], a[116:119], v[168:171]
    ds_read_b64_tr_b16 a[66:67], v248 offset:49408
    v_or_b32 v236, 1, v236
    v_mfma_f32_16x16x32_bf16 v[172:175], a[24:27], a[116:119], v[172:175]
    ds_read_b64_tr_b16 a[68:69], v249 offset:49152
    v_cvt_pk_bf16_f32 v192, v176, v180
    v_mfma_f32_16x16x32_bf16 v[160:163], a[12:15], a[120:123], v[160:163]
    ds_read_b64_tr_b16 a[70:71], v249 offset:49408
    v_cvt_pk_bf16_f32 v193, v177, v181
    v_mfma_f32_16x16x32_bf16 v[164:167], a[28:31], a[120:123], v[164:167]
    ds_read_b64_tr_b16 a[72:73], v248 offset:51200
    v_cvt_pk_bf16_f32 v194, v178, v182
    v_mfma_f32_16x16x32_bf16 v[168:171], a[12:15], a[124:127], v[168:171]
    ds_read_b64_tr_b16 a[74:75], v248 offset:51456
    v_cvt_pk_bf16_f32 v195, v179, v183
    v_mfma_f32_16x16x32_bf16 v[172:175], a[28:31], a[124:127], v[172:175]
    ds_read_b64_tr_b16 a[76:77], v249 offset:51200
    v_cvt_pk_bf16_f32 v196, v184, v188
    s_waitcnt lgkmcnt(7)
    v_mfma_f32_16x16x32_bf16 v[200:203], a[128:131], a[32:35], 0
    buffer_store_dwordx4 v[232:235], v251, s[20:23], s58 offen offset:0 sc1
    v_cvt_pk_bf16_f32 v197, v185, v189
    v_mfma_f32_16x16x32_bf16 v[208:211], a[128:131], a[48:51], 0
    buffer_store_dwordx4 v[236:239], v251, s[20:23], s58 offen offset:1024 sc1
    v_cvt_pk_bf16_f32 v198, v186, v190
    v_mfma_f32_16x16x32_bf16 v[204:207], a[132:135], a[32:35], 0
    v_cvt_pk_bf16_f32 v199, v187, v191
    v_mfma_f32_16x16x32_bf16 v[212:215], a[132:135], a[48:51], 0
    ds_write_b128 v250, v[192:195] offset:0
    v_mfma_f32_16x16x32_bf16 v[200:203], a[136:139], a[36:39], v[200:203]
    v_mul_f32 v176, v128, v160
    v_mul_f32 v180, v132, v160
    v_mfma_f32_16x16x32_bf16 v[208:211], a[136:139], a[52:55], v[208:211]
    ds_write_b128 v250, v[196:199] offset:1024
    v_mfma_f32_16x16x32_bf16 v[204:207], a[140:143], a[36:39], v[204:207]
    ds_read_b64_tr_b16 a[78:79], v249 offset:51456
    v_mul_f32 v184, v128, v168
    v_mfma_f32_16x16x32_bf16 v[212:215], a[140:143], a[52:55], v[212:215]
    ds_read_b64_tr_b16 a[80:81], v248 offset:53248
    v_mul_f32 v188, v132, v168
    v_mfma_f32_16x16x32_bf16 v[200:203], a[144:147], a[40:43], v[200:203]
    ds_read_b64_tr_b16 a[82:83], v248 offset:53504
    v_mul_f32 v177, v129, v161
    v_mfma_f32_16x16x32_bf16 v[208:211], a[144:147], a[56:59], v[208:211]
    ds_read_b64_tr_b16 a[84:85], v249 offset:53248
    v_mul_f32 v181, v133, v161
    v_mfma_f32_16x16x32_bf16 v[204:207], a[148:151], a[40:43], v[204:207]
    ds_read_b64_tr_b16 a[86:87], v249 offset:53504
    v_mul_f32 v185, v129, v169
    v_mfma_f32_16x16x32_bf16 v[212:215], a[148:151], a[56:59], v[212:215]
    ds_read_b64_tr_b16 a[88:89], v248 offset:55296
    v_mul_f32 v189, v133, v169
    v_mfma_f32_16x16x32_bf16 v[200:203], a[152:155], a[44:47], v[200:203]
    ds_read_b64_tr_b16 a[90:91], v248 offset:55552
    v_mul_f32 v178, v130, v162
    v_mfma_f32_16x16x32_bf16 v[208:211], a[152:155], a[60:63], v[208:211]
    ds_read_b64_tr_b16 a[92:93], v249 offset:55296
    v_mul_f32 v182, v134, v162
    v_mfma_f32_16x16x32_bf16 v[204:207], a[156:159], a[44:47], v[204:207]
    ds_read_b64_tr_b16 a[94:95], v249 offset:55552
    v_mul_f32 v186, v130, v170
    v_mfma_f32_16x16x32_bf16 v[212:215], a[156:159], a[60:63], v[212:215]
    v_mul_f32 v190, v134, v170
    v_mul_f32 v179, v131, v163
    v_mul_f32 v183, v135, v163
    v_mul_f32 v187, v131, v171
    v_mul_f32 v191, v135, v171
    v_pk_fma_f32 v[176:177], v[132:133], v[164:165], v[176:177] neg_lo:[1,0,0] neg_hi:[1,0,0]
    v_pk_fma_f32 v[180:181], v[24:25], v[164:165], v[180:181]
    v_pk_fma_f32 v[184:185], v[132:133], v[172:173], v[184:185] neg_lo:[1,0,0] neg_hi:[1,0,0]
    v_pk_fma_f32 v[188:189], v[24:25], v[172:173], v[188:189]
    v_pk_fma_f32 v[176:177], v[140:141], v[168:169], v[176:177] neg_lo:[1,0,0] neg_hi:[1,0,0]
    v_pk_fma_f32 v[180:181], v[136:137], v[168:169], v[180:181]
    v_pk_fma_f32 v[184:185], v[140:141], v[160:161], v[184:185]
    v_pk_fma_f32 v[188:189], v[136:137], v[160:161], v[188:189] neg_lo:[1,0,0] neg_hi:[1,0,0]
    v_pk_fma_f32 v[176:177], v[136:137], v[172:173], v[176:177] neg_lo:[1,0,0] neg_hi:[1,0,0]
    v_pk_fma_f32 v[180:181], v[26:27], v[172:173], v[180:181] neg_lo:[1,0,0] neg_hi:[1,0,0]
    v_pk_fma_f32 v[184:185], v[136:137], v[164:165], v[184:185]
    v_pk_fma_f32 v[188:189], v[26:27], v[164:165], v[188:189]
    v_pk_fma_f32 v[178:179], v[134:135], v[166:167], v[178:179] neg_lo:[1,0,0] neg_hi:[1,0,0]
    v_pk_fma_f32 v[182:183], v[130:131], v[166:167], v[182:183]
    v_pk_fma_f32 v[186:187], v[134:135], v[174:175], v[186:187] neg_lo:[1,0,0] neg_hi:[1,0,0]
    v_pk_fma_f32 v[190:191], v[130:131], v[174:175], v[190:191]
    v_pk_fma_f32 v[178:179], v[142:143], v[170:171], v[178:179] neg_lo:[1,0,0] neg_hi:[1,0,0]
    v_pk_fma_f32 v[182:183], v[138:139], v[170:171], v[182:183]
    v_pk_fma_f32 v[186:187], v[142:143], v[162:163], v[186:187]
    v_pk_fma_f32 v[190:191], v[138:139], v[162:163], v[190:191] neg_lo:[1,0,0] neg_hi:[1,0,0]
    v_pk_fma_f32 v[178:179], v[138:139], v[174:175], v[178:179] neg_lo:[1,0,0] neg_hi:[1,0,0]
    v_pk_fma_f32 v[182:183], v[142:143], v[174:175], v[182:183] neg_lo:[1,0,0] neg_hi:[1,0,0]
    v_pk_fma_f32 v[186:187], v[138:139], v[166:167], v[186:187]
    v_pk_fma_f32 v[190:191], v[142:143], v[166:167], v[190:191]
    s_waitcnt lgkmcnt(0)
    v_mfma_f32_16x16x32_bf16 v[160:163], a[0:3], a[64:67], 0
    s_waitcnt lgkmcnt(0)
    s_barrier
    v_mfma_f32_16x16x32_bf16 v[164:167], a[16:19], a[64:67], 0
    ds_read_b128 a[128:131], v33 offset:0
    v_cvt_pk_bf16_f32 v232, v200, v201
    v_mfma_f32_16x16x32_bf16 v[168:171], a[0:3], a[68:71], 0
    ds_read_b128 a[132:135], v33 offset:1024
    v_cvt_pk_bf16_f32 v233, v202, v203
    v_mfma_f32_16x16x32_bf16 v[172:175], a[16:19], a[68:71], 0
    ds_read_b128 a[136:139], v33 offset:2048
    v_cvt_pk_bf16_f32 v234, v204, v205
    v_mfma_f32_16x16x32_bf16 v[160:163], a[4:7], a[72:75], v[160:163]
    ds_read_b128 a[140:143], v33 offset:3072
    v_cvt_pk_bf16_f32 v235, v206, v207
    v_mfma_f32_16x16x32_bf16 v[164:167], a[20:23], a[72:75], v[164:167]
    ds_read_b128 a[144:147], v33 offset:4096
    v_or_b32 v232, 1, v232
    v_mfma_f32_16x16x32_bf16 v[168:171], a[4:7], a[76:79], v[168:171]
    ds_read_b128 a[148:151], v33 offset:5120
    v_cvt_pk_bf16_f32 v236, v208, v209
    v_mfma_f32_16x16x32_bf16 v[172:175], a[20:23], a[76:79], v[172:175]
    ds_read_b128 a[152:155], v33 offset:6144
    v_cvt_pk_bf16_f32 v237, v210, v211
    v_mfma_f32_16x16x32_bf16 v[160:163], a[8:11], a[80:83], v[160:163]
    ds_read_b128 a[156:159], v33 offset:7168
    v_cvt_pk_bf16_f32 v238, v212, v213
    v_mfma_f32_16x16x32_bf16 v[164:167], a[24:27], a[80:83], v[164:167]
    v_cvt_pk_bf16_f32 v239, v214, v215
    v_mfma_f32_16x16x32_bf16 v[168:171], a[8:11], a[84:87], v[168:171]
    v_or_b32 v236, 1, v236
    v_mfma_f32_16x16x32_bf16 v[172:175], a[24:27], a[84:87], v[172:175]
    v_cvt_pk_bf16_f32 v192, v176, v180
    v_mfma_f32_16x16x32_bf16 v[160:163], a[12:15], a[88:91], v[160:163]
    v_cvt_pk_bf16_f32 v193, v177, v181
    v_mfma_f32_16x16x32_bf16 v[164:167], a[28:31], a[88:91], v[164:167]
    v_cvt_pk_bf16_f32 v194, v178, v182
    v_mfma_f32_16x16x32_bf16 v[168:171], a[12:15], a[92:95], v[168:171]
    v_cvt_pk_bf16_f32 v195, v179, v183
    v_mfma_f32_16x16x32_bf16 v[172:175], a[28:31], a[92:95], v[172:175]
    v_cvt_pk_bf16_f32 v196, v184, v188
    s_waitcnt lgkmcnt(0)
    v_mfma_f32_16x16x32_bf16 v[200:203], a[128:131], a[32:35], 0
    buffer_store_dwordx4 v[232:235], v251, s[20:23], s59 offen offset:0 sc1
    v_cvt_pk_bf16_f32 v197, v185, v189
    v_mfma_f32_16x16x32_bf16 v[208:211], a[128:131], a[48:51], 0
    buffer_store_dwordx4 v[236:239], v251, s[20:23], s59 offen offset:1024 sc1
    v_cvt_pk_bf16_f32 v198, v186, v190
    v_mfma_f32_16x16x32_bf16 v[204:207], a[132:135], a[32:35], 0
    v_cvt_pk_bf16_f32 v199, v187, v191
    v_mfma_f32_16x16x32_bf16 v[212:215], a[132:135], a[48:51], 0
    ds_write_b128 v250, v[192:195] offset:8192
    v_mfma_f32_16x16x32_bf16 v[200:203], a[136:139], a[36:39], v[200:203]
    v_mul_f32 v176, v144, v160
    v_mul_f32 v180, v148, v160
    v_mfma_f32_16x16x32_bf16 v[208:211], a[136:139], a[52:55], v[208:211]
    ds_write_b128 v250, v[196:199] offset:9216
    v_mfma_f32_16x16x32_bf16 v[204:207], a[140:143], a[36:39], v[204:207]
    v_mul_f32 v184, v144, v168
    v_mul_f32 v188, v148, v168
    v_mfma_f32_16x16x32_bf16 v[212:215], a[140:143], a[52:55], v[212:215]
    v_mul_f32 v177, v145, v161
    v_mul_f32 v181, v149, v161
    v_mfma_f32_16x16x32_bf16 v[200:203], a[144:147], a[40:43], v[200:203]
    v_mul_f32 v185, v145, v169
    v_mul_f32 v189, v149, v169
    v_mfma_f32_16x16x32_bf16 v[208:211], a[144:147], a[56:59], v[208:211]
    v_mul_f32 v178, v146, v162
    v_mul_f32 v182, v150, v162
    v_mfma_f32_16x16x32_bf16 v[204:207], a[148:151], a[40:43], v[204:207]
    v_mul_f32 v186, v146, v170
    v_mul_f32 v190, v150, v170
    v_mfma_f32_16x16x32_bf16 v[212:215], a[148:151], a[56:59], v[212:215]
    v_mul_f32 v179, v147, v163
    v_mul_f32 v183, v151, v163
    v_mfma_f32_16x16x32_bf16 v[200:203], a[152:155], a[44:47], v[200:203]
    v_mul_f32 v187, v147, v171
    v_mul_f32 v191, v151, v171
    v_mfma_f32_16x16x32_bf16 v[208:211], a[152:155], a[60:63], v[208:211]
    v_mfma_f32_16x16x32_bf16 v[204:207], a[156:159], a[44:47], v[204:207]
    v_mfma_f32_16x16x32_bf16 v[212:215], a[156:159], a[60:63], v[212:215]
    v_pk_fma_f32 v[176:177], v[148:149], v[164:165], v[176:177] neg_lo:[1,0,0] neg_hi:[1,0,0]
    v_pk_fma_f32 v[180:181], v[44:45], v[164:165], v[180:181]
    v_pk_fma_f32 v[184:185], v[148:149], v[172:173], v[184:185] neg_lo:[1,0,0] neg_hi:[1,0,0]
    v_pk_fma_f32 v[188:189], v[44:45], v[172:173], v[188:189]
    v_pk_fma_f32 v[176:177], v[156:157], v[168:169], v[176:177] neg_lo:[1,0,0] neg_hi:[1,0,0]
    v_pk_fma_f32 v[180:181], v[152:153], v[168:169], v[180:181]
    v_pk_fma_f32 v[184:185], v[156:157], v[160:161], v[184:185]
    v_pk_fma_f32 v[188:189], v[152:153], v[160:161], v[188:189] neg_lo:[1,0,0] neg_hi:[1,0,0]
    v_pk_fma_f32 v[176:177], v[152:153], v[172:173], v[176:177] neg_lo:[1,0,0] neg_hi:[1,0,0]
    v_pk_fma_f32 v[180:181], v[46:47], v[172:173], v[180:181] neg_lo:[1,0,0] neg_hi:[1,0,0]
    v_pk_fma_f32 v[184:185], v[152:153], v[164:165], v[184:185]
    v_pk_fma_f32 v[188:189], v[46:47], v[164:165], v[188:189]
    v_pk_fma_f32 v[178:179], v[150:151], v[166:167], v[178:179] neg_lo:[1,0,0] neg_hi:[1,0,0]
    v_pk_fma_f32 v[182:183], v[146:147], v[166:167], v[182:183]
    v_pk_fma_f32 v[186:187], v[150:151], v[174:175], v[186:187] neg_lo:[1,0,0] neg_hi:[1,0,0]
    v_pk_fma_f32 v[190:191], v[146:147], v[174:175], v[190:191]
    v_pk_fma_f32 v[178:179], v[158:159], v[170:171], v[178:179] neg_lo:[1,0,0] neg_hi:[1,0,0]
    v_pk_fma_f32 v[182:183], v[154:155], v[170:171], v[182:183]
    v_pk_fma_f32 v[186:187], v[158:159], v[162:163], v[186:187]
    v_pk_fma_f32 v[190:191], v[154:155], v[162:163], v[190:191] neg_lo:[1,0,0] neg_hi:[1,0,0]
    v_pk_fma_f32 v[178:179], v[154:155], v[174:175], v[178:179] neg_lo:[1,0,0] neg_hi:[1,0,0]
    v_pk_fma_f32 v[182:183], v[158:159], v[174:175], v[182:183] neg_lo:[1,0,0] neg_hi:[1,0,0]
    v_pk_fma_f32 v[186:187], v[154:155], v[166:167], v[186:187]
    v_pk_fma_f32 v[190:191], v[158:159], v[166:167], v[190:191]
    v_cvt_pk_bf16_f32 v192, v176, v180
    v_cvt_pk_bf16_f32 v193, v177, v181
    v_cvt_pk_bf16_f32 v194, v178, v182
    v_cvt_pk_bf16_f32 v195, v179, v183
    ds_write_b128 v250, v[192:195] offset:0
    v_cvt_pk_bf16_f32 v196, v184, v188
    v_cvt_pk_bf16_f32 v197, v185, v189
    v_cvt_pk_bf16_f32 v198, v186, v190
    v_cvt_pk_bf16_f32 v199, v187, v191
    ds_write_b128 v250, v[196:199] offset:1024
    v_cvt_pk_bf16_f32 v232, v200, v201
    v_cvt_pk_bf16_f32 v233, v202, v203
    v_cvt_pk_bf16_f32 v234, v204, v205
    v_cvt_pk_bf16_f32 v235, v206, v207
    v_or_b32 v232, 1, v232
    v_cvt_pk_bf16_f32 v236, v208, v209
    v_cvt_pk_bf16_f32 v237, v210, v211
    v_cvt_pk_bf16_f32 v238, v212, v213
    v_cvt_pk_bf16_f32 v239, v214, v215
    v_or_b32 v236, 1, v236
    s_waitcnt lgkmcnt(0)
    s_barrier
    ds_read_b128 a[128:131], v33 offset:8192
    ds_read_b128 a[132:135], v33 offset:9216
    ds_read_b128 a[136:139], v33 offset:10240
    ds_read_b128 a[140:143], v33 offset:11264
    ds_read_b128 a[144:147], v33 offset:12288
    ds_read_b128 a[148:151], v33 offset:13312
    ds_read_b128 a[152:155], v33 offset:14336
    ds_read_b128 a[156:159], v33 offset:15360
    s_waitcnt lgkmcnt(6)
    v_mfma_f32_16x16x32_bf16 v[200:203], a[128:131], a[32:35], 0
    ds_read_b128 a[64:67], v33 offset:0
    v_mfma_f32_16x16x32_bf16 v[208:211], a[128:131], a[48:51], 0
    ds_read_b128 a[68:71], v33 offset:1024
    v_mfma_f32_16x16x32_bf16 v[204:207], a[132:135], a[32:35], 0
    ds_read_b128 a[72:75], v33 offset:2048
    v_mfma_f32_16x16x32_bf16 v[212:215], a[132:135], a[48:51], 0
    ds_read_b128 a[76:79], v33 offset:3072
    s_waitcnt lgkmcnt(8)
    v_mfma_f32_16x16x32_bf16 v[200:203], a[136:139], a[36:39], v[200:203]
    ds_read_b128 a[80:83], v33 offset:4096
    v_mfma_f32_16x16x32_bf16 v[208:211], a[136:139], a[52:55], v[208:211]
    ds_read_b128 a[84:87], v33 offset:5120
    v_mfma_f32_16x16x32_bf16 v[204:207], a[140:143], a[36:39], v[204:207]
    ds_read_b128 a[88:91], v33 offset:6144
    v_mfma_f32_16x16x32_bf16 v[212:215], a[140:143], a[52:55], v[212:215]
    ds_read_b128 a[92:95], v33 offset:7168
    s_waitcnt lgkmcnt(10)
    v_mfma_f32_16x16x32_bf16 v[200:203], a[144:147], a[40:43], v[200:203]
    buffer_store_dwordx4 v[232:235], v251, s[20:23], s60 offen offset:0 sc1
    v_mfma_f32_16x16x32_bf16 v[208:211], a[144:147], a[56:59], v[208:211]
    buffer_store_dwordx4 v[236:239], v251, s[20:23], s60 offen offset:1024 sc1
    v_mfma_f32_16x16x32_bf16 v[204:207], a[148:151], a[40:43], v[204:207]
    v_mfma_f32_16x16x32_bf16 v[212:215], a[148:151], a[56:59], v[212:215]
    s_waitcnt lgkmcnt(8)
    v_mfma_f32_16x16x32_bf16 v[200:203], a[152:155], a[44:47], v[200:203]
    v_mfma_f32_16x16x32_bf16 v[208:211], a[152:155], a[60:63], v[208:211]
    v_mfma_f32_16x16x32_bf16 v[204:207], a[156:159], a[44:47], v[204:207]
    v_mfma_f32_16x16x32_bf16 v[212:215], a[156:159], a[60:63], v[212:215]
    s_waitcnt lgkmcnt(0)
    v_mfma_f32_16x16x32_bf16 v[160:163], a[64:67], a[32:35], 0
    v_mfma_f32_16x16x32_bf16 v[164:167], a[68:71], a[32:35], 0
    v_mfma_f32_16x16x32_bf16 v[160:163], a[72:75], a[36:39], v[160:163]
    s_nop 0
    v_cvt_pk_bf16_f32 v232, v200, v201
    v_mfma_f32_16x16x32_bf16 v[164:167], a[76:79], a[36:39], v[164:167]
    v_cvt_pk_bf16_f32 v233, v202, v203
    v_mfma_f32_16x16x32_bf16 v[160:163], a[80:83], a[40:43], v[160:163]
    v_cvt_pk_bf16_f32 v234, v204, v205
    v_mfma_f32_16x16x32_bf16 v[164:167], a[84:87], a[40:43], v[164:167]
    v_cvt_pk_bf16_f32 v235, v206, v207
    v_mfma_f32_16x16x32_bf16 v[160:163], a[88:91], a[44:47], v[160:163]
    v_or_b32 v232, 1, v232
    v_mfma_f32_16x16x32_bf16 v[164:167], a[92:95], a[44:47], v[164:167]
    buffer_store_dwordx4 v[232:235], v251, s[20:23], s61 offen offset:0 sc1
    v_mfma_f32_16x16x32_bf16 v[168:171], a[64:67], a[48:51], 0
    v_cvt_pk_bf16_f32 v236, v208, v209
    v_mfma_f32_16x16x32_bf16 v[172:175], a[68:71], a[48:51], 0
    v_cvt_pk_bf16_f32 v237, v210, v211
    v_mfma_f32_16x16x32_bf16 v[168:171], a[72:75], a[52:55], v[168:171]
    v_cvt_pk_bf16_f32 v238, v212, v213
    v_mfma_f32_16x16x32_bf16 v[172:175], a[76:79], a[52:55], v[172:175]
    v_cvt_pk_bf16_f32 v239, v214, v215
    v_mfma_f32_16x16x32_bf16 v[168:171], a[80:83], a[56:59], v[168:171]
    v_or_b32 v236, 1, v236
    v_mfma_f32_16x16x32_bf16 v[172:175], a[84:87], a[56:59], v[172:175]
    buffer_store_dwordx4 v[236:239], v251, s[20:23], s61 offen offset:1024 sc1
    v_mfma_f32_16x16x32_bf16 v[168:171], a[88:91], a[60:63], v[168:171]
    v_mfma_f32_16x16x32_bf16 v[172:175], a[92:95], a[60:63], v[172:175]
    v_cvt_pk_bf16_f32 v192, v160, v161
    v_cvt_pk_bf16_f32 v193, v162, v163
    v_cvt_pk_bf16_f32 v194, v164, v165
    v_cvt_pk_bf16_f32 v195, v166, v167
    v_or_b32 v192, 1, v192
    buffer_store_dwordx4 v[192:195], v251, s[20:23], s62 offen offset:0 sc1
    s_nop 0
    v_cvt_pk_bf16_f32 v196, v168, v169
    v_cvt_pk_bf16_f32 v197, v170, v171
    v_cvt_pk_bf16_f32 v198, v172, v173
    v_cvt_pk_bf16_f32 v199, v174, v175
    v_or_b32 v196, 1, v196
    buffer_store_dwordx4 v[196:199], v251, s[20:23], s62 offen offset:1024 sc1
    s_add_u32 m0, s43, 14336
    s_nop 0
    buffer_load_dwordx4 v32, s[24:27], 0 offen lds
    s_add_u32 m0, s43, 0
    s_mov_b32 s54, 0
    buffer_load_dwordx4 v29, s[8:11], s54 offen lds
    buffer_load_dwordx4 v254, s[8:11], s54 offen offset:1024 lds
    s_add_u32 m0, s43, 2048
    s_mov_b32 s54, 128
    buffer_load_dwordx4 v29, s[8:11], s54 offen lds
    buffer_load_dwordx4 v254, s[8:11], s54 offen offset:1024 lds
    s_add_u32 m0, s43, 4096
    s_mov_b32 s54, 256
    buffer_load_dwordx4 v29, s[8:11], s54 offen lds
    buffer_load_dwordx4 v254, s[8:11], s54 offen offset:1024 lds
    s_add_u32 m0, s43, 6144
    s_mov_b32 s54, 384
    buffer_load_dwordx4 v29, s[8:11], s54 offen lds
    buffer_load_dwordx4 v254, s[8:11], s54 offen offset:1024 lds
    s_add_u32 m0, s43, 8192
    s_mov_b32 s54, 512
    buffer_load_dwordx4 v29, s[8:11], s54 offen lds
    buffer_load_dwordx4 v254, s[8:11], s54 offen offset:1024 lds
    s_add_u32 m0, s43, 10240
    s_mov_b32 s54, 640
    buffer_load_dwordx4 v29, s[8:11], s54 offen lds
    buffer_load_dwordx4 v254, s[8:11], s54 offen offset:1024 lds
    s_add_u32 m0, s43, 12288
    s_mov_b32 s54, 768
    buffer_load_dwordx4 v29, s[8:11], s54 offen lds
    buffer_load_dwordx4 v254, s[8:11], s54 offen offset:1024 lds
    s_waitcnt vmcnt(0)
    ds_read_b128 a[160:163], v240 offset:0
    ds_read_b128 a[164:167], v242 offset:14336
    ds_read_b128 a[168:171], v241 offset:0
    ds_read_b128 a[172:175], v242 offset:14400
    ds_read_b128 a[176:179], v240 offset:2048
    ds_read_b128 a[180:183], v242 offset:14464
    ds_read_b128 a[184:187], v241 offset:2048
    ds_read_b128 a[188:191], v242 offset:14528
    ds_read_b128 a[192:195], v240 offset:4096
    ds_read_b128 a[196:199], v242 offset:14592
    s_waitcnt lgkmcnt(8)
    v_mfma_f32_16x16x32_bf16 v[224:227], a[164:167], a[160:163], 0
    ds_read_b128 a[200:203], v241 offset:4096
    ds_read_b128 a[204:207], v242 offset:14656
    s_waitcnt lgkmcnt(8)
    v_mfma_f32_16x16x32_bf16 v[224:227], a[172:175], a[168:171], v[224:227]
    ds_read_b128 a[160:163], v240 offset:6144
    ds_read_b128 a[164:167], v242 offset:14720
    s_waitcnt lgkmcnt(8)
    v_mfma_f32_16x16x32_bf16 v[224:227], a[180:183], a[176:179], v[224:227]
    ds_read_b128 a[168:171], v241 offset:6144
    ds_read_b128 a[172:175], v242 offset:14784
    s_waitcnt lgkmcnt(8)
    v_mfma_f32_16x16x32_bf16 v[224:227], a[188:191], a[184:187], v[224:227]
    ds_read_b128 a[176:179], v240 offset:8192
    ds_read_b128 a[180:183], v242 offset:14848
    s_waitcnt lgkmcnt(8)
    v_mfma_f32_16x16x32_bf16 v[224:227], a[196:199], a[192:195], v[224:227]
    ds_read_b128 a[184:187], v241 offset:8192
    ds_read_b128 a[188:191], v242 offset:14912
    s_waitcnt lgkmcnt(8)
    v_mfma_f32_16x16x32_bf16 v[224:227], a[204:207], a[200:203], v[224:227]
    ds_read_b128 a[192:195], v240 offset:10240
    ds_read_b128 a[196:199], v242 offset:14976
    s_waitcnt lgkmcnt(8)
    v_mfma_f32_16x16x32_bf16 v[224:227], a[164:167], a[160:163], v[224:227]
    ds_read_b128 a[200:203], v241 offset:10240
    ds_read_b128 a[204:207], v242 offset:15040
    s_waitcnt lgkmcnt(8)
    v_mfma_f32_16x16x32_bf16 v[224:227], a[172:175], a[168:171], v[224:227]
    ds_read_b128 a[160:163], v240 offset:12288
    ds_read_b128 a[164:167], v242 offset:15104
    s_waitcnt lgkmcnt(8)
    v_mfma_f32_16x16x32_bf16 v[224:227], a[180:183], a[176:179], v[224:227]
    ds_read_b128 a[168:171], v241 offset:12288
    ds_read_b128 a[172:175], v242 offset:15168
    s_waitcnt lgkmcnt(8)
    v_mfma_f32_16x16x32_bf16 v[224:227], a[188:191], a[184:187], v[224:227]
    s_waitcnt lgkmcnt(6)
    v_mfma_f32_16x16x32_bf16 v[224:227], a[196:199], a[192:195], v[224:227]
    s_waitcnt lgkmcnt(4)
    v_mfma_f32_16x16x32_bf16 v[224:227], a[204:207], a[200:203], v[224:227]
    s_waitcnt lgkmcnt(2)
    v_mfma_f32_16x16x32_bf16 v[224:227], a[164:167], a[160:163], v[224:227]
    s_waitcnt lgkmcnt(0)
    v_mfma_f32_16x16x32_bf16 v[224:227], a[172:175], a[168:171], v[224:227]
    s_nop 7
    v_mul_f32 v224, 0x3fb8aa3b, v224
    v_exp_f32 v224, v224
    v_mov_b32 v225, v30
    v_add_f32 v224, 1.0, v224
    v_rcp_f32 v224, v224
    s_mov_b64 exec, 0xffff
    buffer_store_dwordx2 v[224:225], v3, s[20:23], 0 offen sc1
    s_mov_b64 exec, -1
L_exit:
    s_endpgm
SPIN_hf0:
    s_mov_b32 s38, 0
LOOP_hf0:
    v_and_b32 v1, 7, v0
    v_min_u32 v1, 6, v1
    v_bfe_u32 v3, v0, 3, 1
    v_lshl_add_u32 v1, v3, 3, v1
    v_sub_u32 v3, v1, v3
    v_lshl_add_u32 v1, v1, 2, s39
    buffer_load_dword v1, v1, s[20:23], 0 offen offset:0 sc1
    s_and_b32 s35, s38, 7
    s_cmp_lg_u32 s35, 7
    s_cbranch_scc0 GLO_hf0
    v_not_b32 v3, v30
    s_branch NOG_hf0
GLO_hf0:
    v_lshl_add_u32 v3, v3, 8, s101
    buffer_load_dword v3, v3, s[20:23], 0 offen offset:0 sc1
NOG_hf0:
    s_add_u32 s38, s38, 1
    s_waitcnt vmcnt(0)

    v_cmp_ne_u32 vcc, v30, v1
    v_cmp_ne_u32 s[36:37], v30, v3
    s_nop 1
    s_and_b64 vcc, vcc, s[36:37]
    s_cbranch_scc0 BACK_hf0
    s_cmp_lt_u32 s38, 200000
    s_cbranch_scc1 LOOP_hf0
    s_endpgm
SPIN_hf1:
    s_mov_b32 s38, 0
LOOP_hf1:
    v_and_b32 v1, 7, v0
    v_min_u32 v1, 6, v1
    v_bfe_u32 v3, v0, 3, 1
    v_lshl_add_u32 v1, v3, 3, v1
    v_sub_u32 v3, v1, v3
    v_lshl_add_u32 v1, v1, 2, s39
    buffer_load_dword v1, v1, s[20:23], 0 offen offset:512 sc1
    s_and_b32 s35, s38, 7
    s_cmp_lg_u32 s35, 7
    s_cbranch_scc0 GLO_hf1
    v_not_b32 v3, v30
    s_branch NOG_hf1
GLO_hf1:
    v_lshl_add_u32 v3, v3, 8, s101
    buffer_load_dword v3, v3, s[20:23], 0 offen offset:128 sc1
NOG_hf1:
    s_add_u32 s38, s38, 1
    s_waitcnt vmcnt(0)

    v_cmp_ne_u32 vcc, v30, v1
    v_cmp_ne_u32 s[36:37], v30, v3
    s_nop 1
    s_and_b64 vcc, vcc, s[36:37]
    s_cbranch_scc0 BACK_hf1
    s_cmp_lt_u32 s38, 200000
    s_cbranch_scc1 LOOP_hf1
    s_endpgm
SPIN_upa:
    s_mov_b32 s38, 0
LOOP_upa:

    buffer_load_dword v36, v35, s[20:23], 0 offen sc1
    s_add_u32 s38, s38, 1
    s_waitcnt vmcnt(0)
    v_and_b32 v36, 1, v36
    v_cmp_eq_u32 vcc, 0, v36
    s_nop 1
    s_cbranch_vccz BACK_upa
    s_cmp_lt_u32 s38, 200000
    s_cbranch_scc1 LOOP_upa
    s_endpgm
SPIN_upb:
    s_mov_b32 s38, 0
LOOP_upb:

    buffer_load_dword v36, v35, s[20:23], s56 offen sc1
    s_add_u32 s38, s38, 1
    s_waitcnt vmcnt(0)
    v_and_b32 v36, 1, v36
    v_cmp_eq_u32 vcc, 0, v36
    s_nop 1
    s_cbranch_vccz BACK_upb
    s_cmp_lt_u32 s38, 200000
    s_cbranch_scc1 LOOP_upb
    s_endpgm
SPIN_pg:
    s_mov_b32 s38, 0
LOOP_pg:

    buffer_load_dword v2, v29, s[20:23], 0 offen sc1
    s_add_u32 s38, s38, 1
    s_waitcnt vmcnt(0)
    v_cmp_ne_u32 vcc, v30, v2
    s_nop 1
    s_cbranch_vccz BACK_pg
    s_cmp_lt_u32 s38, 200000
    s_cbranch_scc1 LOOP_pg
    s_endpgm
SPIN_ff:
    s_mov_b32 s38, 0
LOOP_ff:

    buffer_load_dword v36, v27, s[20:23], 0 offen sc1
    s_add_u32 s38, s38, 1
    s_waitcnt vmcnt(0)
    v_cmp_ne_u32 vcc, v30, v36
    s_nop 1
    s_cbranch_vccz BACK_ff
    s_cmp_lt_u32 s38, 200000
    s_cbranch_scc1 LOOP_ff
    s_endpgm
SPIN_u2:
    s_mov_b32 s38, 0
    s_waitcnt vmcnt(0) lgkmcnt(0)
    s_barrier
LOOP_u2:
    s_add_u32 m0, s31, 16384
    s_mov_b32 s5, 0
    buffer_load_dwordx4 v33, s[20:23], s5 offen sc1 lds
    s_add_u32 m0, s31, 20480
    s_mov_b32 s5, 57344
    buffer_load_dwordx4 v33, s[20:23], s5 offen sc1 lds
    s_add_u32 m0, s31, 24576
    s_mov_b32 s5, 8192
    buffer_load_dwordx4 v33, s[20:23], s5 offen sc1 lds
    s_add_u32 m0, s31, 28672
    s_mov_b32 s5, 65536
    buffer_load_dwordx4 v33, s[20:23], s5 offen sc1 lds
    s_add_u32 m0, s31, 32768
    s_mov_b32 s5, 16384
    buffer_load_dwordx4 v33, s[20:23], s5 offen sc1 lds
    s_add_u32 m0, s31, 36864
    s_mov_b32 s5, 73728
    buffer_load_dwordx4 v33, s[20:23], s5 offen sc1 lds
    s_add_u32 m0, s31, 40960
    s_mov_b32 s5, 24576
    buffer_load_dwordx4 v33, s[20:23], s5 offen sc1 lds
    s_add_u32 m0, s31, 45056
    s_mov_b32 s5, 81920
    buffer_load_dwordx4 v33, s[20:23], s5 offen sc1 lds
    s_add_u32 m0, s31, 49152
    s_mov_b32 s5, 32768
    buffer_load_dwordx4 v33, s[20:23], s5 offen sc1 lds
    s_add_u32 m0, s31, 53248
    s_mov_b32 s5, 90112
    buffer_load_dwordx4 v33, s[20:23], s5 offen sc1 lds
    s_add_u32 m0, s31, 57344
    s_mov_b32 s5, 40960
    buffer_load_dwordx4 v33, s[20:23], s5 offen sc1 lds
    s_add_u32 m0, s31, 61440
    s_mov_b32 s5, 98304
    buffer_load_dwordx4 v33, s[20:23], s5 offen sc1 lds
    s_add_u32 m0, s31, 0
    s_mov_b32 s5, 49152
    buffer_load_dwordx4 v33, s[20:23], s5 offen sc1 lds
    s_add_u32 m0, s31, 4096
    s_mov_b32 s5, 106496
    buffer_load_dwordx4 v33, s[20:23], s5 offen sc1 lds
    s_add_u32 s38, s38, 1
    s_waitcnt vmcnt(0)
    ds_read2st64_b32 v[160:161], v27 offset0:64 offset1:80
    ds_read2st64_b32 v[162:163], v27 offset0:96 offset1:112
    ds_read2st64_b32 v[164:165], v27 offset0:128 offset1:144
    ds_read2st64_b32 v[166:167], v27 offset0:160 offset1:176
    ds_read2st64_b32 v[168:169], v27 offset0:192 offset1:208
    ds_read2st64_b32 v[170:171], v27 offset0:224 offset1:240
    ds_read2st64_b32 v[172:173], v27 offset0:0 offset1:16
    s_waitcnt lgkmcnt(0)
    v_bitop3_b32 v160, v160, v161, v162 bitop3:0x80
    v_bitop3_b32 v160, v160, v163, v164 bitop3:0x80
    v_bitop3_b32 v160, v160, v165, v166 bitop3:0x80
    v_bitop3_b32 v160, v160, v167, v168 bitop3:0x80
    v_bitop3_b32 v160, v160, v169, v170 bitop3:0x80
    v_bitop3_b32 v160, v160, v171, v172 bitop3:0x80
    v_bitop3_b32 v160, v160, v173, 1 bitop3:0x80
    v_cmp_eq_u32 vcc, 0, v160
    s_nop 1
    s_cbranch_vccz DONE_u2
    s_cmp_lt_u32 s38, 200000
    s_cbranch_scc1 LOOP_u2
    s_endpgm
DONE_u2:
    s_barrier
    ds_read_b128 v[160:163], v16 offset:16384
    ds_read_b128 v[164:167], v16 offset:17408
    ds_read_b128 v[168:171], v16 offset:18432
    ds_read_b128 v[172:175], v16 offset:19456
    s_waitcnt lgkmcnt(0)
    v_mfma_f32_16x16x32_bf16 v[44:47], v[160:163], v[64:67], 0
    v_mfma_f32_16x16x32_bf16 v[48:51], v[164:167], v[64:67], 0
    v_mfma_f32_16x16x32_bf16 v[52:55], v[168:171], v[64:67], 0
    v_mfma_f32_16x16x32_bf16 v[56:59], v[172:175], v[64:67], 0
    ds_read_b128 v[176:179], v16 offset:20480
    ds_read_b128 v[180:183], v16 offset:21504
    ds_read_b128 v[184:187], v16 offset:22528
    ds_read_b128 v[188:191], v16 offset:23552
    s_waitcnt lgkmcnt(0)
    v_mfma_f32_16x16x32_bf16 v[44:47], v[176:179], v[92:95], v[44:47]
    v_mfma_f32_16x16x32_bf16 v[48:51], v[180:183], v[92:95], v[48:51]
    v_mfma_f32_16x16x32_bf16 v[52:55], v[184:187], v[92:95], v[52:55]
    v_mfma_f32_16x16x32_bf16 v[56:59], v[188:191], v[92:95], v[56:59]
    ds_read_b128 v[192:195], v16 offset:24576
    ds_read_b128 v[196:199], v16 offset:25600
    ds_read_b128 v[200:203], v16 offset:26624
    ds_read_b128 v[204:207], v16 offset:27648
    s_waitcnt lgkmcnt(0)
    v_mfma_f32_16x16x32_bf16 v[44:47], v[192:195], v[68:71], v[44:47]
    v_mfma_f32_16x16x32_bf16 v[48:51], v[196:199], v[68:71], v[48:51]
    v_mfma_f32_16x16x32_bf16 v[52:55], v[200:203], v[68:71], v[52:55]
    v_mfma_f32_16x16x32_bf16 v[56:59], v[204:207], v[68:71], v[56:59]
    ds_read_b128 v[160:163], v16 offset:28672
    ds_read_b128 v[164:167], v16 offset:29696
    ds_read_b128 v[168:171], v16 offset:30720
    ds_read_b128 v[172:175], v16 offset:31744
    s_waitcnt lgkmcnt(0)
    v_mfma_f32_16x16x32_bf16 v[44:47], v[160:163], v[96:99], v[44:47]
    v_mfma_f32_16x16x32_bf16 v[48:51], v[164:167], v[96:99], v[48:51]
    v_mfma_f32_16x16x32_bf16 v[52:55], v[168:171], v[96:99], v[52:55]
    v_mfma_f32_16x16x32_bf16 v[56:59], v[172:175], v[96:99], v[56:59]
    ds_read_b128 v[176:179], v16 offset:32768
    ds_read_b128 v[180:183], v16 offset:33792
    ds_read_b128 v[184:187], v16 offset:34816
    ds_read_b128 v[188:191], v16 offset:35840
    s_waitcnt lgkmcnt(0)
    v_mfma_f32_16x16x32_bf16 v[44:47], v[176:179], v[72:75], v[44:47]
    v_mfma_f32_16x16x32_bf16 v[48:51], v[180:183], v[72:75], v[48:51]
    v_mfma_f32_16x16x32_bf16 v[52:55], v[184:187], v[72:75], v[52:55]
    v_mfma_f32_16x16x32_bf16 v[56:59], v[188:191], v[72:75], v[56:59]
    ds_read_b128 v[192:195], v16 offset:36864
    ds_read_b128 v[196:199], v16 offset:37888
    ds_read_b128 v[200:203], v16 offset:38912
    ds_read_b128 v[204:207], v16 offset:39936
    s_waitcnt lgkmcnt(0)
    v_mfma_f32_16x16x32_bf16 v[44:47], v[192:195], v[100:103], v[44:47]
    v_mfma_f32_16x16x32_bf16 v[48:51], v[196:199], v[100:103], v[48:51]
    v_mfma_f32_16x16x32_bf16 v[52:55], v[200:203], v[100:103], v[52:55]
    v_mfma_f32_16x16x32_bf16 v[56:59], v[204:207], v[100:103], v[56:59]
    ds_read_b128 v[160:163], v16 offset:40960
    ds_read_b128 v[164:167], v16 offset:41984
    ds_read_b128 v[168:171], v16 offset:43008
    ds_read_b128 v[172:175], v16 offset:44032
    s_waitcnt lgkmcnt(0)
    v_mfma_f32_16x16x32_bf16 v[44:47], v[160:163], v[76:79], v[44:47]
    v_mfma_f32_16x16x32_bf16 v[48:51], v[164:167], v[76:79], v[48:51]
    v_mfma_f32_16x16x32_bf16 v[52:55], v[168:171], v[76:79], v[52:55]
    v_mfma_f32_16x16x32_bf16 v[56:59], v[172:175], v[76:79], v[56:59]
    ds_read_b128 v[176:179], v16 offset:45056
    ds_read_b128 v[180:183], v16 offset:46080
    ds_read_b128 v[184:187], v16 offset:47104
    ds_read_b128 v[188:191], v16 offset:48128
    s_waitcnt lgkmcnt(0)
    v_mfma_f32_16x16x32_bf16 v[44:47], v[176:179], v[104:107], v[44:47]
    v_mfma_f32_16x16x32_bf16 v[48:51], v[180:183], v[104:107], v[48:51]
    v_mfma_f32_16x16x32_bf16 v[52:55], v[184:187], v[104:107], v[52:55]
    v_mfma_f32_16x16x32_bf16 v[56:59], v[188:191], v[104:107], v[56:59]
    ds_read_b128 v[192:195], v16 offset:49152
    ds_read_b128 v[196:199], v16 offset:50176
    ds_read_b128 v[200:203], v16 offset:51200
    ds_read_b128 v[204:207], v16 offset:52224
    s_waitcnt lgkmcnt(0)
    v_mfma_f32_16x16x32_bf16 v[44:47], v[192:195], v[80:83], v[44:47]
    v_mfma_f32_16x16x32_bf16 v[48:51], v[196:199], v[80:83], v[48:51]
    v_mfma_f32_16x16x32_bf16 v[52:55], v[200:203], v[80:83], v[52:55]
    v_mfma_f32_16x16x32_bf16 v[56:59], v[204:207], v[80:83], v[56:59]
    ds_read_b128 v[160:163], v16 offset:53248
    ds_read_b128 v[164:167], v16 offset:54272
    ds_read_b128 v[168:171], v16 offset:55296
    ds_read_b128 v[172:175], v16 offset:56320
    s_waitcnt lgkmcnt(0)
    v_mfma_f32_16x16x32_bf16 v[44:47], v[160:163], v[108:111], v[44:47]
    v_mfma_f32_16x16x32_bf16 v[48:51], v[164:167], v[108:111], v[48:51]
    v_mfma_f32_16x16x32_bf16 v[52:55], v[168:171], v[108:111], v[52:55]
    v_mfma_f32_16x16x32_bf16 v[56:59], v[172:175], v[108:111], v[56:59]
    ds_read_b128 v[176:179], v16 offset:57344
    ds_read_b128 v[180:183], v16 offset:58368
    ds_read_b128 v[184:187], v16 offset:59392
    ds_read_b128 v[188:191], v16 offset:60416
    s_waitcnt lgkmcnt(0)
    v_mfma_f32_16x16x32_bf16 v[44:47], v[176:179], v[84:87], v[44:47]
    v_mfma_f32_16x16x32_bf16 v[48:51], v[180:183], v[84:87], v[48:51]
    v_mfma_f32_16x16x32_bf16 v[52:55], v[184:187], v[84:87], v[52:55]
    v_mfma_f32_16x16x32_bf16 v[56:59], v[188:191], v[84:87], v[56:59]
    ds_read_b128 v[192:195], v16 offset:61440
    ds_read_b128 v[196:199], v16 offset:62464
    ds_read_b128 v[200:203], v16 offset:63488
    ds_read_b128 v[204:207], v16 offset:64512
    s_waitcnt lgkmcnt(0)
    v_mfma_f32_16x16x32_bf16 v[44:47], v[192:195], v[112:115], v[44:47]
    v_mfma_f32_16x16x32_bf16 v[48:51], v[196:199], v[112:115], v[48:51]
    v_mfma_f32_16x16x32_bf16 v[52:55], v[200:203], v[112:115], v[52:55]
    v_mfma_f32_16x16x32_bf16 v[56:59], v[204:207], v[112:115], v[56:59]
    ds_read_b128 v[160:163], v16 offset:0
    ds_read_b128 v[164:167], v16 offset:1024
    ds_read_b128 v[168:171], v16 offset:2048
    ds_read_b128 v[172:175], v16 offset:3072
    s_waitcnt lgkmcnt(0)
    v_mfma_f32_16x16x32_bf16 v[44:47], v[160:163], v[88:91], v[44:47]
    v_mfma_f32_16x16x32_bf16 v[48:51], v[164:167], v[88:91], v[48:51]
    v_mfma_f32_16x16x32_bf16 v[52:55], v[168:171], v[88:91], v[52:55]
    v_mfma_f32_16x16x32_bf16 v[56:59], v[172:175], v[88:91], v[56:59]
    ds_read_b128 v[176:179], v16 offset:4096
    ds_read_b128 v[180:183], v16 offset:5120
    ds_read_b128 v[184:187], v16 offset:6144
    ds_read_b128 v[188:191], v16 offset:7168
    s_waitcnt lgkmcnt(0)
    v_mfma_f32_16x16x32_bf16 v[44:47], v[176:179], v[116:119], v[44:47]
    v_mfma_f32_16x16x32_bf16 v[48:51], v[180:183], v[116:119], v[48:51]
    v_mfma_f32_16x16x32_bf16 v[52:55], v[184:187], v[116:119], v[52:55]
    v_mfma_f32_16x16x32_bf16 v[56:59], v[188:191], v[116:119], v[56:59]
    s_add_u32 m0, s62, 16384
    s_nop 7
    s_branch BACK_u2
SPIN_px:
    s_mov_b32 s38, 0
LOOP_px:

    buffer_load_dwordx2 v[240:241], v223, s[20:23], 0 offen offset:0 sc1
    buffer_load_dwordx2 v[242:243], v223, s[20:23], 0 offen offset:64 sc1
    buffer_load_dwordx2 v[244:245], v223, s[20:23], 0 offen offset:128 sc1
    buffer_load_dwordx2 v[246:247], v223, s[20:23], 0 offen offset:192 sc1
    s_add_u32 s38, s38, 1
    s_waitcnt vmcnt(0)
    v_max3_u32 v1, v240, v242, v244
    v_max_u32 v1, v1, v246
    v_cmp_eq_u32 vcc, -1, v1
    s_nop 1
    s_cbranch_vccz BACK_px
    s_cmp_lt_u32 s38, 200000
    s_cbranch_scc1 LOOP_px
    s_endpgm
SPIN_gz:
    s_mov_b32 s38, 0
LOOP_gz:

    buffer_load_dwordx4 v[208:211], v12, s[20:23], 0 offen offset:0 sc1
    buffer_load_dwordx4 v[212:215], v12, s[20:23], 0 offen offset:16 sc1
    s_add_u32 s38, s38, 1
    s_waitcnt vmcnt(0)
    v_bitop3_b32 v1, v209, v211, v30 bitop3:0x7e
    v_bitop3_b32 v2, v213, v215, v30 bitop3:0x7e
    v_or_b32 v1, v1, v2
    v_cmp_ne_u32 vcc, 0, v1
    s_nop 1
    s_cbranch_vccz BACK_gz
    s_cmp_lt_u32 s38, 200000
    s_cbranch_scc1 LOOP_gz
    s_endpgm
L_end:
.section .rodata,"a"
.p2align 6
.amdhsa_kernel gated_mix__spectral_gfnet__swiglu_ffn__prompt_kernel
  .amdhsa_next_free_vgpr 512
  .amdhsa_next_free_sgpr 102
  .amdhsa_accum_offset 256
  .amdhsa_group_segment_fixed_size 0
  .amdhsa_kernarg_size 88
  .amdhsa_user_sgpr_count 2
  .amdhsa_user_sgpr_kernarg_segment_ptr 1
  .amdhsa_system_sgpr_workgroup_id_x 1
.end_amdhsa_kernel
```
